```python
import torch

def _softmax(x, axis=-1):
    return torch.softmax(x, dim=axis)

def _gelu(x):
    return torch.nn.functional.gelu(x, approximate='tanh')

def _silu(x):
    return torch.nn.functional.silu(x)

def _sigmoid(x):
    return torch.sigmoid(x)

def _layernorm(x, axis=-1, eps=1e-05):
    m = x.mean(dim=axis, keepdim=True)
    v = x.var(dim=axis, keepdim=True, unbiased=False)
    return (x - m) / torch.sqrt(v + eps)

def _scatter_add(tgt, idx, src, axis=0):
    return tgt.clone().index_add_(axis, idx, src)

def _segment_sum(src, seg, n):
    out = torch.zeros((n,) + src.shape[1:], dtype=src.dtype)
    return out.index_add_(0, seg, src)

def _pad(x, pw):
    flat = tuple((v for pair in reversed(pw) for v in pair))
    return torch.nn.functional.pad(x, flat)
kernel_name = 'recurrent_scan__sliding_local_dilated__mixer_gmlp__prompt'

def setup_inputs():

    _w = lambda a: (lambda t: t.to(torch.bfloat16) if t.is_floating_point() else t)(torch.as_tensor(a))

    def _A_setup():
        B, S, D = (1, 2048, 512)
        return {'x': _w((lambda *s: torch.randn(*s, dtype=torch.bfloat16) * 0.05)(B, S, D)), 'wqkv': _w((lambda *s: torch.randn(*s, dtype=torch.bfloat16) * 0.05)(D, 3 * D)), 'wo': _w((lambda *s: torch.randn(*s, dtype=torch.bfloat16) * 0.05)(D, D))}
    _A_in = _A_setup()

    def _B_setup():
        B, S, D, F = (1, 2048, 512, 1792)
        Fh = F // 2
        return {'x': _w((lambda *s: torch.randn(*s, dtype=torch.bfloat16) * 0.05)(B, S, D)), 'w_in': _w((lambda *s: torch.randn(*s, dtype=torch.bfloat16) * 0.4)(D, 2 * Fh)), 'w_sp': _w(0.01 * (lambda *s: torch.randn(*s, dtype=torch.bfloat16) * 0.4)(S, S)), 'b_sp': _w(1.0 + 0.01 * (lambda *s: torch.randn(*s, dtype=torch.bfloat16) * 0.05)(S)), 'w_out': _w((lambda *s: torch.randn(*s, dtype=torch.bfloat16) * 0.05)(Fh, D))}
    _B_in = _B_setup()
    return {'A_x': _A_in['x'], 'A_wqkv': _A_in['wqkv'], 'A_wo': _A_in['wo'], 'B_x': _B_in['x'], 'B_w_in': _B_in['w_in'], 'B_w_sp': _B_in['w_sp'], 'B_b_sp': _B_in['b_sp'], 'B_w_out': _B_in['w_out']}

def reference(A_x, A_wqkv, A_wo, B_x, B_w_in, B_w_sp, B_b_sp, B_w_out):

    def _A_ref(x, wqkv, wo):
        B, S, D = x.shape
        H = 32
        Dh = D // H
        W, dil = (8, 2)
        qkv = (lambda x, *d: x.permute(*d))((x @ wqkv).reshape(B, S, 3, H, Dh), 2, 0, 3, 1, 4)
        q, k, v = (qkv[0], qkv[1], qkv[2])
        scale = Dh ** (-0.5)
        pos = torch.arange(S)
        off = torch.arange(W) * dil
        idx = pos[:, None] - off[None, :]
        mask = idx >= 0
        idx_c = torch.where(mask, idx, 0).reshape(-1)
        kg = k[:, :, idx_c, :].reshape(B, H, S, W, Dh)
        vg = v[:, :, idx_c, :].reshape(B, H, S, W, Dh)
        logits = torch.einsum('bhsd,bhswd->bhsw', q, kg) * scale
        logits = torch.where(mask[None, None, :, :], logits, -1000000000.0)
        attn = _softmax(logits, axis=-1)
        o = torch.einsum('bhsw,bhswd->bhsd', attn, vg)
        return (lambda x, *d: x.permute(*d))(o, 0, 2, 1, 3).reshape(B, S, D) @ wo

    def _B_ref(x, w_in, w_sp, b_sp, w_out):
        B, S, D = x.shape
        F = w_in.shape[-1]
        Fh = F // 2
        z = _gelu(torch.einsum('bsd,df->bsf', x, w_in))
        z1 = z[..., :Fh].clone()
        z2 = _layernorm(z[..., Fh:], axis=-1)
        g = torch.einsum('ts,bsf->btf', w_sp, z2) + b_sp[None, :, None]
        return torch.einsum('bsf,fd->bsd', z1 * g, w_out)
    x = A_x
    xn = _layernorm(x, axis=-1)
    s = _A_ref(xn, A_wqkv, A_wo)
    g = _silu(_B_ref(xn, B_w_in, B_w_sp, B_b_sp, B_w_out))
    return x + s * g
```

```asm
; @launch grid=(256,1,1) block=(256,1,1) lds=163840
.amdgcn_target "amdgcn-amd-amdhsa--gfx950"
.text
.globl recurrent_scan__sliding_local_dilated__mixer_gmlp__prompt_kernel
.p2align 8
.type recurrent_scan__sliding_local_dilated__mixer_gmlp__prompt_kernel,@function
recurrent_scan__sliding_local_dilated__mixer_gmlp__prompt_kernel:
s_load_dwordx2 s[4:5], s[0:1], 0
s_load_dwordx2 s[24:25], s[0:1], 80
s_getpc_b64 s[72:73]
s_cmp_ge_u32 s2, 256
s_cbranch_scc1 L_end
s_lshl_b32 s75, s2, 8
v_lshlrev_b32 v2, 3, v0
s_and_b32 s75, s75, 0xf800
v_add_u32 v2, s75, v2
global_load_dword v30, v2, s[72:73]
s_lshr_b32 s101, s2, 5
s_and_b32 s76, s2, 4
s_lshl1_add_u32 s77, s76, s101
s_bfe_u32 s76, s2, 0x10001
s_lshl1_add_u32 s41, s77, s76
s_and_b32 s74, s2, 1
s_bfe_u32 s77, s2, 0x20003
s_lshl2_add_u32 s42, s74, s77
s_lshl1_add_u32 s43, s42, s101
v_lshrrev_b32 v233, 3, v0
v_and_b32 v232, 7, v0
s_and_b32 s43, s43, 7
v_and_b32 v234, 24, v233
v_add_u32 v235, v233, v234
s_lshl_b32 s72, s42, 3
s_and_b32 s72, s72, 8
s_lshl_b32 s73, s41, 6
s_add_u32 s74, s73, s72
v_add_u32 v235, s74, v235
v_lshlrev_b32 v235, 10, v235
v_lshl_add_u32 v235, v232, 4, v235
s_lshl_b32 s80, s43, 7
s_mov_b32 s6, 0x200000
s_mov_b32 s7, 0x20000
s_xor_b32 s81, s80, 128
s_xor_b32 s82, s80, 256
s_xor_b32 s83, s80, 384
s_xor_b32 s84, s80, 512
s_xor_b32 s85, s80, 640
s_xor_b32 s86, s80, 768
s_xor_b32 s87, s80, 896
s_waitcnt lgkmcnt(0)
buffer_load_dwordx4 v[64:67], v235, s[4:7], s80 offen
buffer_load_dwordx4 v[68:71], v235, s[4:7], s81 offen
buffer_load_dwordx4 v[72:75], v235, s[4:7], s82 offen
buffer_load_dwordx4 v[76:79], v235, s[4:7], s83 offen
buffer_load_dwordx4 v[80:83], v235, s[4:7], s84 offen
buffer_load_dwordx4 v[84:87], v235, s[4:7], s85 offen
buffer_load_dwordx4 v[88:91], v235, s[4:7], s86 offen
buffer_load_dwordx4 v[92:95], v235, s[4:7], s87 offen
s_load_dwordx2 s[12:13], s[0:1], 32
s_load_dwordx2 s[8:9], s[0:1], 8
s_load_dwordx2 s[16:17], s[0:1], 40
s_load_dwordx2 s[20:21], s[0:1], 56
s_load_dwordx2 s[28:29], s[0:1], 64
s_load_dwordx2 s[32:33], s[0:1], 48
s_load_dwordx2 s[36:37], s[0:1], 16
v_lshrrev_b32 v1, 6, v0
v_and_b32 v0, 63, v0
v_readfirstlane_b32 s40, v1
v_and_b32 v233, 7, v233
v_add_u32 v234, s72, v233
v_xor_b32 v236, 0x2000, v235
s_lshl_b32 s46, s40, 11
s_mov_b32 s10, 1572864
s_mov_b32 s11, 0x20000
s_mov_b32 s14, 1835008
s_mov_b32 s15, 0x20000
s_mov_b32 s18, 8388608
s_mov_b32 s19, 0x20000
s_mov_b32 s22, 917504
s_mov_b32 s23, 0x20000
s_mov_b32 s26, 268435456
s_mov_b32 s27, 0x20000
s_mov_b32 s30, 2097152
s_mov_b32 s31, 0x20000
s_mov_b32 s34, 4096
s_mov_b32 s35, 0x20000
s_mov_b32 s38, 524288
s_mov_b32 s39, 0x20000
s_mov_b32 s96, 0x3f803f80
v_lshlrev_b32 v1, 4, v0
s_waitcnt lgkmcnt(0)
s_load_dword s45, s[24:25], 0
s_cmp_eq_u32 s42, 7
s_cbranch_scc1 L_roleS
v_and_b32 v248, 6, v233
v_xor_b32 v248, v248, v232
v_lshlrev_b32 v248, 4, v248
v_lshrrev_b32 v249, 5, v0
v_lshlrev_b32 v249, 3, v249
v_and_b32 v250, 3, v233
v_add_u32 v249, v249, v250
s_and_b32 s72, s40, 1
s_lshr_b32 s73, s40, 1
s_lshl_b32 s74, s72, 2
v_add_u32 v250, s74, v249
v_mul_u32_u24 v250, 3584, v250
s_lshl_b32 s74, s42, 8
s_lshl_b32 s76, s73, 7
s_add_u32 s74, s74, s76
v_add3_u32 v2, v250, v248, s74
v_add_u32 v3, 56320, v2
s_lshl_b32 s74, s72, 2
s_lshl_b32 s76, s73, 5
s_add_u32 s74, s74, s76
v_add_u32 v250, s74, v249
v_mul_u32_u24 v250, 3072, v250
s_cmp_eq_u32 s42, 3
s_cselect_b32 s1, 7, s42
s_lshl_b32 s74, s1, 7
v_add3_u32 v4, v250, v248, s74
v_add_u32 v5, 48128, v4
s_mul_i32 s48, s80, 1792
s_add_u32 s56, s48, 114688
s_mul_i32 s64, s80, 1536
s_mul_i32 s49, s81, 1792
s_add_u32 s57, s49, 114688
s_mul_i32 s65, s81, 1536
s_mul_i32 s50, s82, 1792
s_add_u32 s58, s50, 114688
s_mul_i32 s66, s82, 1536
s_mul_i32 s51, s83, 1792
s_add_u32 s59, s51, 114688
s_mul_i32 s67, s83, 1536
s_mul_i32 s52, s84, 1792
s_add_u32 s60, s52, 114688
s_mul_i32 s68, s84, 1536
s_mul_i32 s53, s85, 1792
s_add_u32 s61, s53, 114688
s_mul_i32 s69, s85, 1536
s_mul_i32 s54, s86, 1792
s_add_u32 s62, s54, 114688
s_mul_i32 s70, s86, 1536
s_mul_i32 s55, s87, 1792
s_add_u32 s63, s55, 114688
s_mul_i32 s71, s87, 1536
s_lshl_b32 s76, s40, 4
v_add_u32 v250, s76, v233
v_lshlrev_b32 v251, 10, v250
v_add3_u32 v8, v251, v248, s74
v_add_u32 v9, 7168, v8
s_mov_b32 s47, s42
s_cmp_ge_u32 s47, 7
s_cselect_b32 s76, 7, 0
s_sub_u32 s47, s47, s76
s_lshl_b32 s97, s47, 17
v_lshlrev_b32 v250, 12, v250
v_lshrrev_b32 v251, 4, v0
v_xor_b32 v251, v251, v232
v_lshl_add_u32 v6, v251, 4, v250
v_xor_b32 v7, 64, v6
v_add_u32 v7, 31744, v7
s_lshl_b32 s74, s41, 18
s_and_b32 s76, s41, 1
s_lshl_b32 s76, s76, 11
s_add_u32 s74, s74, s76
s_and_b32 s76, s101, 1
s_lshl_b32 s76, s76, 9
s_add_u32 s98, s74, s76
s_cmp_eq_u32 s41, 0
s_cselect_b32 s44, 0xf149f2ca, 0
v_lshrrev_b32 v250, 2, v232
v_lshlrev_b32 v250, 10, v250
v_and_b32 v251, 3, v232
v_lshl_add_u32 v250, v251, 8, v250
s_add_u32 s74, s46, 16384
v_xor_b32 v251, v234, v232
v_lshl_add_u32 v237, v251, 4, v250
v_add_u32 v237, s74, v237
v_xor_b32 v238, 128, v237
v_and_b32 v250, 15, v0
v_lshrrev_b32 v251, 4, v0
v_xor_b32 v249, v250, v251
v_lshlrev_b32 v249, 4, v249
v_lshl_add_u32 v249, v251, 8, v249
v_add_u32 v10, 16384, v249
v_xor_b32 v11, 1088, v10
v_lshrrev_b32 v249, 2, v250
v_cmp_eq_u32 vcc, v249, v251
v_and_b32 v249, 1, v0
v_lshlrev_b32 v249, 4, v249
v_mov_b32 v176, 0x3f80
v_lshlrev_b32 v249, v249, v176
v_cndmask_b32 v249, 0, v249, vcc
v_and_b32 v250, 2, v0
v_cmp_eq_u32 vcc, 0, v250
v_mov_b32 v176, 0
v_mov_b32 v177, 0
v_mov_b32 v180, 0
v_mov_b32 v181, 0
v_cndmask_b32 v178, 0, v249, vcc
v_sub_u32 v179, v249, v178
v_lshrrev_b32 v249, 2, v0
v_lshlrev_b32 v249, 7, v249
v_and_b32 v250, 3, v0
v_lshl_add_u32 v249, v250, 3, v249
v_and_b32 v250, 3, v233
v_lshl_add_u32 v249, v250, 5, v249
s_lshl_b32 s74, s40, 5
v_xor_b32 v18, s74, v249
s_lshl_b32 s74, s72, 6
s_lshl_b32 s76, s73, 12
s_or_b32 s74, s74, s76
v_xor_b32 v12, s74, v249
v_xor_b32 v13, 32, v12
v_add_u32 v19, 65536, v18
v_add_u32 v14, 65536, v12
v_add_u32 v15, 65536, v13
v_add_u32 v20, 131072, v18
v_add_u32 v16, 131072, v12
v_add_u32 v17, 131072, v13
s_lshl_b32 s74, s40, 6
s_add_u32 s74, s74, 64
v_lshl_add_u32 v240, v234, 2, s74
v_xor_b32 v241, 32, v240
v_and_b32 v243, 15, v0
v_lshlrev_b32 v243, 2, v243
v_and_b32 v218, 31, v0
v_lshlrev_b32 v218, 5, v218
s_lshl2_add_u32 s75, s42, s40
s_mul_i32 s73, s41, 112
s_add_u32 s73, s73, s75
s_lshl_b32 s73, s73, 10
s_add_u32 s73, s73, 8388608
v_mov_b32 v200, -1
v_mov_b32 v201, -1
v_mov_b32 v202, -1
v_mov_b32 v203, -1
s_lshl_b32 s72, s41, 7
v_lshrrev_b32 v29, 1, v243
v_add_u32 v29, s72, v29
v_mov_b32 v252, 0
v_mov_b32 v253, 0
s_waitcnt vmcnt(7)
v_dot2c_f32_bf16 v252, s96, v64
buffer_load_dwordx4 v[96:99], v236, s[4:7], s80 offen
v_dot2c_f32_bf16 v253, v64, v64
v_dot2c_f32_bf16 v252, s96, v65
v_dot2c_f32_bf16 v253, v65, v65
v_dot2c_f32_bf16 v252, s96, v66
v_dot2c_f32_bf16 v253, v66, v66
v_dot2c_f32_bf16 v252, s96, v67
v_dot2c_f32_bf16 v253, v67, v67
s_waitcnt vmcnt(7)
v_dot2c_f32_bf16 v252, s96, v68
buffer_load_dwordx4 v[100:103], v236, s[4:7], s81 offen
v_dot2c_f32_bf16 v253, v68, v68
v_dot2c_f32_bf16 v252, s96, v69
v_dot2c_f32_bf16 v253, v69, v69
v_dot2c_f32_bf16 v252, s96, v70
v_dot2c_f32_bf16 v253, v70, v70
v_dot2c_f32_bf16 v252, s96, v71
v_dot2c_f32_bf16 v253, v71, v71
s_waitcnt vmcnt(7)
v_dot2c_f32_bf16 v252, s96, v72
buffer_load_dwordx4 v[104:107], v236, s[4:7], s82 offen
v_dot2c_f32_bf16 v253, v72, v72
v_dot2c_f32_bf16 v252, s96, v73
v_dot2c_f32_bf16 v253, v73, v73
v_dot2c_f32_bf16 v252, s96, v74
v_dot2c_f32_bf16 v253, v74, v74
v_dot2c_f32_bf16 v252, s96, v75
v_dot2c_f32_bf16 v253, v75, v75
s_waitcnt vmcnt(7)
v_dot2c_f32_bf16 v252, s96, v76
buffer_load_dwordx4 v[108:111], v236, s[4:7], s83 offen
v_dot2c_f32_bf16 v253, v76, v76
v_dot2c_f32_bf16 v252, s96, v77
v_dot2c_f32_bf16 v253, v77, v77
v_dot2c_f32_bf16 v252, s96, v78
v_dot2c_f32_bf16 v253, v78, v78
v_dot2c_f32_bf16 v252, s96, v79
v_dot2c_f32_bf16 v253, v79, v79
s_waitcnt vmcnt(7)
v_dot2c_f32_bf16 v252, s96, v80
buffer_load_dwordx4 v[112:115], v236, s[4:7], s84 offen
v_dot2c_f32_bf16 v253, v80, v80
v_dot2c_f32_bf16 v252, s96, v81
v_dot2c_f32_bf16 v253, v81, v81
v_dot2c_f32_bf16 v252, s96, v82
v_dot2c_f32_bf16 v253, v82, v82
v_dot2c_f32_bf16 v252, s96, v83
v_dot2c_f32_bf16 v253, v83, v83
s_waitcnt vmcnt(7)
v_dot2c_f32_bf16 v252, s96, v84
buffer_load_dwordx4 v[116:119], v236, s[4:7], s85 offen
v_dot2c_f32_bf16 v253, v84, v84
v_dot2c_f32_bf16 v252, s96, v85
v_dot2c_f32_bf16 v253, v85, v85
v_dot2c_f32_bf16 v252, s96, v86
v_dot2c_f32_bf16 v253, v86, v86
v_dot2c_f32_bf16 v252, s96, v87
v_dot2c_f32_bf16 v253, v87, v87
s_waitcnt vmcnt(7)
v_dot2c_f32_bf16 v252, s96, v88
buffer_load_dwordx4 v[120:123], v236, s[4:7], s86 offen
v_dot2c_f32_bf16 v253, v88, v88
v_dot2c_f32_bf16 v252, s96, v89
v_dot2c_f32_bf16 v253, v89, v89
v_dot2c_f32_bf16 v252, s96, v90
v_dot2c_f32_bf16 v253, v90, v90
v_dot2c_f32_bf16 v252, s96, v91
v_dot2c_f32_bf16 v253, v91, v91
s_waitcnt vmcnt(7)
v_dot2c_f32_bf16 v252, s96, v92
buffer_load_dwordx4 v[124:127], v236, s[4:7], s87 offen
v_dot2c_f32_bf16 v253, v92, v92
v_dot2c_f32_bf16 v252, s96, v93
v_dot2c_f32_bf16 v253, v93, v93
v_dot2c_f32_bf16 v252, s96, v94
v_dot2c_f32_bf16 v253, v94, v94
v_dot2c_f32_bf16 v252, s96, v95
v_dot2c_f32_bf16 v253, v95, v95
s_nop 1
v_add_f32_dpp v252, v252, v252 quad_perm:[1,0,3,2] row_mask:0xf bank_mask:0xf
v_add_f32_dpp v253, v253, v253 quad_perm:[1,0,3,2] row_mask:0xf bank_mask:0xf
s_nop 0
v_add_f32_dpp v252, v252, v252 quad_perm:[2,3,0,1] row_mask:0xf bank_mask:0xf
v_add_f32_dpp v253, v253, v253 quad_perm:[2,3,0,1] row_mask:0xf bank_mask:0xf
s_nop 0
v_add_f32_dpp v252, v252, v252 row_half_mirror row_mask:0xf bank_mask:0xf
v_add_f32_dpp v253, v253, v253 row_half_mirror row_mask:0xf bank_mask:0xf
buffer_load_ushort v26, v29, s[32:35], 0 offen offset:0
buffer_load_ushort v27, v29, s[32:35], 0 offen offset:32
buffer_load_ushort v28, v29, s[32:35], 0 offen offset:64
buffer_load_ushort v29, v29, s[32:35], 0 offen offset:96
v_mul_f32 v184, 0xbb000000, v252
v_mul_f32 v185, 0xbb000000, v252
v_mul_f32 v186, 0xbb000000, v252
v_mul_f32 v187, 0xbb000000, v252
s_nop 1
v_mfma_f32_16x16x32_bf16 v[144:147], v[178:181], v[64:67], v[184:187]
v_mul_f32 v253, 0x3b000000, v253
v_fma_f32 v253, -v184, v184, v253
v_mfma_f32_16x16x32_bf16 v[148:151], v[176:179], v[64:67], v[184:187]
v_max_f32 v253, 0, v253
v_mfma_f32_16x16x32_bf16 v[152:155], v[178:181], v[68:71], v[184:187]
s_add_u32 m0, s46, 80128
s_nop 0
buffer_load_dwordx4 v2, s[12:15], s48 offen offset:1792  lds
v_add_f32 v253, 0x3727c5ac, v253
v_rsq_f32 v253, v253
v_mfma_f32_16x16x32_bf16 v[156:159], v[176:179], v[68:71], v[184:187]
ds_write_b32 v240, v253
v_mfma_f32_16x16x32_bf16 v[160:163], v[178:181], v[72:75], v[184:187]
v_cvt_pk_bf16_f32 v64, v144, v145
v_cvt_pk_bf16_f32 v65, v146, v147
v_mfma_f32_16x16x32_bf16 v[164:167], v[176:179], v[72:75], v[184:187]
v_cvt_pk_bf16_f32 v66, v148, v149
buffer_load_dwordx4 v3, s[12:15], s48 offen offset:2816  lds
s_add_u32 m0, s46, 88320
v_cvt_pk_bf16_f32 v67, v150, v151
ds_write_b128 v237, v[64:67] offset:0
v_mfma_f32_16x16x32_bf16 v[168:171], v[178:181], v[76:79], v[184:187]
v_cvt_pk_bf16_f32 v68, v152, v153
v_cvt_pk_bf16_f32 v69, v154, v155
v_mfma_f32_16x16x32_bf16 v[172:175], v[176:179], v[76:79], v[184:187]
v_cvt_pk_bf16_f32 v70, v156, v157
v_cvt_pk_bf16_f32 v71, v158, v159
v_mfma_f32_16x16x32_bf16 v[144:147], v[178:181], v[80:83], v[184:187]
v_cvt_pk_bf16_f32 v72, v160, v161
buffer_load_dwordx4 v2, s[12:15], s56 offen offset:1792  lds
v_cvt_pk_bf16_f32 v73, v162, v163
v_mfma_f32_16x16x32_bf16 v[148:151], v[176:179], v[80:83], v[184:187]
v_cvt_pk_bf16_f32 v74, v164, v165
v_cvt_pk_bf16_f32 v75, v166, v167
ds_write_b128 v237, v[72:75] offset:16384
v_mfma_f32_16x16x32_bf16 v[152:155], v[178:181], v[84:87], v[184:187]
v_cvt_pk_bf16_f32 v76, v168, v169
v_cvt_pk_bf16_f32 v77, v170, v171
v_mfma_f32_16x16x32_bf16 v[156:159], v[176:179], v[84:87], v[184:187]
v_cvt_pk_bf16_f32 v78, v172, v173
v_cvt_pk_bf16_f32 v79, v174, v175
buffer_load_dwordx4 v3, s[12:15], s56 offen offset:2816  lds
s_add_u32 m0, s46, 96512
v_mfma_f32_16x16x32_bf16 v[160:163], v[178:181], v[88:91], v[184:187]
v_cvt_pk_bf16_f32 v80, v144, v145
v_cvt_pk_bf16_f32 v81, v146, v147
v_mfma_f32_16x16x32_bf16 v[164:167], v[176:179], v[88:91], v[184:187]
buffer_load_dwordx4 v2, s[12:15], s49 offen offset:1792  lds
v_cvt_pk_bf16_f32 v82, v148, v149
v_cvt_pk_bf16_f32 v83, v150, v151
ds_write_b128 v237, v[80:83] offset:32768
v_mfma_f32_16x16x32_bf16 v[168:171], v[178:181], v[92:95], v[184:187]
v_cvt_pk_bf16_f32 v84, v152, v153
v_cvt_pk_bf16_f32 v85, v154, v155
buffer_load_dwordx4 v3, s[12:15], s49 offen offset:2816  lds
s_add_u32 m0, s46, 104704
v_mfma_f32_16x16x32_bf16 v[172:175], v[176:179], v[92:95], v[184:187]
v_cvt_pk_bf16_f32 v86, v156, v157
v_cvt_pk_bf16_f32 v87, v158, v159
v_cvt_pk_bf16_f32 v88, v160, v161
v_cvt_pk_bf16_f32 v89, v162, v163
v_cvt_pk_bf16_f32 v90, v164, v165
v_cvt_pk_bf16_f32 v91, v166, v167
ds_write_b128 v237, v[88:91] offset:49152
v_cvt_pk_bf16_f32 v92, v168, v169
v_cvt_pk_bf16_f32 v93, v170, v171
v_cvt_pk_bf16_f32 v94, v172, v173
buffer_load_dwordx4 v2, s[12:15], s57 offen offset:1792  lds
v_cvt_pk_bf16_f32 v95, v174, v175
v_mov_b32 v252, 0
v_mov_b32 v253, 0
s_waitcnt vmcnt(18)
v_dot2c_f32_bf16 v252, s96, v96
v_dot2c_f32_bf16 v253, v96, v96
v_dot2c_f32_bf16 v252, s96, v97
v_dot2c_f32_bf16 v253, v97, v97
ds_write_b128 v237, v[68:71] offset:8192
v_dot2c_f32_bf16 v252, s96, v98
v_dot2c_f32_bf16 v253, v98, v98
v_dot2c_f32_bf16 v252, s96, v99
v_dot2c_f32_bf16 v253, v99, v99
s_waitcnt vmcnt(17)
v_dot2c_f32_bf16 v252, s96, v100
v_dot2c_f32_bf16 v253, v100, v100
v_dot2c_f32_bf16 v252, s96, v101
buffer_load_dwordx4 v3, s[12:15], s57 offen offset:2816  lds
s_add_u32 m0, s46, 112896
v_dot2c_f32_bf16 v253, v101, v101
v_dot2c_f32_bf16 v252, s96, v102
v_dot2c_f32_bf16 v253, v102, v102
v_dot2c_f32_bf16 v252, s96, v103
v_dot2c_f32_bf16 v253, v103, v103
s_waitcnt vmcnt(17)
v_dot2c_f32_bf16 v252, s96, v104
v_dot2c_f32_bf16 v253, v104, v104
v_dot2c_f32_bf16 v252, s96, v105
v_dot2c_f32_bf16 v253, v105, v105
ds_write_b128 v237, v[76:79] offset:24576
v_dot2c_f32_bf16 v252, s96, v106
v_dot2c_f32_bf16 v253, v106, v106
v_dot2c_f32_bf16 v252, s96, v107
v_dot2c_f32_bf16 v253, v107, v107
s_waitcnt vmcnt(16)
v_dot2c_f32_bf16 v252, s96, v108
v_dot2c_f32_bf16 v253, v108, v108
v_dot2c_f32_bf16 v252, s96, v109
v_dot2c_f32_bf16 v253, v109, v109
v_dot2c_f32_bf16 v252, s96, v110
v_dot2c_f32_bf16 v253, v110, v110
v_dot2c_f32_bf16 v252, s96, v111
v_dot2c_f32_bf16 v253, v111, v111
s_waitcnt vmcnt(15)
v_dot2c_f32_bf16 v252, s96, v112
v_dot2c_f32_bf16 v253, v112, v112
v_dot2c_f32_bf16 v252, s96, v113
v_dot2c_f32_bf16 v253, v113, v113
ds_write_b128 v237, v[84:87] offset:40960
v_dot2c_f32_bf16 v252, s96, v114
v_dot2c_f32_bf16 v253, v114, v114
v_dot2c_f32_bf16 v252, s96, v115
v_dot2c_f32_bf16 v253, v115, v115
s_waitcnt vmcnt(14)
v_dot2c_f32_bf16 v252, s96, v116
v_dot2c_f32_bf16 v253, v116, v116
v_dot2c_f32_bf16 v252, s96, v117
v_dot2c_f32_bf16 v253, v117, v117
v_dot2c_f32_bf16 v252, s96, v118
v_dot2c_f32_bf16 v253, v118, v118
v_dot2c_f32_bf16 v252, s96, v119
v_dot2c_f32_bf16 v253, v119, v119
s_waitcnt vmcnt(13)
v_dot2c_f32_bf16 v252, s96, v120
v_dot2c_f32_bf16 v253, v120, v120
v_dot2c_f32_bf16 v252, s96, v121
v_dot2c_f32_bf16 v253, v121, v121
ds_write_b128 v237, v[92:95] offset:57344
v_dot2c_f32_bf16 v252, s96, v122
v_dot2c_f32_bf16 v253, v122, v122
v_dot2c_f32_bf16 v252, s96, v123
v_dot2c_f32_bf16 v253, v123, v123
s_waitcnt vmcnt(12)
v_dot2c_f32_bf16 v252, s96, v124
v_dot2c_f32_bf16 v253, v124, v124
v_dot2c_f32_bf16 v252, s96, v125
v_dot2c_f32_bf16 v253, v125, v125
v_dot2c_f32_bf16 v252, s96, v126
v_dot2c_f32_bf16 v253, v126, v126
v_dot2c_f32_bf16 v252, s96, v127
v_dot2c_f32_bf16 v253, v127, v127
s_nop 1
v_add_f32_dpp v252, v252, v252 quad_perm:[1,0,3,2] row_mask:0xf bank_mask:0xf
v_add_f32_dpp v253, v253, v253 quad_perm:[1,0,3,2] row_mask:0xf bank_mask:0xf
s_nop 0
v_add_f32_dpp v252, v252, v252 quad_perm:[2,3,0,1] row_mask:0xf bank_mask:0xf
v_add_f32_dpp v253, v253, v253 quad_perm:[2,3,0,1] row_mask:0xf bank_mask:0xf
s_nop 0
v_add_f32_dpp v252, v252, v252 row_half_mirror row_mask:0xf bank_mask:0xf
v_add_f32_dpp v253, v253, v253 row_half_mirror row_mask:0xf bank_mask:0xf
v_mul_f32 v188, 0xbb000000, v252
v_mul_f32 v189, 0xbb000000, v252
v_mul_f32 v190, 0xbb000000, v252
v_mul_f32 v191, 0xbb000000, v252
s_nop 1
v_mfma_f32_16x16x32_bf16 v[144:147], v[178:181], v[96:99], v[188:191]
v_mul_f32 v253, 0x3b000000, v253
v_fma_f32 v253, -v188, v188, v253
v_mfma_f32_16x16x32_bf16 v[148:151], v[176:179], v[96:99], v[188:191]
v_max_f32 v253, 0, v253
v_mfma_f32_16x16x32_bf16 v[152:155], v[178:181], v[100:103], v[188:191]
v_add_f32 v253, 0x3727c5ac, v253
v_rsq_f32 v253, v253
v_mfma_f32_16x16x32_bf16 v[156:159], v[176:179], v[100:103], v[188:191]
ds_write_b32 v241, v253
v_mfma_f32_16x16x32_bf16 v[160:163], v[178:181], v[104:107], v[188:191]
v_cvt_pk_bf16_f32 v96, v144, v145
v_cvt_pk_bf16_f32 v97, v146, v147
v_mfma_f32_16x16x32_bf16 v[164:167], v[176:179], v[104:107], v[188:191]
v_cvt_pk_bf16_f32 v98, v148, v149
v_cvt_pk_bf16_f32 v99, v150, v151
ds_write_b128 v238, v[96:99] offset:0
v_mfma_f32_16x16x32_bf16 v[168:171], v[178:181], v[108:111], v[188:191]
v_cvt_pk_bf16_f32 v100, v152, v153
v_cvt_pk_bf16_f32 v101, v154, v155
v_mfma_f32_16x16x32_bf16 v[172:175], v[176:179], v[108:111], v[188:191]
v_cvt_pk_bf16_f32 v102, v156, v157
v_cvt_pk_bf16_f32 v103, v158, v159
ds_write_b128 v238, v[100:103] offset:8192
v_mfma_f32_16x16x32_bf16 v[144:147], v[178:181], v[112:115], v[188:191]
v_cvt_pk_bf16_f32 v104, v160, v161
v_cvt_pk_bf16_f32 v105, v162, v163
v_mfma_f32_16x16x32_bf16 v[148:151], v[176:179], v[112:115], v[188:191]
v_cvt_pk_bf16_f32 v106, v164, v165
v_cvt_pk_bf16_f32 v107, v166, v167
ds_write_b128 v238, v[104:107] offset:16384
v_mfma_f32_16x16x32_bf16 v[152:155], v[178:181], v[116:119], v[188:191]
v_cvt_pk_bf16_f32 v108, v168, v169
v_cvt_pk_bf16_f32 v109, v170, v171
v_mfma_f32_16x16x32_bf16 v[156:159], v[176:179], v[116:119], v[188:191]
v_cvt_pk_bf16_f32 v110, v172, v173
v_cvt_pk_bf16_f32 v111, v174, v175
ds_write_b128 v238, v[108:111] offset:24576
v_mfma_f32_16x16x32_bf16 v[160:163], v[178:181], v[120:123], v[188:191]
v_cvt_pk_bf16_f32 v112, v144, v145
v_cvt_pk_bf16_f32 v113, v146, v147
v_mfma_f32_16x16x32_bf16 v[164:167], v[176:179], v[120:123], v[188:191]
v_cvt_pk_bf16_f32 v114, v148, v149
v_cvt_pk_bf16_f32 v115, v150, v151
ds_write_b128 v238, v[112:115] offset:32768
v_mfma_f32_16x16x32_bf16 v[168:171], v[178:181], v[124:127], v[188:191]
v_cvt_pk_bf16_f32 v116, v152, v153
v_cvt_pk_bf16_f32 v117, v154, v155
v_mfma_f32_16x16x32_bf16 v[172:175], v[176:179], v[124:127], v[188:191]
v_cvt_pk_bf16_f32 v118, v156, v157
v_cvt_pk_bf16_f32 v119, v158, v159
ds_write_b128 v238, v[116:119] offset:40960
v_cvt_pk_bf16_f32 v120, v160, v161
v_cvt_pk_bf16_f32 v121, v162, v163
v_cvt_pk_bf16_f32 v122, v164, v165
v_cvt_pk_bf16_f32 v123, v166, v167
ds_write_b128 v238, v[120:123] offset:49152
v_cvt_pk_bf16_f32 v124, v168, v169
v_cvt_pk_bf16_f32 v125, v170, v171
v_cvt_pk_bf16_f32 v126, v172, v173
v_cvt_pk_bf16_f32 v127, v174, v175
ds_write_b128 v238, v[124:127] offset:57344
s_waitcnt lgkmcnt(0)
s_add_u32 s45, s45, 0x9e3779b9
buffer_load_dwordx4 v2, s[12:15], s50 offen offset:1792  lds
buffer_load_dwordx4 v3, s[12:15], s50 offen offset:2816  lds
s_add_u32 m0, s46, 121088
s_nop 0
buffer_load_dwordx4 v2, s[12:15], s58 offen offset:1792  lds
buffer_load_dwordx4 v3, s[12:15], s58 offen offset:2816  lds
s_waitcnt vmcnt(8)
s_barrier
ds_read_b64_tr_b16 v[120:121], v14 offset:16384
ds_read_b64_tr_b16 v[122:123], v14 offset:18432
ds_read_b64_tr_b16 v[124:125], v15 offset:16384
ds_read_b64_tr_b16 v[126:127], v15 offset:18432
ds_read_b128 a[0:3], v10 offset:0
ds_read_b128 a[4:7], v10 offset:2048
ds_read_b128 a[8:11], v10 offset:4096
ds_read_b128 a[12:15], v10 offset:6144
ds_read_b64_tr_b16 v[128:129], v14 offset:24576
ds_read_b64_tr_b16 v[130:131], v14 offset:26624
ds_read_b64_tr_b16 v[132:133], v15 offset:24576
ds_read_b64_tr_b16 v[134:135], v15 offset:26624
ds_read_b128 a[16:19], v11 offset:0
ds_read_b128 a[20:23], v11 offset:2048
ds_read_b128 a[24:27], v11 offset:4096
ds_read_b128 a[28:31], v11 offset:6144
ds_read_b32 v22, v243 offset:64
ds_read_b32 v23, v243 offset:128
ds_read_b32 v24, v243 offset:192
ds_read_b32 v25, v243 offset:256
s_add_u32 m0, s46, 129280
s_nop 0
buffer_load_dwordx4 v2, s[12:15], s51 offen offset:1792  lds
buffer_load_dwordx4 v3, s[12:15], s51 offen offset:2816  lds
s_add_u32 m0, s46, 137472
s_nop 0
buffer_load_dwordx4 v2, s[12:15], s59 offen offset:1792  lds
s_waitcnt vmcnt(7) lgkmcnt(12)
s_barrier
v_mfma_f32_16x16x32_bf16 v[32:35], v[120:123], a[0:3], 0
buffer_load_dwordx4 v3, s[12:15], s59 offen offset:2816  lds
s_add_u32 m0, s46, 145664
v_mfma_f32_16x16x32_bf16 v[40:43], v[120:123], a[4:7], 0
ds_read_b64_tr_b16 v[152:153], v14 offset:32768
ds_read_b64_tr_b16 v[154:155], v14 offset:34816
v_mfma_f32_16x16x32_bf16 v[48:51], v[120:123], a[8:11], 0
ds_read_b64_tr_b16 v[156:157], v15 offset:32768
s_lshl_b32 s88, s40, 3
v_mfma_f32_16x16x32_bf16 v[56:59], v[120:123], a[12:15], 0
ds_read_b64_tr_b16 v[158:159], v15 offset:34816
s_add_u32 s88, s88, 512
v_mfma_f32_16x16x32_bf16 v[36:39], v[124:127], a[0:3], 0
buffer_load_dwordx4 v2, s[12:15], s52 offen offset:1792  lds
v_mfma_f32_16x16x32_bf16 v[44:47], v[124:127], a[4:7], 0
ds_read_b128 a[32:35], v10 offset:8192
ds_read_b128 a[36:39], v10 offset:10240
v_mfma_f32_16x16x32_bf16 v[52:55], v[124:127], a[8:11], 0
ds_read_b128 a[40:43], v10 offset:12288
v_lshl_add_u32 v220, v0, 5, s88
v_mfma_f32_16x16x32_bf16 v[60:63], v[124:127], a[12:15], 0
ds_read_b128 a[44:47], v10 offset:14336
s_waitcnt lgkmcnt(12)
v_mfma_f32_16x16x32_bf16 v[32:35], v[128:131], a[16:19], v[32:35]
buffer_load_dwordx4 v3, s[12:15], s52 offen offset:2816  lds
s_add_u32 m0, s46, 153856
v_mfma_f32_16x16x32_bf16 v[40:43], v[128:131], a[20:23], v[40:43]
ds_read_b64_tr_b16 v[160:161], v14 offset:40960
ds_read_b64_tr_b16 v[162:163], v14 offset:43008
v_mfma_f32_16x16x32_bf16 v[48:51], v[128:131], a[24:27], v[48:51]
ds_read_b64_tr_b16 v[164:165], v15 offset:40960
v_and_b32 v224, 15, v0
v_mfma_f32_16x16x32_bf16 v[56:59], v[128:131], a[28:31], v[56:59]
ds_read_b64_tr_b16 v[166:167], v15 offset:43008
v_lshrrev_b32 v225, 4, v0
v_mfma_f32_16x16x32_bf16 v[36:39], v[132:135], a[16:19], v[36:39]
buffer_load_dwordx4 v2, s[12:15], s60 offen offset:1792  lds
v_mfma_f32_16x16x32_bf16 v[44:47], v[132:135], a[20:23], v[44:47]
ds_read_b128 a[48:51], v11 offset:8192
ds_read_b128 a[52:55], v11 offset:10240
v_mfma_f32_16x16x32_bf16 v[52:55], v[132:135], a[24:27], v[52:55]
ds_read_b128 a[56:59], v11 offset:12288
s_lshl_b32 s88, s40, 9
v_mfma_f32_16x16x32_bf16 v[60:63], v[132:135], a[28:31], v[60:63]
ds_read_b128 a[60:63], v11 offset:14336
s_waitcnt vmcnt(7) lgkmcnt(8)
s_barrier
v_mfma_f32_16x16x32_bf16 v[32:35], v[152:155], a[32:35], v[32:35]
buffer_load_dwordx4 v3, s[12:15], s60 offen offset:2816  lds
s_add_u32 m0, s46, 80128
v_mfma_f32_16x16x32_bf16 v[40:43], v[152:155], a[36:39], v[40:43]
ds_read_b64_tr_b16 v[120:121], v14 offset:49152
ds_read_b64_tr_b16 v[122:123], v14 offset:51200
v_mfma_f32_16x16x32_bf16 v[48:51], v[152:155], a[40:43], v[48:51]
ds_read_b64_tr_b16 v[124:125], v15 offset:49152
s_add_u32 s88, s88, 512
v_mfma_f32_16x16x32_bf16 v[56:59], v[152:155], a[44:47], v[56:59]
ds_read_b64_tr_b16 v[126:127], v15 offset:51200
v_lshl_add_u32 v221, v224, 5, s88
v_mfma_f32_16x16x32_bf16 v[36:39], v[156:159], a[32:35], v[36:39]
buffer_load_dwordx4 v2, s[12:15], s53 offen offset:1792  lds
v_mfma_f32_16x16x32_bf16 v[44:47], v[156:159], a[36:39], v[44:47]
ds_read_b128 a[64:67], v10 offset:16384
ds_read_b128 a[68:71], v10 offset:18432
v_mfma_f32_16x16x32_bf16 v[52:55], v[156:159], a[40:43], v[52:55]
ds_read_b128 a[72:75], v10 offset:20480
v_lshl_add_u32 v221, v225, 3, v221
v_mfma_f32_16x16x32_bf16 v[60:63], v[156:159], a[44:47], v[60:63]
ds_read_b128 a[76:79], v10 offset:22528
s_waitcnt lgkmcnt(8)
v_mfma_f32_16x16x32_bf16 v[32:35], v[160:163], a[48:51], v[32:35]
buffer_load_dwordx4 v3, s[12:15], s53 offen offset:2816  lds
s_add_u32 m0, s46, 88320
v_mfma_f32_16x16x32_bf16 v[40:43], v[160:163], a[52:55], v[40:43]
ds_read_b64_tr_b16 v[128:129], v14 offset:57344
ds_read_b64_tr_b16 v[130:131], v14 offset:59392
v_mfma_f32_16x16x32_bf16 v[48:51], v[160:163], a[56:59], v[48:51]
ds_read_b64_tr_b16 v[132:133], v15 offset:57344
v_lshlrev_b32 v222, 4, v224
v_mfma_f32_16x16x32_bf16 v[56:59], v[160:163], a[60:63], v[56:59]
ds_read_b64_tr_b16 v[134:135], v15 offset:59392
v_lshl_add_u32 v223, v225, 10, v222
v_mfma_f32_16x16x32_bf16 v[36:39], v[164:167], a[48:51], v[36:39]
buffer_load_dwordx4 v2, s[12:15], s61 offen offset:1792  lds
v_mfma_f32_16x16x32_bf16 v[44:47], v[164:167], a[52:55], v[44:47]
ds_read_b128 a[80:83], v11 offset:16384
ds_read_b128 a[84:87], v11 offset:18432
v_mfma_f32_16x16x32_bf16 v[52:55], v[164:167], a[56:59], v[52:55]
ds_read_b128 a[88:91], v11 offset:20480
v_lshl_add_u32 v222, v225, 28, v222
v_mfma_f32_16x16x32_bf16 v[60:63], v[164:167], a[60:63], v[60:63]
ds_read_b128 a[92:95], v11 offset:22528
s_waitcnt vmcnt(7) lgkmcnt(8)
s_barrier
v_mfma_f32_16x16x32_bf16 v[32:35], v[120:123], a[64:67], v[32:35]
buffer_load_dwordx4 v3, s[12:15], s61 offen offset:2816  lds
s_add_u32 m0, s46, 14592
v_mfma_f32_16x16x32_bf16 v[40:43], v[120:123], a[68:71], v[40:43]
ds_read_b64_tr_b16 v[152:153], v16 offset:0
ds_read_b64_tr_b16 v[154:155], v16 offset:2048
v_mfma_f32_16x16x32_bf16 v[48:51], v[120:123], a[72:75], v[48:51]
ds_read_b64_tr_b16 v[156:157], v17 offset:0
s_lshl_b32 s86, s41, 13
v_mfma_f32_16x16x32_bf16 v[56:59], v[120:123], a[76:79], v[56:59]
ds_read_b64_tr_b16 v[158:159], v17 offset:2048
s_lshl_b32 s87, s40, 8
v_mfma_f32_16x16x32_bf16 v[36:39], v[124:127], a[64:67], v[36:39]
buffer_load_dwordx4 v2, s[12:15], s54 offen offset:1792  lds
v_mfma_f32_16x16x32_bf16 v[44:47], v[124:127], a[68:71], v[44:47]
ds_read_b128 a[96:99], v10 offset:24576
ds_read_b128 a[100:103], v10 offset:26624
v_mfma_f32_16x16x32_bf16 v[52:55], v[124:127], a[72:75], v[52:55]
ds_read_b128 a[104:107], v10 offset:28672
s_add_u32 s86, s86, s87
v_mfma_f32_16x16x32_bf16 v[60:63], v[124:127], a[76:79], v[60:63]
ds_read_b128 a[108:111], v10 offset:30720
s_waitcnt lgkmcnt(8)
v_mfma_f32_16x16x32_bf16 v[32:35], v[128:131], a[80:83], v[32:35]
buffer_load_dwordx4 v3, s[12:15], s54 offen offset:2816  lds
s_add_u32 m0, s46, 96512
v_mfma_f32_16x16x32_bf16 v[40:43], v[128:131], a[84:87], v[40:43]
ds_read_b64_tr_b16 v[160:161], v16 offset:8192
ds_read_b64_tr_b16 v[162:163], v16 offset:10240
v_mfma_f32_16x16x32_bf16 v[48:51], v[128:131], a[88:91], v[48:51]
ds_read_b64_tr_b16 v[164:165], v17 offset:8192
s_add_u32 s86, s86, 65536
v_mfma_f32_16x16x32_bf16 v[56:59], v[128:131], a[92:95], v[56:59]
ds_read_b64_tr_b16 v[166:167], v17 offset:10240
s_add_u32 s87, s86, 4096
v_mfma_f32_16x16x32_bf16 v[36:39], v[132:135], a[80:83], v[36:39]
buffer_load_dwordx4 v2, s[12:15], s62 offen offset:1792  lds
v_mfma_f32_16x16x32_bf16 v[44:47], v[132:135], a[84:87], v[44:47]
ds_read_b128 a[112:115], v11 offset:24576
ds_read_b128 a[116:119], v11 offset:26624
v_mfma_f32_16x16x32_bf16 v[52:55], v[132:135], a[88:91], v[52:55]
ds_read_b128 a[120:123], v11 offset:28672
s_lshl_b32 s89, s42, 10
v_mfma_f32_16x16x32_bf16 v[60:63], v[132:135], a[92:95], v[60:63]
ds_read_b128 a[124:127], v11 offset:30720
s_waitcnt vmcnt(7) lgkmcnt(8)
s_barrier
v_mfma_f32_16x16x32_bf16 v[32:35], v[152:155], a[96:99], v[32:35]
buffer_load_dwordx4 v3, s[12:15], s62 offen offset:2816  lds
s_add_u32 m0, s46, 104704
v_mfma_f32_16x16x32_bf16 v[40:43], v[152:155], a[100:103], v[40:43]
ds_read_b64_tr_b16 v[120:121], v16 offset:16384
ds_read_b64_tr_b16 v[122:123], v16 offset:18432
v_mfma_f32_16x16x32_bf16 v[48:51], v[152:155], a[104:107], v[48:51]
ds_read_b64_tr_b16 v[124:125], v17 offset:16384
s_add_u32 s89, s89, s86
v_mfma_f32_16x16x32_bf16 v[56:59], v[152:155], a[108:111], v[56:59]
ds_read_b64_tr_b16 v[126:127], v17 offset:18432
v_mov_b32 v250, s45
v_mfma_f32_16x16x32_bf16 v[36:39], v[156:159], a[96:99], v[36:39]
buffer_load_dwordx4 v2, s[12:15], s55 offen offset:1792  lds
v_mfma_f32_16x16x32_bf16 v[44:47], v[156:159], a[100:103], v[44:47]
ds_read_b128 a[128:131], v10 offset:32768
ds_read_b128 a[132:135], v10 offset:34816
v_mfma_f32_16x16x32_bf16 v[52:55], v[156:159], a[104:107], v[52:55]
ds_read_b128 a[136:139], v10 offset:36864
v_mov_b32 v251, s45
v_mfma_f32_16x16x32_bf16 v[60:63], v[156:159], a[108:111], v[60:63]
ds_read_b128 a[140:143], v10 offset:38912
s_waitcnt lgkmcnt(8)
v_mfma_f32_16x16x32_bf16 v[32:35], v[160:163], a[112:115], v[32:35]
buffer_load_dwordx4 v3, s[12:15], s55 offen offset:2816  lds
s_add_u32 m0, s46, 22784
v_mfma_f32_16x16x32_bf16 v[40:43], v[160:163], a[116:119], v[40:43]
ds_read_b64_tr_b16 v[128:129], v16 offset:24576
ds_read_b64_tr_b16 v[130:131], v16 offset:26624
v_mfma_f32_16x16x32_bf16 v[48:51], v[160:163], a[120:123], v[48:51]
ds_read_b64_tr_b16 v[132:133], v17 offset:24576
v_mul_f32 v233, 0xc0135761, v22
v_mfma_f32_16x16x32_bf16 v[56:59], v[160:163], a[124:127], v[56:59]
ds_read_b64_tr_b16 v[134:135], v17 offset:26624
v_mul_f32 v232, v22, v22
v_mfma_f32_16x16x32_bf16 v[36:39], v[164:167], a[112:115], v[36:39]
buffer_load_dwordx4 v2, s[12:15], s63 offen offset:1792  lds
v_mfma_f32_16x16x32_bf16 v[44:47], v[164:167], a[116:119], v[44:47]
ds_read_b128 a[144:147], v11 offset:32768
ds_read_b128 a[148:151], v11 offset:34816
v_mfma_f32_16x16x32_bf16 v[52:55], v[164:167], a[120:123], v[52:55]
ds_read_b128 a[152:155], v11 offset:36864
v_mul_f32 v232, v232, v233
v_mfma_f32_16x16x32_bf16 v[60:63], v[164:167], a[124:127], v[60:63]
ds_read_b128 a[156:159], v11 offset:38912
s_waitcnt vmcnt(7) lgkmcnt(8)
s_barrier
v_mfma_f32_16x16x32_bf16 v[32:35], v[120:123], a[128:131], v[32:35]
buffer_load_dwordx4 v3, s[12:15], s63 offen offset:2816  lds
s_add_u32 m0, s46, 114688
v_mfma_f32_16x16x32_bf16 v[40:43], v[120:123], a[132:135], v[40:43]
ds_read_b64_tr_b16 v[152:153], v14 offset:16384
ds_read_b64_tr_b16 v[154:155], v14 offset:18432
v_mfma_f32_16x16x32_bf16 v[48:51], v[120:123], a[136:139], v[48:51]
ds_read_b64_tr_b16 v[156:157], v15 offset:16384
v_mul_f32 v232, 0x3d372713, v232
v_mfma_f32_16x16x32_bf16 v[56:59], v[120:123], a[140:143], v[56:59]
ds_read_b64_tr_b16 v[158:159], v15 offset:18432
v_mul_f32 v235, 0xc0135761, v23
v_mfma_f32_16x16x32_bf16 v[36:39], v[124:127], a[128:131], v[36:39]
buffer_load_dwordx4 v4, s[8:11], s64 offen offset:0  lds
v_mfma_f32_16x16x32_bf16 v[44:47], v[124:127], a[132:135], v[44:47]
ds_read_b128 a[160:163], v10 offset:40960
ds_read_b128 a[164:167], v10 offset:43008
v_mfma_f32_16x16x32_bf16 v[52:55], v[124:127], a[136:139], v[52:55]
ds_read_b128 a[168:171], v10 offset:45056
v_mul_f32 v234, v23, v23
v_mfma_f32_16x16x32_bf16 v[60:63], v[124:127], a[140:143], v[60:63]
ds_read_b128 a[172:175], v10 offset:47104
s_waitcnt lgkmcnt(8)
v_mfma_f32_16x16x32_bf16 v[32:35], v[128:131], a[144:147], v[32:35]
buffer_load_dwordx4 v5, s[8:11], s64 offen offset:1024  lds
s_add_u32 m0, s46, 121856
v_mfma_f32_16x16x32_bf16 v[40:43], v[128:131], a[148:151], v[40:43]
ds_read_b64_tr_b16 v[160:161], v14 offset:24576
ds_read_b64_tr_b16 v[162:163], v14 offset:26624
v_mfma_f32_16x16x32_bf16 v[48:51], v[128:131], a[152:155], v[48:51]
ds_read_b64_tr_b16 v[164:165], v15 offset:24576
v_mul_f32 v234, v234, v235
v_mfma_f32_16x16x32_bf16 v[56:59], v[128:131], a[156:159], v[56:59]
ds_read_b64_tr_b16 v[166:167], v15 offset:26624
v_mul_f32 v234, 0x3d372713, v234
v_mfma_f32_16x16x32_bf16 v[36:39], v[132:135], a[144:147], v[36:39]
buffer_load_dwordx4 v4, s[8:11], s64 offen offset:1024  lds
v_mfma_f32_16x16x32_bf16 v[44:47], v[132:135], a[148:151], v[44:47]
ds_read_b128 a[176:179], v11 offset:40960
ds_read_b128 a[180:183], v11 offset:43008
v_mfma_f32_16x16x32_bf16 v[52:55], v[132:135], a[152:155], v[52:55]
ds_read_b128 a[184:187], v11 offset:45056
v_mul_f32 v237, 0xc0135761, v24
v_mfma_f32_16x16x32_bf16 v[60:63], v[132:135], a[156:159], v[60:63]
ds_read_b128 a[188:191], v11 offset:47104
s_waitcnt vmcnt(7) lgkmcnt(8)
s_barrier
v_mfma_f32_16x16x32_bf16 v[32:35], v[152:155], a[160:163], v[32:35]
buffer_load_dwordx4 v5, s[8:11], s64 offen offset:2048  lds
s_add_u32 m0, s46, 30720
v_mfma_f32_16x16x32_bf16 v[40:43], v[152:155], a[164:167], v[40:43]
ds_read_b64_tr_b16 v[120:121], v12 offset:16384
ds_read_b64_tr_b16 v[122:123], v12 offset:18432
v_mfma_f32_16x16x32_bf16 v[48:51], v[152:155], a[168:171], v[48:51]
ds_read_b64_tr_b16 v[124:125], v13 offset:16384
v_mul_f32 v236, v24, v24
v_mfma_f32_16x16x32_bf16 v[56:59], v[152:155], a[172:175], v[56:59]
ds_read_b64_tr_b16 v[126:127], v13 offset:18432
v_mul_f32 v236, v236, v237
v_mfma_f32_16x16x32_bf16 v[36:39], v[156:159], a[160:163], v[36:39]
buffer_load_dwordx4 v4, s[8:11], s64 offen offset:2048  lds
v_mfma_f32_16x16x32_bf16 v[44:47], v[156:159], a[164:167], v[44:47]
ds_read_b128 a[192:195], v10 offset:49152
ds_read_b128 a[196:199], v10 offset:51200
v_mfma_f32_16x16x32_bf16 v[52:55], v[156:159], a[168:171], v[52:55]
ds_read_b128 a[200:203], v10 offset:53248
v_mul_f32 v236, 0x3d372713, v236
v_mfma_f32_16x16x32_bf16 v[60:63], v[156:159], a[172:175], v[60:63]
ds_read_b128 a[204:207], v10 offset:55296
s_waitcnt lgkmcnt(8)
v_mfma_f32_16x16x32_bf16 v[32:35], v[160:163], a[176:179], v[32:35]
buffer_load_dwordx4 v5, s[8:11], s64 offen offset:3072  lds
s_add_u32 m0, s46, 131072
v_mfma_f32_16x16x32_bf16 v[40:43], v[160:163], a[180:183], v[40:43]
ds_read_b64_tr_b16 v[128:129], v14 offset:32768
ds_read_b64_tr_b16 v[130:131], v14 offset:34816
v_mfma_f32_16x16x32_bf16 v[48:51], v[160:163], a[184:187], v[48:51]
ds_read_b64_tr_b16 v[132:133], v15 offset:32768
v_mul_f32 v239, 0xc0135761, v25
v_mfma_f32_16x16x32_bf16 v[56:59], v[160:163], a[188:191], v[56:59]
ds_read_b64_tr_b16 v[134:135], v15 offset:34816
v_mul_f32 v238, v25, v25
v_mfma_f32_16x16x32_bf16 v[36:39], v[164:167], a[176:179], v[36:39]
buffer_load_dwordx4 v4, s[8:11], s65 offen offset:0  lds
v_mfma_f32_16x16x32_bf16 v[44:47], v[164:167], a[180:183], v[44:47]
ds_read_b128 a[208:211], v11 offset:49152
ds_read_b128 a[212:215], v11 offset:51200
v_mfma_f32_16x16x32_bf16 v[52:55], v[164:167], a[184:187], v[52:55]
ds_read_b128 a[216:219], v11 offset:53248
v_mul_f32 v238, v238, v239
v_mfma_f32_16x16x32_bf16 v[60:63], v[164:167], a[188:191], v[60:63]
ds_read_b128 a[220:223], v11 offset:55296
s_waitcnt vmcnt(7) lgkmcnt(8)
s_barrier
v_mfma_f32_16x16x32_bf16 v[32:35], v[120:123], a[192:195], v[32:35]
buffer_load_dwordx4 v5, s[8:11], s65 offen offset:1024  lds
s_add_u32 m0, s46, 138240
v_mfma_f32_16x16x32_bf16 v[40:43], v[120:123], a[196:199], v[40:43]
ds_read_b64_tr_b16 v[152:153], v14 offset:40960
ds_read_b64_tr_b16 v[154:155], v14 offset:43008
v_mfma_f32_16x16x32_bf16 v[48:51], v[120:123], a[200:203], v[48:51]
ds_read_b64_tr_b16 v[156:157], v15 offset:40960
v_mul_f32 v238, 0x3d372713, v238
v_mfma_f32_16x16x32_bf16 v[56:59], v[120:123], a[204:207], v[56:59]
ds_read_b64_tr_b16 v[158:159], v15 offset:43008
v_mfma_f32_16x16x32_bf16 v[36:39], v[124:127], a[192:195], v[36:39]
ds_read_b128 a[224:227], v10 offset:57344
v_mfma_f32_16x16x32_bf16 v[44:47], v[124:127], a[196:199], v[44:47]
ds_read_b128 a[228:231], v10 offset:59392
v_mfma_f32_16x16x32_bf16 v[52:55], v[124:127], a[200:203], v[52:55]
ds_read_b128 a[232:235], v10 offset:61440
v_mfma_f32_16x16x32_bf16 v[60:63], v[124:127], a[204:207], v[60:63]
ds_read_b128 a[236:239], v10 offset:63488
s_waitcnt lgkmcnt(8)
v_mfma_f32_16x16x32_bf16 v[32:35], v[128:131], a[208:211], v[32:35]
ds_read_b64_tr_b16 v[160:161], v12 offset:24576
v_mfma_f32_16x16x32_bf16 v[40:43], v[128:131], a[212:215], v[40:43]
ds_read_b64_tr_b16 v[162:163], v12 offset:26624
v_mfma_f32_16x16x32_bf16 v[48:51], v[128:131], a[216:219], v[48:51]
ds_read_b64_tr_b16 v[164:165], v13 offset:24576
v_mfma_f32_16x16x32_bf16 v[56:59], v[128:131], a[220:223], v[56:59]
ds_read_b64_tr_b16 v[166:167], v13 offset:26624
v_mfma_f32_16x16x32_bf16 v[36:39], v[132:135], a[208:211], v[36:39]
ds_read_b128 a[240:243], v11 offset:57344
v_mfma_f32_16x16x32_bf16 v[44:47], v[132:135], a[212:215], v[44:47]
ds_read_b128 a[244:247], v11 offset:59392
v_mfma_f32_16x16x32_bf16 v[52:55], v[132:135], a[216:219], v[52:55]
ds_read_b128 a[248:251], v11 offset:61440
v_mfma_f32_16x16x32_bf16 v[60:63], v[132:135], a[220:223], v[60:63]
ds_read_b128 a[252:255], v11 offset:63488
s_waitcnt lgkmcnt(8)
s_barrier
v_mfma_f32_16x16x32_bf16 v[32:35], v[152:155], a[224:227], v[32:35]
v_mfma_f32_16x16x32_bf16 v[40:43], v[152:155], a[228:231], v[40:43]
v_mfma_f32_16x16x32_bf16 v[48:51], v[152:155], a[232:235], v[48:51]
v_mfma_f32_16x16x32_bf16 v[56:59], v[152:155], a[236:239], v[56:59]
v_mfma_f32_16x16x32_bf16 v[36:39], v[156:159], a[224:227], v[36:39]
v_mfma_f32_16x16x32_bf16 v[44:47], v[156:159], a[228:231], v[44:47]
v_mfma_f32_16x16x32_bf16 v[52:55], v[156:159], a[232:235], v[52:55]
v_mfma_f32_16x16x32_bf16 v[60:63], v[156:159], a[236:239], v[60:63]
s_waitcnt lgkmcnt(0)
v_mfma_f32_16x16x32_bf16 v[32:35], v[160:163], a[240:243], v[32:35]
v_mfma_f32_16x16x32_bf16 v[40:43], v[160:163], a[244:247], v[40:43]
v_mfma_f32_16x16x32_bf16 v[48:51], v[160:163], a[248:251], v[48:51]
v_mfma_f32_16x16x32_bf16 v[56:59], v[160:163], a[252:255], v[56:59]
v_mfma_f32_16x16x32_bf16 v[36:39], v[164:167], a[240:243], v[36:39]
v_mfma_f32_16x16x32_bf16 v[44:47], v[164:167], a[244:247], v[44:47]
v_mfma_f32_16x16x32_bf16 v[52:55], v[164:167], a[248:251], v[52:55]
v_mfma_f32_16x16x32_bf16 v[60:63], v[164:167], a[252:255], v[60:63]
s_barrier
v_pk_mul_f32 v[240:241], v[32:33], v[32:33]
v_pk_mul_f32 v[242:243], v[34:35], v[34:35]
s_nop 1
v_pk_mul_f32 v[244:245], v[36:37], v[36:37]
v_pk_mul_f32 v[246:247], v[38:39], v[38:39]
v_pk_fma_f32 v[240:241], v[240:241], v[232:233], v[232:233] op_sel:[0,0,1] op_sel_hi:[1,0,1]
v_pk_fma_f32 v[242:243], v[242:243], v[232:233], v[232:233] op_sel:[0,0,1] op_sel_hi:[1,0,1]
v_pk_fma_f32 v[244:245], v[244:245], v[232:233], v[232:233] op_sel:[0,0,1] op_sel_hi:[1,0,1]
v_pk_fma_f32 v[246:247], v[246:247], v[232:233], v[232:233] op_sel:[0,0,1] op_sel_hi:[1,0,1]
v_pk_mul_f32 v[240:241], v[240:241], v[32:33]
v_pk_mul_f32 v[242:243], v[242:243], v[34:35]
v_pk_mul_f32 v[244:245], v[244:245], v[36:37]
v_pk_mul_f32 v[246:247], v[246:247], v[38:39]
v_exp_f32 v240, v240
v_pk_mul_f32 v[64:65], v[40:41], v[40:41]
v_exp_f32 v241, v241
v_pk_mul_f32 v[66:67], v[42:43], v[42:43]
v_exp_f32 v242, v242
v_pk_add_f32 v[240:241], v[240:241], 1.0 op_sel_hi:[1,0]
v_exp_f32 v243, v243
v_pk_mul_f32 v[68:69], v[44:45], v[44:45]
v_exp_f32 v244, v244
v_pk_add_f32 v[242:243], v[242:243], 1.0 op_sel_hi:[1,0]
v_exp_f32 v245, v245
v_pk_mul_f32 v[70:71], v[46:47], v[46:47]
v_exp_f32 v246, v246
v_pk_add_f32 v[244:245], v[244:245], 1.0 op_sel_hi:[1,0]
v_exp_f32 v247, v247
v_pk_fma_f32 v[64:65], v[64:65], v[234:235], v[234:235] op_sel:[0,0,1] op_sel_hi:[1,0,1]
v_rcp_f32 v240, v240
v_pk_add_f32 v[246:247], v[246:247], 1.0 op_sel_hi:[1,0]
v_rcp_f32 v241, v241
v_pk_fma_f32 v[66:67], v[66:67], v[234:235], v[234:235] op_sel:[0,0,1] op_sel_hi:[1,0,1]
v_rcp_f32 v242, v242
v_pk_fma_f32 v[68:69], v[68:69], v[234:235], v[234:235] op_sel:[0,0,1] op_sel_hi:[1,0,1]
v_rcp_f32 v243, v243
v_pk_fma_f32 v[70:71], v[70:71], v[234:235], v[234:235] op_sel:[0,0,1] op_sel_hi:[1,0,1]
v_rcp_f32 v244, v244
v_pk_mul_f32 v[64:65], v[64:65], v[40:41]
v_rcp_f32 v245, v245
v_pk_mul_f32 v[66:67], v[66:67], v[42:43]
v_rcp_f32 v246, v246
v_pk_mul_f32 v[68:69], v[68:69], v[44:45]
v_rcp_f32 v247, v247
v_pk_mul_f32 v[70:71], v[70:71], v[46:47]
v_exp_f32 v64, v64
v_pk_mul_f32 v[32:33], v[32:33], v[240:241]
v_exp_f32 v65, v65
v_pk_mul_f32 v[34:35], v[34:35], v[242:243]
buffer_load_dwordx4 v4, s[8:11], s65 offen offset:1024  lds
v_exp_f32 v66, v66
v_pk_add_f32 v[64:65], v[64:65], 1.0 op_sel_hi:[1,0]
v_exp_f32 v67, v67
v_pk_mul_f32 v[36:37], v[36:37], v[244:245]
v_exp_f32 v68, v68
v_pk_add_f32 v[66:67], v[66:67], 1.0 op_sel_hi:[1,0]
v_exp_f32 v69, v69
v_pk_mul_f32 v[38:39], v[38:39], v[246:247]
v_exp_f32 v70, v70
buffer_load_dwordx4 v5, s[8:11], s65 offen offset:2048  lds
s_add_u32 m0, s46, 38912
v_pk_add_f32 v[68:69], v[68:69], 1.0 op_sel_hi:[1,0]
v_exp_f32 v71, v71
v_pk_mul_f32 v[240:241], v[48:49], v[48:49]
v_rcp_f32 v64, v64
v_pk_add_f32 v[70:71], v[70:71], 1.0 op_sel_hi:[1,0]
v_rcp_f32 v65, v65
v_pk_mul_f32 v[242:243], v[50:51], v[50:51]
v_rcp_f32 v66, v66
buffer_load_dwordx4 v4, s[8:11], s65 offen offset:2048  lds
v_pk_mul_f32 v[244:245], v[52:53], v[52:53]
v_rcp_f32 v67, v67
v_pk_mul_f32 v[246:247], v[54:55], v[54:55]
v_rcp_f32 v68, v68
v_pk_fma_f32 v[240:241], v[240:241], v[236:237], v[236:237] op_sel:[0,0,1] op_sel_hi:[1,0,1]
v_rcp_f32 v69, v69
v_pk_fma_f32 v[242:243], v[242:243], v[236:237], v[236:237] op_sel:[0,0,1] op_sel_hi:[1,0,1]
v_rcp_f32 v70, v70
v_pk_fma_f32 v[244:245], v[244:245], v[236:237], v[236:237] op_sel:[0,0,1] op_sel_hi:[1,0,1]
v_rcp_f32 v71, v71
v_pk_fma_f32 v[246:247], v[246:247], v[236:237], v[236:237] op_sel:[0,0,1] op_sel_hi:[1,0,1]
v_pk_mul_f32 v[240:241], v[240:241], v[48:49]
buffer_load_dwordx4 v5, s[8:11], s65 offen offset:3072  lds
s_add_u32 m0, s46, 147456
v_pk_mul_f32 v[242:243], v[242:243], v[50:51]
v_pk_mul_f32 v[244:245], v[244:245], v[52:53]
v_pk_mul_f32 v[246:247], v[246:247], v[54:55]
v_exp_f32 v240, v240
v_pk_mul_f32 v[40:41], v[40:41], v[64:65]
v_exp_f32 v241, v241
v_pk_mul_f32 v[42:43], v[42:43], v[66:67]
v_exp_f32 v242, v242
v_pk_add_f32 v[240:241], v[240:241], 1.0 op_sel_hi:[1,0]
buffer_load_dwordx4 v4, s[8:11], s66 offen offset:0  lds
v_exp_f32 v243, v243
v_pk_mul_f32 v[44:45], v[44:45], v[68:69]
v_exp_f32 v244, v244
v_pk_add_f32 v[242:243], v[242:243], 1.0 op_sel_hi:[1,0]
v_exp_f32 v245, v245
v_pk_mul_f32 v[46:47], v[46:47], v[70:71]
v_exp_f32 v246, v246
v_pk_add_f32 v[244:245], v[244:245], 1.0 op_sel_hi:[1,0]
v_exp_f32 v247, v247
buffer_load_dwordx4 v5, s[8:11], s66 offen offset:1024  lds
s_add_u32 m0, s46, 154624
v_pk_mul_f32 v[64:65], v[56:57], v[56:57]
v_rcp_f32 v240, v240
v_pk_add_f32 v[246:247], v[246:247], 1.0 op_sel_hi:[1,0]
v_rcp_f32 v241, v241
v_pk_mul_f32 v[66:67], v[58:59], v[58:59]
v_rcp_f32 v242, v242
v_pk_mul_f32 v[68:69], v[60:61], v[60:61]
v_rcp_f32 v243, v243
buffer_load_dwordx4 v4, s[8:11], s66 offen offset:1024  lds
v_pk_mul_f32 v[70:71], v[62:63], v[62:63]
v_rcp_f32 v244, v244
v_pk_fma_f32 v[64:65], v[64:65], v[238:239], v[238:239] op_sel:[0,0,1] op_sel_hi:[1,0,1]
v_rcp_f32 v245, v245
v_pk_fma_f32 v[66:67], v[66:67], v[238:239], v[238:239] op_sel:[0,0,1] op_sel_hi:[1,0,1]
v_rcp_f32 v246, v246
v_pk_fma_f32 v[68:69], v[68:69], v[238:239], v[238:239] op_sel:[0,0,1] op_sel_hi:[1,0,1]
v_rcp_f32 v247, v247
v_pk_fma_f32 v[70:71], v[70:71], v[238:239], v[238:239] op_sel:[0,0,1] op_sel_hi:[1,0,1]
buffer_load_dwordx4 v5, s[8:11], s66 offen offset:2048  lds
s_add_u32 m0, s46, 47104
v_pk_mul_f32 v[64:65], v[64:65], v[56:57]
v_pk_mul_f32 v[66:67], v[66:67], v[58:59]
v_pk_mul_f32 v[68:69], v[68:69], v[60:61]
v_pk_mul_f32 v[70:71], v[70:71], v[62:63]
v_exp_f32 v64, v64
v_pk_mul_f32 v[48:49], v[48:49], v[240:241]
v_exp_f32 v65, v65
v_pk_mul_f32 v[50:51], v[50:51], v[242:243]
v_exp_f32 v66, v66
buffer_load_dwordx4 v4, s[8:11], s66 offen offset:2048  lds
v_pk_add_f32 v[64:65], v[64:65], 1.0 op_sel_hi:[1,0]
v_exp_f32 v67, v67
v_pk_mul_f32 v[52:53], v[52:53], v[244:245]
v_exp_f32 v68, v68
v_pk_add_f32 v[66:67], v[66:67], 1.0 op_sel_hi:[1,0]
v_exp_f32 v69, v69
v_pk_mul_f32 v[54:55], v[54:55], v[246:247]
v_exp_f32 v70, v70
v_pk_add_f32 v[68:69], v[68:69], 1.0 op_sel_hi:[1,0]
v_exp_f32 v71, v71
buffer_load_dwordx4 v5, s[8:11], s66 offen offset:3072  lds
s_add_u32 m0, s46, 81920
v_rcp_f32 v64, v64
v_pk_add_f32 v[70:71], v[70:71], 1.0 op_sel_hi:[1,0]
v_rcp_f32 v65, v65
v_rcp_f32 v66, v66
v_rcp_f32 v67, v67
v_rcp_f32 v68, v68
buffer_load_dwordx4 v4, s[8:11], s67 offen offset:0  lds
v_rcp_f32 v69, v69
v_rcp_f32 v70, v70
v_rcp_f32 v71, v71
v_pk_mul_f32 v[56:57], v[56:57], v[64:65]
v_pk_mul_f32 v[58:59], v[58:59], v[66:67]
v_pk_mul_f32 v[60:61], v[60:61], v[68:69]
v_pk_mul_f32 v[62:63], v[62:63], v[70:71]
v_pk_add_f32 v[232:233], v[32:33], v[34:35]
v_pk_mul_f32 v[234:235], v[32:33], v[32:33]
v_pk_add_f32 v[236:237], v[36:37], v[38:39]
buffer_load_dwordx4 v5, s[8:11], s67 offen offset:1024  lds
s_add_u32 m0, s46, 89088
v_pk_fma_f32 v[234:235], v[34:35], v[34:35], v[234:235]
v_pk_fma_f32 v[234:235], v[36:37], v[36:37], v[234:235]
v_pk_fma_f32 v[234:235], v[38:39], v[38:39], v[234:235]
v_pk_add_f32 v[232:233], v[232:233], v[236:237]
v_add_f32 v244, v234, v235
v_add_f32 v240, v232, v233
v_pk_add_f32 v[232:233], v[40:41], v[42:43]
v_pk_mul_f32 v[234:235], v[40:41], v[40:41]
v_pk_add_f32 v[236:237], v[44:45], v[46:47]
v_pk_fma_f32 v[234:235], v[42:43], v[42:43], v[234:235]
v_pk_fma_f32 v[234:235], v[44:45], v[44:45], v[234:235]
v_pk_fma_f32 v[234:235], v[46:47], v[46:47], v[234:235]
buffer_load_dwordx4 v4, s[8:11], s67 offen offset:1024  lds
v_pk_add_f32 v[232:233], v[232:233], v[236:237]
v_add_f32 v245, v234, v235
v_add_f32 v241, v232, v233
v_pk_add_f32 v[232:233], v[48:49], v[50:51]
v_pk_mul_f32 v[234:235], v[48:49], v[48:49]
v_pk_add_f32 v[236:237], v[52:53], v[54:55]
v_pk_fma_f32 v[234:235], v[50:51], v[50:51], v[234:235]
v_pk_fma_f32 v[234:235], v[52:53], v[52:53], v[234:235]
v_pk_fma_f32 v[234:235], v[54:55], v[54:55], v[234:235]
v_pk_add_f32 v[232:233], v[232:233], v[236:237]
v_add_f32 v246, v234, v235
v_add_f32 v242, v232, v233
v_pk_add_f32 v[232:233], v[56:57], v[58:59]
v_pk_mul_f32 v[234:235], v[56:57], v[56:57]
buffer_load_dwordx4 v5, s[8:11], s67 offen offset:2048  lds
s_add_u32 m0, s46, 55296
v_pk_add_f32 v[236:237], v[60:61], v[62:63]
v_pk_fma_f32 v[234:235], v[58:59], v[58:59], v[234:235]
v_pk_fma_f32 v[234:235], v[60:61], v[60:61], v[234:235]
v_pk_fma_f32 v[234:235], v[62:63], v[62:63], v[234:235]
v_pk_add_f32 v[232:233], v[232:233], v[236:237]
v_add_f32 v247, v234, v235
v_add_f32 v243, v232, v233
v_permlane16_swap_b32 v244, v245
v_permlane16_swap_b32 v246, v247
v_permlane16_swap_b32 v240, v241
buffer_load_dwordx4 v4, s[8:11], s67 offen offset:2048  lds
v_permlane16_swap_b32 v242, v243
v_add_f32 v244, v244, v245
v_add_f32 v246, v246, v247
v_add_f32 v240, v240, v241
v_add_f32 v242, v242, v243
v_permlane32_swap_b32 v244, v246
s_nop 0
v_permlane32_swap_b32 v240, v242
v_add_f32 v233, v244, v246
v_add_f32 v232, v240, v242
ds_write_b64 v220, v[232:233]
s_waitcnt vmcnt(17) lgkmcnt(0)
s_barrier
ds_read_b64 v[248:249], v221
ds_read_b64_tr_b16 v[120:121], v19 offset:49152
ds_read_b64_tr_b16 v[122:123], v19 offset:51200
ds_read_b64_tr_b16 v[124:125], v19 offset:57344
ds_read_b64_tr_b16 v[126:127], v19 offset:59392
ds_read_b64_tr_b16 v[128:129], v18 offset:32768
ds_read_b64_tr_b16 v[130:131], v18 offset:34816
ds_read_b64_tr_b16 v[132:133], v19 offset:53248
ds_read_b64_tr_b16 v[134:135], v19 offset:55296
ds_read_b64_tr_b16 v[136:137], v19 offset:61440
ds_read_b64_tr_b16 v[138:139], v19 offset:63488
ds_read_b64_tr_b16 v[140:141], v18 offset:36864
ds_read_b64_tr_b16 v[142:143], v18 offset:38912
s_waitcnt lgkmcnt(12)
v_mov_b32 v236, v248
buffer_load_dwordx4 v5, s[8:11], s67 offen offset:3072  lds
s_add_u32 m0, s46, 16384
v_mov_b32 v237, v249
v_permlane16_swap_b32 v248, v236
s_nop 0
v_permlane16_swap_b32 v249, v237
v_add_f32 v248, v248, v236
v_add_f32 v249, v249, v237
v_mov_b32 v236, v248
v_mov_b32 v237, v249
s_nop 0
v_permlane32_swap_b32 v248, v236
v_permlane32_swap_b32 v249, v237
buffer_load_dwordx4 v4, s[8:11], s68 offen offset:0  lds
v_add_f32 v248, v248, v236
v_add_f32 v249, v249, v237
buffer_store_dwordx4 v[248:251], v222, s[24:27], s89 offen sc1
s_waitcnt vmcnt(8) lgkmcnt(6)
s_barrier
v_mfma_f32_16x16x32_bf16 v[84:87], v[124:127], a[0:3], 0
ds_read_b64_tr_b16 v[152:153], v20 offset:0
s_lshl_b32 s88, s40, 6
s_add_u32 s88, s88, 64
v_lshl_add_u32 v245, v224, 2, s88
ds_read_b32 v245, v245
s_lshl_b32 s88, s40, 7
v_mfma_f32_16x16x32_bf16 v[88:91], v[124:127], a[4:7], 0
buffer_load_dwordx4 v5, s[8:11], s68 offen offset:1024  lds
s_add_u32 m0, s46, 97280
s_add_u32 s88, s88, 2560
v_lshl_add_u32 v220, v224, 3, s88
v_lshlrev_b32 v221, 3, v224
v_mfma_f32_16x16x32_bf16 v[92:95], v[124:127], a[8:11], 0
ds_read_b64_tr_b16 v[154:155], v20 offset:2048
v_bfe_u32 v242, v0, 1, 2
v_xor_b32 v242, v242, v225
v_lshlrev_b32 v242, 4, v242
v_lshl_add_u32 v242, v224, 6, v242
s_add_u32 s88, s46, 8192
v_mfma_f32_16x16x32_bf16 v[96:99], v[124:127], a[12:15], 0
buffer_load_dwordx4 v4, s[8:11], s68 offen offset:1024  lds
v_add_u32 v242, s88, v242
v_bfe_u32 v243, v0, 3, 1
v_and_b32 v244, 3, v0
v_xor_b32 v243, v243, v244
v_mfma_f32_16x16x32_bf16 v[104:107], a[0:3], v[128:131], 0
ds_read_b64_tr_b16 v[156:157], v20 offset:8192
v_lshlrev_b32 v243, 4, v243
v_bfe_u32 v244, v0, 2, 2
v_lshl_add_u32 v243, v244, 6, v243
v_lshl_add_u32 v243, v225, 9, v243
v_add_u32 v243, s88, v243
v_mfma_f32_16x16x32_bf16 v[108:111], a[4:7], v[128:131], 0
buffer_load_dwordx4 v5, s[8:11], s68 offen offset:2048  lds
s_add_u32 m0, s46, 63488
v_xor_b32 v244, 288, v243
s_waitcnt lgkmcnt(2)
v_mul_f32 v245, v245, v245
v_mfma_f32_16x16x32_bf16 v[112:115], a[8:11], v[128:131], 0
ds_read_b64_tr_b16 v[158:159], v20 offset:10240
v_rcp_f32 v245, v245
s_lshl_b32 s88, s42, 2
s_add_u32 s88, s88, s40
s_lshl_b32 s3, s88, 17
v_mfma_f32_16x16x32_bf16 v[116:119], a[12:15], v[128:131], 0
buffer_load_dwordx4 v4, s[8:11], s68 offen offset:2048  lds
s_add_u32 s3, s3, 2097152
s_lshl_b32 s88, s88, 10
s_add_u32 s89, s88, 1572864
v_mul_f32 v245, 0x3727c5ac, v245
v_mfma_f32_16x16x32_bf16 v[64:67], v[120:123], a[0:3], 0
ds_read_b64_tr_b16 v[160:161], v18 offset:40960
v_mov_b32 v247, 0
v_mfma_f32_16x16x32_bf16 v[68:71], v[120:123], a[4:7], 0
v_and_b32 v30, 1, v0
v_cmp_eq_u32 s[80:81], 1, v30
v_mfma_f32_16x16x32_bf16 v[72:75], v[120:123], a[8:11], 0
buffer_load_dwordx4 v5, s[8:11], s68 offen offset:3072  lds
s_add_u32 m0, s46, 106496
v_mfma_f32_16x16x32_bf16 v[76:79], v[120:123], a[12:15], 0
ds_read_b64_tr_b16 v[162:163], v18 offset:43008
v_mfma_f32_16x16x32_bf16 v[84:87], v[136:139], a[16:19], v[84:87]
ds_read_b64_tr_b16 v[164:165], v20 offset:4096
v_lshrrev_b32 v231, 4, v0
v_mfma_f32_16x16x32_bf16 v[88:91], v[136:139], a[20:23], v[88:91]
v_lshl_add_u32 v231, v231, 2, v30
v_and_b32 v230, 15, v0
v_mfma_f32_16x16x32_bf16 v[92:95], v[136:139], a[24:27], v[92:95]
ds_read_b64_tr_b16 v[166:167], v20 offset:6144
v_cmp_le_u32 s[82:83], v231, v230
v_mfma_f32_16x16x32_bf16 v[96:99], v[136:139], a[28:31], v[96:99]
buffer_load_dwordx4 v4, s[8:11], s69 offen offset:0  lds
v_mfma_f32_16x16x32_bf16 v[104:107], a[16:19], v[140:143], v[104:107]
ds_read_b64_tr_b16 v[168:169], v20 offset:12288
v_add_u32 v231, 2, v231
v_mfma_f32_16x16x32_bf16 v[108:111], a[20:23], v[140:143], v[108:111]
v_cmp_le_u32 s[84:85], v231, v230
v_mov_b32 v230, 0x0c0c0100
v_mfma_f32_16x16x32_bf16 v[112:115], a[24:27], v[140:143], v[112:115]
ds_read_b64_tr_b16 v[170:171], v20 offset:14336
v_mov_b32 v231, 0x01000c0c
v_mfma_f32_16x16x32_bf16 v[116:119], a[28:31], v[140:143], v[116:119]
buffer_load_dwordx4 v5, s[8:11], s69 offen offset:1024  lds
s_add_u32 m0, s46, 23552
v_mfma_f32_16x16x32_bf16 v[64:67], v[132:135], a[16:19], v[64:67]
ds_read_b64_tr_b16 v[172:173], v18 offset:45056
v_mov_b32 v30, 0x0c0c0c0c
v_mfma_f32_16x16x32_bf16 v[68:71], v[132:135], a[20:23], v[68:71]
v_cndmask_b32 v230, v230, v231, s[80:81]
v_cndmask_b32 v226, v230, v30, s[82:83]
v_mfma_f32_16x16x32_bf16 v[72:75], v[132:135], a[24:27], v[72:75]
ds_read_b64_tr_b16 v[174:175], v18 offset:47104
v_cndmask_b32 v228, v30, v230, s[82:83]
v_mfma_f32_16x16x32_bf16 v[76:79], v[132:135], a[28:31], v[76:79]
v_mov_b32 v230, 0x0c0c0302
s_waitcnt lgkmcnt(6)
v_mfma_f32_16x16x32_bf16 v[84:87], v[156:159], a[32:35], v[84:87]
ds_read_b64_tr_b16 v[120:121], v20 offset:16384
v_mov_b32 v231, 0x03020c0c
v_mfma_f32_16x16x32_bf16 v[88:91], v[156:159], a[36:39], v[88:91]
v_cndmask_b32 v230, v230, v231, s[80:81]
v_cndmask_b32 v227, v230, v30, s[84:85]
v_mfma_f32_16x16x32_bf16 v[92:95], v[156:159], a[40:43], v[92:95]
ds_read_b64_tr_b16 v[122:123], v20 offset:18432
v_cndmask_b32 v229, v30, v230, s[84:85]
v_mfma_f32_16x16x32_bf16 v[96:99], v[156:159], a[44:47], v[96:99]
s_lshl_b32 s78, s41, 5
s_lshl_b32 s79, s42, 2
v_mfma_f32_16x16x32_bf16 v[104:107], a[32:35], v[160:163], v[104:107]
ds_read_b64_tr_b16 v[124:125], v20 offset:24576
s_add_u32 s78, s78, s79
v_mfma_f32_16x16x32_bf16 v[108:111], a[36:39], v[160:163], v[108:111]
s_add_u32 s78, s78, s40
s_lshl_b32 s77, s78, 11
v_mfma_f32_16x16x32_bf16 v[112:115], a[40:43], v[160:163], v[112:115]
ds_read_b64_tr_b16 v[126:127], v20 offset:26624
s_add_u32 s77, s77, 23068672
v_mfma_f32_16x16x32_bf16 v[116:119], a[44:47], v[160:163], v[116:119]
s_min_u32 s76, s41, 1
s_lshl_b32 s76, s76, 16
v_mfma_f32_16x16x32_bf16 v[64:67], v[152:155], a[32:35], v[64:67]
ds_read_b64_tr_b16 v[128:129], v18 offset:49152
s_sub_u32 s76, s77, s76
v_mfma_f32_16x16x32_bf16 v[68:71], v[152:155], a[36:39], v[68:71]
s_lshl_b32 s79, s78, 5
s_add_u32 s79, s79, 1605632
v_mfma_f32_16x16x32_bf16 v[72:75], v[152:155], a[40:43], v[72:75]
ds_read_b64_tr_b16 v[130:131], v18 offset:51200
s_lshr_b32 s74, s40, 1
v_mfma_f32_16x16x32_bf16 v[76:79], v[152:155], a[44:47], v[76:79]
s_and_b32 s75, s40, 1
s_waitcnt lgkmcnt(6)
v_mfma_f32_16x16x32_bf16 v[84:87], v[168:171], a[48:51], v[84:87]
buffer_load_dwordx4 v4, s[8:11], s69 offen offset:1024  lds
v_mfma_f32_16x16x32_bf16 v[88:91], v[168:171], a[52:55], v[88:91]
ds_read_b64_tr_b16 v[132:133], v20 offset:20480
s_lshl1_add_u32 s78, s41, s75
v_mfma_f32_16x16x32_bf16 v[92:95], v[168:171], a[56:59], v[92:95]
ds_read_b64_tr_b16 v[134:135], v20 offset:22528
s_lshl_b32 s78, s78, 5
v_mfma_f32_16x16x32_bf16 v[96:99], v[168:171], a[60:63], v[96:99]
s_add_u32 s78, s78, s74
s_lshl1_add_u32 s78, s1, s78
v_mfma_f32_16x16x32_bf16 v[104:107], a[48:51], v[172:175], v[104:107]
buffer_load_dwordx4 v5, s[8:11], s69 offen offset:2048  lds
s_add_u32 m0, s46, 71680
v_mfma_f32_16x16x32_bf16 v[108:111], a[52:55], v[172:175], v[108:111]
ds_read_b64_tr_b16 v[136:137], v20 offset:28672
s_lshl_b32 s78, s78, 10
v_mfma_f32_16x16x32_bf16 v[112:115], a[56:59], v[172:175], v[112:115]
ds_read_b64_tr_b16 v[138:139], v20 offset:30720
s_add_u32 s78, s78, 6291456
v_mfma_f32_16x16x32_bf16 v[116:119], a[60:63], v[172:175], v[116:119]
s_lshl_b32 s74, s74, 12
s_lshl3_add_u32 s74, s75, s74
v_mfma_f32_16x16x32_bf16 v[64:67], v[164:167], a[48:51], v[64:67]
buffer_load_dwordx4 v4, s[8:11], s69 offen offset:2048  lds
v_mfma_f32_16x16x32_bf16 v[68:71], v[164:167], a[52:55], v[68:71]
ds_read_b64_tr_b16 v[140:141], v18 offset:53248
s_add_u32 s74, s74, 8192
v_mfma_f32_16x16x32_bf16 v[72:75], v[164:167], a[56:59], v[72:75]
ds_read_b64_tr_b16 v[142:143], v18 offset:55296
v_and_b32 v230, 0x30, v0
v_mfma_f32_16x16x32_bf16 v[76:79], v[164:167], a[60:63], v[76:79]
v_add_u32 v231, s74, v1
buffer_load_dwordx4 v5, s[8:11], s69 offen offset:3072  lds
s_waitcnt vmcnt(6) lgkmcnt(6)
s_barrier
v_mfma_f32_16x16x32_bf16 v[84:87], v[124:127], a[64:67], v[84:87]
s_add_u32 m0, s46, 114688
s_nop 0
buffer_load_dwordx4 v4, s[8:11], s70 offen offset:0  lds
v_mfma_f32_16x16x32_bf16 v[88:91], v[124:127], a[68:71], v[88:91]
ds_read_b64_tr_b16 v[152:153], v19 offset:16384
v_mfma_f32_16x16x32_bf16 v[92:95], v[124:127], a[72:75], v[92:95]
ds_read_b64_tr_b16 v[154:155], v19 offset:18432
v_mfma_f32_16x16x32_bf16 v[96:99], v[124:127], a[76:79], v[96:99]
v_mfma_f32_16x16x32_bf16 v[104:107], a[64:67], v[128:131], v[104:107]
buffer_load_dwordx4 v5, s[8:11], s70 offen offset:1024  lds
s_add_u32 m0, s46, 121856
v_mfma_f32_16x16x32_bf16 v[108:111], a[68:71], v[128:131], v[108:111]
ds_read_b64_tr_b16 v[156:157], v19 offset:24576
v_mfma_f32_16x16x32_bf16 v[112:115], a[72:75], v[128:131], v[112:115]
ds_read_b64_tr_b16 v[158:159], v19 offset:26624
v_mfma_f32_16x16x32_bf16 v[116:119], a[76:79], v[128:131], v[116:119]
v_mfma_f32_16x16x32_bf16 v[64:67], v[120:123], a[64:67], v[64:67]
buffer_load_dwordx4 v4, s[8:11], s70 offen offset:1024  lds
v_mfma_f32_16x16x32_bf16 v[68:71], v[120:123], a[68:71], v[68:71]
ds_read_b64_tr_b16 v[160:161], v18 offset:57344
v_mfma_f32_16x16x32_bf16 v[72:75], v[120:123], a[72:75], v[72:75]
ds_read_b64_tr_b16 v[162:163], v18 offset:59392
v_mfma_f32_16x16x32_bf16 v[76:79], v[120:123], a[76:79], v[76:79]
s_waitcnt lgkmcnt(6)
v_mfma_f32_16x16x32_bf16 v[84:87], v[136:139], a[80:83], v[84:87]
buffer_load_dwordx4 v5, s[8:11], s70 offen offset:2048  lds
s_add_u32 m0, s46, 30720
v_mfma_f32_16x16x32_bf16 v[88:91], v[136:139], a[84:87], v[88:91]
ds_read_b64_tr_b16 v[164:165], v19 offset:20480
v_mfma_f32_16x16x32_bf16 v[92:95], v[136:139], a[88:91], v[92:95]
ds_read_b64_tr_b16 v[166:167], v19 offset:22528
v_mfma_f32_16x16x32_bf16 v[96:99], v[136:139], a[92:95], v[96:99]
v_mfma_f32_16x16x32_bf16 v[104:107], a[80:83], v[140:143], v[104:107]
buffer_load_dwordx4 v4, s[8:11], s70 offen offset:2048  lds
v_mfma_f32_16x16x32_bf16 v[108:111], a[84:87], v[140:143], v[108:111]
ds_read_b64_tr_b16 v[168:169], v19 offset:28672
v_mfma_f32_16x16x32_bf16 v[112:115], a[88:91], v[140:143], v[112:115]
ds_read_b64_tr_b16 v[170:171], v19 offset:30720
v_mfma_f32_16x16x32_bf16 v[116:119], a[92:95], v[140:143], v[116:119]
v_mfma_f32_16x16x32_bf16 v[64:67], v[132:135], a[80:83], v[64:67]
buffer_load_dwordx4 v5, s[8:11], s70 offen offset:3072  lds
s_add_u32 m0, s46, 131072
buffer_load_dwordx4 v[232:235], v223, s[24:27], s86 offen sc1
v_mfma_f32_16x16x32_bf16 v[68:71], v[132:135], a[84:87], v[68:71]
ds_read_b64_tr_b16 v[172:173], v18 offset:61440
buffer_load_dwordx4 v[236:239], v223, s[24:27], s87 offen sc1
v_mfma_f32_16x16x32_bf16 v[72:75], v[132:135], a[88:91], v[72:75]
ds_read_b64_tr_b16 v[174:175], v18 offset:63488
v_mfma_f32_16x16x32_bf16 v[76:79], v[132:135], a[92:95], v[76:79]
s_waitcnt lgkmcnt(6)
v_mfma_f32_16x16x32_bf16 v[84:87], v[156:159], a[96:99], v[84:87]
ds_read_b64_tr_b16 v[120:121], v18 offset:16384
v_mfma_f32_16x16x32_bf16 v[88:91], v[156:159], a[100:103], v[88:91]
v_mfma_f32_16x16x32_bf16 v[92:95], v[156:159], a[104:107], v[92:95]
ds_read_b64_tr_b16 v[122:123], v18 offset:18432
v_mfma_f32_16x16x32_bf16 v[96:99], v[156:159], a[108:111], v[96:99]
v_mfma_f32_16x16x32_bf16 v[104:107], a[96:99], v[160:163], v[104:107]
ds_read_b64_tr_b16 v[124:125], v19 offset:32768
v_mfma_f32_16x16x32_bf16 v[108:111], a[100:103], v[160:163], v[108:111]
buffer_load_dwordx4 v4, s[8:11], s71 offen offset:0  lds
v_mfma_f32_16x16x32_bf16 v[112:115], a[104:107], v[160:163], v[112:115]
ds_read_b64_tr_b16 v[126:127], v19 offset:34816
v_mfma_f32_16x16x32_bf16 v[116:119], a[108:111], v[160:163], v[116:119]
v_mfma_f32_16x16x32_bf16 v[64:67], v[152:155], a[96:99], v[64:67]
ds_read_b64_tr_b16 v[128:129], v19 offset:0
v_mfma_f32_16x16x32_bf16 v[68:71], v[152:155], a[100:103], v[68:71]
buffer_load_dwordx4 v5, s[8:11], s71 offen offset:1024  lds
s_add_u32 m0, s46, 138240
v_mfma_f32_16x16x32_bf16 v[72:75], v[152:155], a[104:107], v[72:75]
ds_read_b64_tr_b16 v[130:131], v19 offset:2048
v_mfma_f32_16x16x32_bf16 v[76:79], v[152:155], a[108:111], v[76:79]
s_waitcnt lgkmcnt(6)
v_mfma_f32_16x16x32_bf16 v[84:87], v[168:171], a[112:115], v[84:87]
ds_read_b64_tr_b16 v[132:133], v18 offset:20480
v_mfma_f32_16x16x32_bf16 v[88:91], v[168:171], a[116:119], v[88:91]
v_mfma_f32_16x16x32_bf16 v[92:95], v[168:171], a[120:123], v[92:95]
buffer_load_dwordx4 v4, s[8:11], s71 offen offset:1024  lds
v_mfma_f32_16x16x32_bf16 v[96:99], v[168:171], a[124:127], v[96:99]
ds_read_b64_tr_b16 v[134:135], v18 offset:22528
v_mfma_f32_16x16x32_bf16 v[104:107], a[112:115], v[172:175], v[104:107]
ds_read_b64_tr_b16 v[136:137], v19 offset:36864
v_mfma_f32_16x16x32_bf16 v[108:111], a[116:119], v[172:175], v[108:111]
v_mfma_f32_16x16x32_bf16 v[112:115], a[120:123], v[172:175], v[112:115]
buffer_load_dwordx4 v5, s[8:11], s71 offen offset:2048  lds
s_add_u32 m0, s46, 38912
v_mfma_f32_16x16x32_bf16 v[116:119], a[124:127], v[172:175], v[116:119]
ds_read_b64_tr_b16 v[138:139], v19 offset:38912
v_mfma_f32_16x16x32_bf16 v[64:67], v[164:167], a[112:115], v[64:67]
ds_read_b64_tr_b16 v[140:141], v19 offset:4096
v_mfma_f32_16x16x32_bf16 v[68:71], v[164:167], a[116:119], v[68:71]
v_mfma_f32_16x16x32_bf16 v[72:75], v[164:167], a[120:123], v[72:75]
buffer_load_dwordx4 v4, s[8:11], s71 offen offset:2048  lds
v_mfma_f32_16x16x32_bf16 v[76:79], v[164:167], a[124:127], v[76:79]
ds_read_b64_tr_b16 v[142:143], v19 offset:6144
buffer_load_dwordx4 v5, s[8:11], s71 offen offset:3072  lds
s_waitcnt vmcnt(8) lgkmcnt(6)
s_barrier
v_mfma_f32_16x16x32_bf16 v[84:87], v[124:127], a[128:131], v[84:87]
ds_read_b64_tr_b16 v[152:153], v19 offset:40960
v_mfma_f32_16x16x32_bf16 v[88:91], v[124:127], a[132:135], v[88:91]
v_mfma_f32_16x16x32_bf16 v[92:95], v[124:127], a[136:139], v[92:95]
s_add_u32 m0, s46, 147456
s_nop 0
buffer_load_dwordx4 v2, s[12:15], s48 offen offset:0  lds
v_mfma_f32_16x16x32_bf16 v[96:99], v[124:127], a[140:143], v[96:99]
ds_read_b64_tr_b16 v[154:155], v19 offset:43008
v_mfma_f32_16x16x32_bf16 v[104:107], a[128:131], v[128:131], v[104:107]
ds_read_b64_tr_b16 v[156:157], v18 offset:24576
v_mfma_f32_16x16x32_bf16 v[108:111], a[132:135], v[128:131], v[108:111]
v_mfma_f32_16x16x32_bf16 v[112:115], a[136:139], v[128:131], v[112:115]
buffer_load_dwordx4 v3, s[12:15], s48 offen offset:1024  lds
s_add_u32 m0, s46, 155648
v_mfma_f32_16x16x32_bf16 v[116:119], a[140:143], v[128:131], v[116:119]
ds_read_b64_tr_b16 v[158:159], v18 offset:26624
v_mfma_f32_16x16x32_bf16 v[64:67], v[120:123], a[128:131], v[64:67]
ds_read_b64_tr_b16 v[160:161], v19 offset:8192
s_waitcnt vmcnt(9)
v_xor_b32 v240, s45, v234
s_waitcnt vmcnt(8)
v_xor_b32 v241, s45, v239
v_or_b32 v240, v240, v241
v_cmp_ne_u32 vcc, 0, v240
s_nop 0
s_cbranch_vccnz L_st_1
L_stb_2:
v_mfma_f32_16x16x32_bf16 v[68:71], v[120:123], a[132:135], v[68:71]
buffer_load_dwordx4 v2, s[12:15], s56 offen offset:0  lds
v_add_f32 v232, v232, v236
v_add_f32 v233, v233, v237
v_mov_b32 v234, v232
v_mov_b32 v235, v233
v_mfma_f32_16x16x32_bf16 v[72:75], v[120:123], a[136:139], v[72:75]
ds_read_b64_tr_b16 v[162:163], v19 offset:10240
v_permlane16_swap_b32 v232, v234
v_permlane16_swap_b32 v233, v235
v_add_f32 v232, v232, v234
v_mfma_f32_16x16x32_bf16 v[76:79], v[120:123], a[140:143], v[76:79]
v_add_f32 v233, v233, v235
v_mov_b32 v234, v232
v_mov_b32 v235, v233
s_nop 0
v_permlane32_swap_b32 v232, v234
s_waitcnt lgkmcnt(6)
v_mfma_f32_16x16x32_bf16 v[84:87], v[136:139], a[144:147], v[84:87]
buffer_load_dwordx4 v3, s[12:15], s56 offen offset:1024  lds
s_add_u32 m0, s46, 49152
v_permlane32_swap_b32 v233, v235
v_add_f32 v232, v232, v234
v_mfma_f32_16x16x32_bf16 v[88:91], v[136:139], a[148:151], v[88:91]
ds_read_b64_tr_b16 v[164:165], v19 offset:45056
v_add_f32 v233, v233, v235
v_mul_f32 v232, 0x3a924925, v232
v_mul_f32 v233, 0x3a924925, v233
v_fma_f32 v233, -v232, v232, v233
v_max_f32 v233, 0, v233
v_mfma_f32_16x16x32_bf16 v[92:95], v[136:139], a[152:155], v[92:95]
buffer_load_dwordx4 v2, s[12:15], s49 offen offset:0  lds
v_add_f32 v233, v233, v245
v_rsq_f32 v234, v233
s_lshl_b32 s87, s41, 12
v_mfma_f32_16x16x32_bf16 v[96:99], v[136:139], a[156:159], v[96:99]
ds_read_b64_tr_b16 v[166:167], v19 offset:47104
v_mul_f32 v235, -v232, v234
ds_write_b64 v220, v[234:235]
s_add_u32 s87, s87, s3
s_lshl_b32 s86, s41, 5
s_add_u32 s86, s86, s89
v_mfma_f32_16x16x32_bf16 v[104:107], a[144:147], v[140:143], v[104:107]
buffer_load_dwordx4 v3, s[12:15], s49 offen offset:1024  lds
s_add_u32 m0, s46, 81920
v_mfma_f32_16x16x32_bf16 v[108:111], a[148:151], v[140:143], v[108:111]
ds_read_b64_tr_b16 v[168:169], v18 offset:28672
s_waitcnt lgkmcnt(0)
s_barrier
ds_read_b64 v[232:233], v221 offset:2560
ds_read_b64 v[234:235], v221 offset:2688
ds_read_b64 v[236:237], v221 offset:2816
ds_read_b64 v[238:239], v221 offset:2944
v_mfma_f32_16x16x32_bf16 v[112:115], a[152:155], v[140:143], v[112:115]
buffer_load_dwordx4 v2, s[12:15], s57 offen offset:0  lds
v_mfma_f32_16x16x32_bf16 v[116:119], a[156:159], v[140:143], v[116:119]
ds_read_b64_tr_b16 v[170:171], v18 offset:30720
v_mfma_f32_16x16x32_bf16 v[64:67], v[132:135], a[144:147], v[64:67]
ds_read_b64_tr_b16 v[172:173], v19 offset:12288
v_mfma_f32_16x16x32_bf16 v[68:71], v[132:135], a[148:151], v[68:71]
v_mfma_f32_16x16x32_bf16 v[72:75], v[132:135], a[152:155], v[72:75]
buffer_load_dwordx4 v3, s[12:15], s57 offen offset:1024  lds
s_add_u32 m0, s46, 90112
s_waitcnt lgkmcnt(5)
v_fma_f32 v32, v32, v232, v233
v_fma_f32 v33, v33, v232, v233
v_fma_f32 v34, v34, v232, v233
v_mfma_f32_16x16x32_bf16 v[76:79], v[132:135], a[156:159], v[76:79]
ds_read_b64_tr_b16 v[174:175], v19 offset:14336
v_fma_f32 v35, v35, v232, v233
v_fma_f32 v36, v36, v232, v233
v_fma_f32 v37, v37, v232, v233
v_fma_f32 v38, v38, v232, v233
v_mfma_f32_16x16x32_bf16 v[84:87], v[156:159], a[160:163], v[84:87]
ds_read_b64_tr_b16 v[120:121], v19 offset:49152
v_fma_f32 v39, v39, v232, v233
v_cvt_pk_bf16_f32 v32, v32, v33
v_cvt_pk_bf16_f32 v33, v34, v35
v_cvt_pk_bf16_f32 v34, v36, v37
v_cvt_pk_bf16_f32 v35, v38, v39
v_mfma_f32_16x16x32_bf16 v[88:91], v[156:159], a[164:167], v[88:91]
ds_write_b128 v242, v[32:35] offset:0
s_waitcnt lgkmcnt(7)
v_fma_f32 v40, v40, v234, v235
v_fma_f32 v41, v41, v234, v235
v_fma_f32 v42, v42, v234, v235
v_fma_f32 v43, v43, v234, v235
v_fma_f32 v44, v44, v234, v235
v_mfma_f32_16x16x32_bf16 v[92:95], v[156:159], a[168:171], v[92:95]
ds_read_b64_tr_b16 v[122:123], v19 offset:51200
v_fma_f32 v45, v45, v234, v235
v_fma_f32 v46, v46, v234, v235
v_fma_f32 v47, v47, v234, v235
v_cvt_pk_bf16_f32 v40, v40, v41
v_cvt_pk_bf16_f32 v41, v42, v43
v_mfma_f32_16x16x32_bf16 v[96:99], v[156:159], a[172:175], v[96:99]
v_cvt_pk_bf16_f32 v42, v44, v45
v_cvt_pk_bf16_f32 v43, v46, v47
ds_write_b128 v242, v[40:43] offset:1024
ds_read_b64_tr_b16 v[36:37], v243 offset:0
ds_read_b64_tr_b16 v[38:39], v244 offset:0
ds_read_b64_tr_b16 v[44:45], v243 offset:8
v_mfma_f32_16x16x32_bf16 v[104:107], a[160:163], v[160:163], v[104:107]
ds_read_b64_tr_b16 v[124:125], v19 offset:57344
ds_read_b64_tr_b16 v[46:47], v244 offset:8
s_waitcnt lgkmcnt(13)
v_fma_f32 v48, v48, v236, v237
v_fma_f32 v49, v49, v236, v237
v_fma_f32 v50, v50, v236, v237
v_fma_f32 v51, v51, v236, v237
v_mfma_f32_16x16x32_bf16 v[108:111], a[164:167], v[160:163], v[108:111]
v_fma_f32 v52, v52, v236, v237
v_fma_f32 v53, v53, v236, v237
v_fma_f32 v54, v54, v236, v237
v_fma_f32 v55, v55, v236, v237
v_cvt_pk_bf16_f32 v48, v48, v49
v_cvt_pk_bf16_f32 v49, v50, v51
v_mfma_f32_16x16x32_bf16 v[112:115], a[168:171], v[160:163], v[112:115]
ds_read_b64_tr_b16 v[126:127], v19 offset:59392
v_cvt_pk_bf16_f32 v50, v52, v53
v_cvt_pk_bf16_f32 v51, v54, v55
ds_write_b128 v242, v[48:51] offset:0
s_waitcnt lgkmcnt(5)
buffer_store_dwordx4 v[36:39], v1, s[24:27], s87 offen offset:0 sc1
v_mfma_f32_16x16x32_bf16 v[116:119], a[172:175], v[160:163], v[116:119]
s_waitcnt lgkmcnt(2)
buffer_store_dwordx4 v[44:47], v1, s[24:27], s87 offen offset:1024 sc1
v_fma_f32 v56, v56, v238, v239
v_fma_f32 v57, v57, v238, v239
v_fma_f32 v58, v58, v238, v239
v_fma_f32 v59, v59, v238, v239
v_mfma_f32_16x16x32_bf16 v[64:67], v[152:155], a[160:163], v[64:67]
ds_read_b64_tr_b16 v[128:129], v18 offset:32768
v_fma_f32 v60, v60, v238, v239
v_fma_f32 v61, v61, v238, v239
v_fma_f32 v62, v62, v238, v239
v_fma_f32 v63, v63, v238, v239
v_cvt_pk_bf16_f32 v56, v56, v57
v_mfma_f32_16x16x32_bf16 v[68:71], v[152:155], a[164:167], v[68:71]
buffer_load_dwordx4 v2, s[12:15], s50 offen offset:0  lds
v_cvt_pk_bf16_f32 v57, v58, v59
v_cvt_pk_bf16_f32 v58, v60, v61
v_cvt_pk_bf16_f32 v59, v62, v63
ds_write_b128 v242, v[56:59] offset:1024
v_mfma_f32_16x16x32_bf16 v[72:75], v[152:155], a[168:171], v[72:75]
ds_read_b64_tr_b16 v[130:131], v18 offset:34816
ds_read_b64_tr_b16 v[52:53], v243 offset:0
ds_read_b64_tr_b16 v[54:55], v244 offset:0
ds_read_b64_tr_b16 v[60:61], v243 offset:8
ds_read_b64_tr_b16 v[62:63], v244 offset:8
v_mfma_f32_16x16x32_bf16 v[76:79], v[152:155], a[172:175], v[76:79]
v_mfma_f32_16x16x32_bf16 v[84:87], v[168:171], a[176:179], v[84:87]
ds_read_b64_tr_b16 v[132:133], v19 offset:53248
v_mfma_f32_16x16x32_bf16 v[88:91], v[168:171], a[180:183], v[88:91]
buffer_load_dwordx4 v3, s[12:15], s50 offen offset:1024  lds
s_add_u32 m0, s46, 57344
v_mfma_f32_16x16x32_bf16 v[92:95], v[168:171], a[184:187], v[92:95]
ds_read_b64_tr_b16 v[134:135], v19 offset:55296
v_mfma_f32_16x16x32_bf16 v[96:99], v[168:171], a[188:191], v[96:99]
v_mfma_f32_16x16x32_bf16 v[104:107], a[176:179], v[172:175], v[104:107]
ds_read_b64_tr_b16 v[136:137], v19 offset:61440
s_waitcnt lgkmcnt(5)
buffer_store_dwordx4 v[52:55], v1, s[24:27], s87 offen offset:2048 sc1
s_waitcnt lgkmcnt(3)
buffer_store_dwordx4 v[60:63], v1, s[24:27], s87 offen offset:3072 sc1
v_mfma_f32_16x16x32_bf16 v[108:111], a[180:183], v[172:175], v[108:111]
v_mfma_f32_16x16x32_bf16 v[112:115], a[184:187], v[172:175], v[112:115]
ds_read_b64_tr_b16 v[138:139], v19 offset:63488
v_mfma_f32_16x16x32_bf16 v[116:119], a[188:191], v[172:175], v[116:119]
v_mfma_f32_16x16x32_bf16 v[64:67], v[164:167], a[176:179], v[64:67]
ds_read_b64_tr_b16 v[140:141], v18 offset:36864
v_mfma_f32_16x16x32_bf16 v[68:71], v[164:167], a[180:183], v[68:71]
buffer_load_dwordx4 v2, s[12:15], s58 offen offset:0  lds
v_mfma_f32_16x16x32_bf16 v[72:75], v[164:167], a[184:187], v[72:75]
ds_read_b64_tr_b16 v[142:143], v18 offset:38912
v_mfma_f32_16x16x32_bf16 v[76:79], v[164:167], a[188:191], v[76:79]
s_waitcnt vmcnt(11)
s_barrier
v_mfma_f32_16x16x32_bf16 v[84:87], v[124:127], a[192:195], v[84:87]
buffer_load_dwordx4 v3, s[12:15], s58 offen offset:1024  lds
s_add_u32 m0, s46, 16384
v_mfma_f32_16x16x32_bf16 v[88:91], v[124:127], a[196:199], v[88:91]
ds_read_b64_tr_b16 v[152:153], v20 offset:0
v_mfma_f32_16x16x32_bf16 v[92:95], v[124:127], a[200:203], v[92:95]
ds_read_b64_tr_b16 v[154:155], v20 offset:2048
v_mfma_f32_16x16x32_bf16 v[96:99], v[124:127], a[204:207], v[96:99]
v_mfma_f32_16x16x32_bf16 v[104:107], a[192:195], v[128:131], v[104:107]
ds_read_b64_tr_b16 v[156:157], v20 offset:8192
v_mfma_f32_16x16x32_bf16 v[108:111], a[196:199], v[128:131], v[108:111]
v_mfma_f32_16x16x32_bf16 v[112:115], a[200:203], v[128:131], v[112:115]
ds_read_b64_tr_b16 v[158:159], v20 offset:10240
v_mfma_f32_16x16x32_bf16 v[116:119], a[204:207], v[128:131], v[116:119]
v_mfma_f32_16x16x32_bf16 v[64:67], v[120:123], a[192:195], v[64:67]
ds_read_b64_tr_b16 v[160:161], v18 offset:40960
v_mfma_f32_16x16x32_bf16 v[68:71], v[120:123], a[196:199], v[68:71]
v_mfma_f32_16x16x32_bf16 v[72:75], v[120:123], a[200:203], v[72:75]
ds_read_b64_tr_b16 v[162:163], v18 offset:43008
v_mfma_f32_16x16x32_bf16 v[76:79], v[120:123], a[204:207], v[76:79]
s_waitcnt lgkmcnt(6)
v_mfma_f32_16x16x32_bf16 v[84:87], v[136:139], a[208:211], v[84:87]
ds_read_b64_tr_b16 v[164:165], v20 offset:4096
v_mfma_f32_16x16x32_bf16 v[88:91], v[136:139], a[212:215], v[88:91]
v_mfma_f32_16x16x32_bf16 v[92:95], v[136:139], a[216:219], v[92:95]
ds_read_b64_tr_b16 v[166:167], v20 offset:6144
v_mfma_f32_16x16x32_bf16 v[96:99], v[136:139], a[220:223], v[96:99]
v_mfma_f32_16x16x32_bf16 v[104:107], a[208:211], v[140:143], v[104:107]
ds_read_b64_tr_b16 v[168:169], v20 offset:12288
v_mfma_f32_16x16x32_bf16 v[108:111], a[212:215], v[140:143], v[108:111]
buffer_load_dwordx4 v2, s[12:15], s51 offen offset:0  lds
v_mfma_f32_16x16x32_bf16 v[112:115], a[216:219], v[140:143], v[112:115]
ds_read_b64_tr_b16 v[170:171], v20 offset:14336
v_mfma_f32_16x16x32_bf16 v[116:119], a[220:223], v[140:143], v[116:119]
v_mfma_f32_16x16x32_bf16 v[64:67], v[132:135], a[208:211], v[64:67]
ds_read_b64_tr_b16 v[172:173], v18 offset:45056
v_mfma_f32_16x16x32_bf16 v[68:71], v[132:135], a[212:215], v[68:71]
v_mfma_f32_16x16x32_bf16 v[72:75], v[132:135], a[216:219], v[72:75]
ds_read_b64_tr_b16 v[174:175], v18 offset:47104
v_mfma_f32_16x16x32_bf16 v[76:79], v[132:135], a[220:223], v[76:79]
s_waitcnt lgkmcnt(6)
v_mfma_f32_16x16x32_bf16 v[84:87], v[156:159], a[224:227], v[84:87]
ds_read_b64_tr_b16 v[120:121], v16 offset:16384
v_mfma_f32_16x16x32_bf16 v[88:91], v[156:159], a[228:231], v[88:91]
v_mfma_f32_16x16x32_bf16 v[92:95], v[156:159], a[232:235], v[92:95]
v_mfma_f32_16x16x32_bf16 v[96:99], v[156:159], a[236:239], v[96:99]
ds_read_b64_tr_b16 v[122:123], v16 offset:18432
v_mfma_f32_16x16x32_bf16 v[104:107], a[224:227], v[160:163], v[104:107]
v_mfma_f32_16x16x32_bf16 v[108:111], a[228:231], v[160:163], v[108:111]
v_mfma_f32_16x16x32_bf16 v[112:115], a[232:235], v[160:163], v[112:115]
ds_read_b64_tr_b16 v[124:125], v17 offset:16384
v_mfma_f32_16x16x32_bf16 v[116:119], a[236:239], v[160:163], v[116:119]
v_mfma_f32_16x16x32_bf16 v[64:67], v[152:155], a[224:227], v[64:67]
v_mfma_f32_16x16x32_bf16 v[68:71], v[152:155], a[228:231], v[68:71]
ds_read_b64_tr_b16 v[126:127], v17 offset:18432
v_mfma_f32_16x16x32_bf16 v[72:75], v[152:155], a[232:235], v[72:75]
buffer_load_dwordx4 v3, s[12:15], s51 offen offset:1024  lds
s_add_u32 m0, s46, 98304
v_mfma_f32_16x16x32_bf16 v[76:79], v[152:155], a[236:239], v[76:79]
s_waitcnt lgkmcnt(4)
v_mfma_f32_16x16x32_bf16 v[84:87], v[168:171], a[240:243], v[84:87]
ds_read_b64_tr_b16 v[128:129], v16 offset:24576
v_mfma_f32_16x16x32_bf16 v[88:91], v[168:171], a[244:247], v[88:91]
s_waitcnt vmcnt(4)
buffer_store_dword v250, v247, s[24:27], s86 offen sc1
v_mfma_f32_16x16x32_bf16 v[92:95], v[168:171], a[248:251], v[92:95]
v_mfma_f32_16x16x32_bf16 v[96:99], v[168:171], a[252:255], v[96:99]
ds_read_b64_tr_b16 v[130:131], v16 offset:26624
v_mfma_f32_16x16x32_bf16 v[104:107], a[240:243], v[172:175], v[104:107]
v_mfma_f32_16x16x32_bf16 v[108:111], a[244:247], v[172:175], v[108:111]
buffer_load_dwordx4 v2, s[12:15], s59 offen offset:0  lds
v_mfma_f32_16x16x32_bf16 v[112:115], a[248:251], v[172:175], v[112:115]
ds_read_b64_tr_b16 v[132:133], v17 offset:24576
v_mfma_f32_16x16x32_bf16 v[116:119], a[252:255], v[172:175], v[116:119]
v_mfma_f32_16x16x32_bf16 v[64:67], v[164:167], a[240:243], v[64:67]
v_mfma_f32_16x16x32_bf16 v[68:71], v[164:167], a[244:247], v[68:71]
buffer_load_dwordx4 v3, s[12:15], s59 offen offset:1024  lds
s_add_u32 m0, s46, 65536
v_mfma_f32_16x16x32_bf16 v[72:75], v[164:167], a[248:251], v[72:75]
ds_read_b64_tr_b16 v[134:135], v17 offset:26624
v_mfma_f32_16x16x32_bf16 v[76:79], v[164:167], a[252:255], v[76:79]
s_waitcnt vmcnt(5) lgkmcnt(4)
s_barrier
v_mfma_f32_16x16x32_bf16 v[184:187], v[120:123], a[0:3], 0
buffer_load_dwordx4 v2, s[12:15], s52 offen offset:0  lds
v_lshrrev_b32 v248, 1, v224
v_xor_b32 v248, v248, v225
v_lshlrev_b32 v248, 4, v248
v_lshl_add_u32 v220, v224, 7, v248
v_mfma_f32_16x16x32_bf16 v[192:195], v[120:123], a[4:7], 0
ds_read_b64_tr_b16 v[136:137], v12 offset:49152
ds_read_b128 v[80:83], v230 offset:256
v_mul_f32 v96, v25, v96
v_mul_f32 v97, v25, v97
v_mul_f32 v98, v25, v98
v_mul_f32 v99, v25, v99
v_mfma_f32_16x16x32_bf16 v[200:203], v[120:123], a[8:11], 0
buffer_load_dwordx4 v3, s[12:15], s52 offen offset:1024  lds
s_add_u32 m0, s46, 106496
v_cvt_pk_bf16_f32 v100, v96, v97
v_cvt_pk_bf16_f32 v101, v98, v99
v_mov_b32 v102, s45
v_mfma_f32_16x16x32_bf16 v[208:211], v[120:123], a[12:15], 0
ds_read_b64_tr_b16 v[138:139], v12 offset:51200
s_waitcnt lgkmcnt(1)
v_mul_f32 v116, v80, v116
v_mul_f32 v117, v81, v117
v_mul_f32 v118, v82, v118
v_mul_f32 v119, v83, v119
v_xor_b32 v221, 64, v220
v_mfma_f32_16x16x32_bf16 v[188:191], v[124:127], a[0:3], 0
buffer_load_dwordx4 v2, s[12:15], s60 offen offset:0  lds
buffer_store_dwordx4 v[100:103], v1, s[24:27], s77 offen sc1
v_cvt_pk_bf16_f32 v80, v116, v117
v_cvt_pk_bf16_f32 v81, v118, v119
v_mfma_f32_16x16x32_bf16 v[196:199], v[124:127], a[4:7], 0
ds_read_b64_tr_b16 v[140:141], v13 offset:49152
v_mov_b32 v82, s45
buffer_store_dwordx4 v[80:83], v1, s[24:27], s77 offen offset:1024 sc1
v_add_u32 v222, 65536, v220
v_add_u32 v223, 65536, v221
v_mfma_f32_16x16x32_bf16 v[204:207], v[124:127], a[8:11], 0
ds_read_b64_tr_b16 v[142:143], v13 offset:51200
v_add_u32 v224, 131072, v220
v_add_u32 v225, 131072, v221
s_and_b32 s100, s98, 0xe00
s_lshl_b32 s100, s100, 5
s_add_u32 s100, s100, s3
v_mfma_f32_16x16x32_bf16 v[212:215], v[124:127], a[12:15], 0
v_mfma_f32_16x16x32_bf16 v[184:187], v[128:131], a[16:19], v[184:187]
ds_read_b64_tr_b16 v[144:145], v14 offset:16384
v_mfma_f32_16x16x32_bf16 v[192:195], v[128:131], a[20:23], v[192:195]
v_mfma_f32_16x16x32_bf16 v[200:203], v[128:131], a[24:27], v[200:203]
ds_read_b64_tr_b16 v[146:147], v14 offset:18432
v_mfma_f32_16x16x32_bf16 v[208:211], v[128:131], a[28:31], v[208:211]
v_mfma_f32_16x16x32_bf16 v[188:191], v[132:135], a[16:19], v[188:191]
buffer_load_dwordx4 v3, s[12:15], s60 offen offset:1024  lds
s_add_u32 m0, s46, 24576
v_mfma_f32_16x16x32_bf16 v[196:199], v[132:135], a[20:23], v[196:199]
ds_read_b64_tr_b16 v[148:149], v15 offset:16384
v_mfma_f32_16x16x32_bf16 v[204:207], v[132:135], a[24:27], v[204:207]
ds_read_b64_tr_b16 v[150:151], v15 offset:18432
v_mfma_f32_16x16x32_bf16 v[212:215], v[132:135], a[28:31], v[212:215]
s_waitcnt lgkmcnt(4)
v_mfma_f32_16x16x32_bf16 v[184:187], v[136:139], a[32:35], v[184:187]
buffer_load_dwordx4 v2, s[12:15], s53 offen offset:0  lds
v_mfma_f32_16x16x32_bf16 v[192:195], v[136:139], a[36:39], v[192:195]
ds_read_b64_tr_b16 v[120:121], v14 offset:24576
v_mfma_f32_16x16x32_bf16 v[200:203], v[136:139], a[40:43], v[200:203]
ds_read_b64_tr_b16 v[122:123], v14 offset:26624
v_mfma_f32_16x16x32_bf16 v[208:211], v[136:139], a[44:47], v[208:211]
v_mfma_f32_16x16x32_bf16 v[188:191], v[140:143], a[32:35], v[188:191]
buffer_load_dwordx4 v3, s[12:15], s53 offen offset:1024  lds
s_add_u32 m0, s46, 73728
v_mfma_f32_16x16x32_bf16 v[196:199], v[140:143], a[36:39], v[196:199]
ds_read_b64_tr_b16 v[124:125], v15 offset:24576
v_mfma_f32_16x16x32_bf16 v[204:207], v[140:143], a[40:43], v[204:207]
ds_read_b64_tr_b16 v[126:127], v15 offset:26624
v_mfma_f32_16x16x32_bf16 v[212:215], v[140:143], a[44:47], v[212:215]
s_waitcnt lgkmcnt(4)
v_mfma_f32_16x16x32_bf16 v[184:187], v[144:147], a[48:51], v[184:187]
buffer_load_dwordx4 v2, s[12:15], s61 offen offset:0  lds
v_mfma_f32_16x16x32_bf16 v[192:195], v[144:147], a[52:55], v[192:195]
ds_read_b64_tr_b16 v[128:129], v12 offset:57344
v_mfma_f32_16x16x32_bf16 v[200:203], v[144:147], a[56:59], v[200:203]
ds_read_b64_tr_b16 v[130:131], v12 offset:59392
v_mfma_f32_16x16x32_bf16 v[208:211], v[144:147], a[60:63], v[208:211]
v_mfma_f32_16x16x32_bf16 v[188:191], v[148:151], a[48:51], v[188:191]
ds_read_b64_tr_b16 v[132:133], v13 offset:57344
v_mfma_f32_16x16x32_bf16 v[196:199], v[148:151], a[52:55], v[196:199]
buffer_load_dwordx4 v3, s[12:15], s61 offen offset:1024  lds
s_add_u32 m0, s46, 114688
v_mfma_f32_16x16x32_bf16 v[204:207], v[148:151], a[56:59], v[204:207]
ds_read_b64_tr_b16 v[134:135], v13 offset:59392
v_mfma_f32_16x16x32_bf16 v[212:215], v[148:151], a[60:63], v[212:215]
buffer_load_dwordx4 v2, s[12:15], s54 offen offset:0  lds
buffer_load_dwordx4 v3, s[12:15], s54 offen offset:1024  lds
s_add_u32 m0, s46, 122880
s_nop 0
buffer_load_dwordx4 v2, s[12:15], s62 offen offset:0  lds
buffer_load_dwordx4 v3, s[12:15], s62 offen offset:1024  lds
s_waitcnt vmcnt(8) lgkmcnt(4)
s_barrier
v_mfma_f32_16x16x32_bf16 v[184:187], v[120:123], a[64:67], v[184:187]
ds_read_b64_tr_b16 v[136:137], v12 offset:16384
v_mfma_f32_16x16x32_bf16 v[192:195], v[120:123], a[68:71], v[192:195]
v_mfma_f32_16x16x32_bf16 v[200:203], v[120:123], a[72:75], v[200:203]
s_add_u32 m0, s46, 32768
s_nop 0
buffer_load_dwordx4 v2, s[12:15], s55 offen offset:0  lds
v_mfma_f32_16x16x32_bf16 v[208:211], v[120:123], a[76:79], v[208:211]
ds_read_b64_tr_b16 v[138:139], v12 offset:18432
v_mfma_f32_16x16x32_bf16 v[188:191], v[124:127], a[64:67], v[188:191]
ds_read_b64_tr_b16 v[140:141], v13 offset:16384
v_mfma_f32_16x16x32_bf16 v[196:199], v[124:127], a[68:71], v[196:199]
v_mfma_f32_16x16x32_bf16 v[204:207], v[124:127], a[72:75], v[204:207]
buffer_load_dwordx4 v3, s[12:15], s55 offen offset:1024  lds
s_add_u32 m0, s46, 131072
v_mfma_f32_16x16x32_bf16 v[212:215], v[124:127], a[76:79], v[212:215]
ds_read_b64_tr_b16 v[142:143], v13 offset:18432
s_waitcnt lgkmcnt(4)
v_mfma_f32_16x16x32_bf16 v[184:187], v[128:131], a[80:83], v[184:187]
ds_read_b64_tr_b16 v[144:145], v14 offset:32768
v_mfma_f32_16x16x32_bf16 v[192:195], v[128:131], a[84:87], v[192:195]
v_mfma_f32_16x16x32_bf16 v[200:203], v[128:131], a[88:91], v[200:203]
buffer_load_dwordx4 v2, s[12:15], s63 offen offset:0  lds
v_mfma_f32_16x16x32_bf16 v[208:211], v[128:131], a[92:95], v[208:211]
ds_read_b64_tr_b16 v[146:147], v14 offset:34816
v_mfma_f32_16x16x32_bf16 v[188:191], v[132:135], a[80:83], v[188:191]
ds_read_b64_tr_b16 v[148:149], v15 offset:32768
v_mfma_f32_16x16x32_bf16 v[196:199], v[132:135], a[84:87], v[196:199]
v_mfma_f32_16x16x32_bf16 v[204:207], v[132:135], a[88:91], v[204:207]
ds_read_b64_tr_b16 v[150:151], v15 offset:34816
v_mfma_f32_16x16x32_bf16 v[212:215], v[132:135], a[92:95], v[212:215]
s_waitcnt lgkmcnt(4)
v_mfma_f32_16x16x32_bf16 v[184:187], v[136:139], a[96:99], v[184:187]
buffer_load_dwordx4 v3, s[12:15], s63 offen offset:1024  lds
s_add_u32 m0, s46, 139264
v_mfma_f32_16x16x32_bf16 v[192:195], v[136:139], a[100:103], v[192:195]
ds_read_b64_tr_b16 v[120:121], v14 offset:0
v_mfma_f32_16x16x32_bf16 v[200:203], v[136:139], a[104:107], v[200:203]
ds_read_b64_tr_b16 v[122:123], v14 offset:2048
v_mfma_f32_16x16x32_bf16 v[208:211], v[136:139], a[108:111], v[208:211]
v_mfma_f32_16x16x32_bf16 v[188:191], v[140:143], a[96:99], v[188:191]
s_xor_b32 s99, s98, 262144
buffer_load_dwordx4 v6, s[16:19], s99 offen offset:0  lds
v_mfma_f32_16x16x32_bf16 v[196:199], v[140:143], a[100:103], v[196:199]
ds_read_b64_tr_b16 v[124:125], v15 offset:0
v_mfma_f32_16x16x32_bf16 v[204:207], v[140:143], a[104:107], v[204:207]
ds_read_b64_tr_b16 v[126:127], v15 offset:2048
v_mfma_f32_16x16x32_bf16 v[212:215], v[140:143], a[108:111], v[212:215]
s_waitcnt lgkmcnt(4)
v_mfma_f32_16x16x32_bf16 v[184:187], v[144:147], a[112:115], v[184:187]
buffer_load_dwordx4 v7, s[16:19], s99 offen offset:1024  lds
s_add_u32 m0, s46, 40832
v_mfma_f32_16x16x32_bf16 v[192:195], v[144:147], a[116:119], v[192:195]
ds_read_b64_tr_b16 v[128:129], v14 offset:40960
v_mfma_f32_16x16x32_bf16 v[200:203], v[144:147], a[120:123], v[200:203]
ds_read_b64_tr_b16 v[130:131], v14 offset:43008
v_mfma_f32_16x16x32_bf16 v[208:211], v[144:147], a[124:127], v[208:211]
v_mfma_f32_16x16x32_bf16 v[188:191], v[148:151], a[112:115], v[188:191]
buffer_load_dwordx4 v6, s[16:19], s99 offen offset:128  lds
v_mfma_f32_16x16x32_bf16 v[196:199], v[148:151], a[116:119], v[196:199]
ds_read_b64_tr_b16 v[132:133], v15 offset:40960
v_mfma_f32_16x16x32_bf16 v[204:207], v[148:151], a[120:123], v[204:207]
ds_read_b64_tr_b16 v[134:135], v15 offset:43008
v_mfma_f32_16x16x32_bf16 v[212:215], v[148:151], a[124:127], v[212:215]
s_waitcnt vmcnt(7) lgkmcnt(4)
s_barrier
v_mfma_f32_16x16x32_bf16 v[184:187], v[120:123], a[128:131], v[184:187]
buffer_load_dwordx4 v7, s[16:19], s99 offen offset:1152  lds
s_add_u32 m0, s46, 147200
v_mfma_f32_16x16x32_bf16 v[192:195], v[120:123], a[132:135], v[192:195]
ds_read_b64_tr_b16 v[136:137], v12 offset:24576
v_mfma_f32_16x16x32_bf16 v[200:203], v[120:123], a[136:139], v[200:203]
ds_read_b64_tr_b16 v[138:139], v12 offset:26624
v_mfma_f32_16x16x32_bf16 v[208:211], v[120:123], a[140:143], v[208:211]
v_mfma_f32_16x16x32_bf16 v[188:191], v[124:127], a[128:131], v[188:191]
buffer_load_dwordx4 v6, s[16:19], s99 offen offset:256  lds
v_mfma_f32_16x16x32_bf16 v[196:199], v[124:127], a[132:135], v[196:199]
ds_read_b64_tr_b16 v[140:141], v13 offset:24576
v_mfma_f32_16x16x32_bf16 v[204:207], v[124:127], a[136:139], v[204:207]
ds_read_b64_tr_b16 v[142:143], v13 offset:26624
v_mfma_f32_16x16x32_bf16 v[212:215], v[124:127], a[140:143], v[212:215]
s_waitcnt lgkmcnt(4)
v_mfma_f32_16x16x32_bf16 v[184:187], v[128:131], a[144:147], v[184:187]
buffer_load_dwordx4 v7, s[16:19], s99 offen offset:1280  lds
s_add_u32 m0, s46, 155264
v_mfma_f32_16x16x32_bf16 v[192:195], v[128:131], a[148:151], v[192:195]
ds_read_b64_tr_b16 v[144:145], v14 offset:8192
v_mfma_f32_16x16x32_bf16 v[200:203], v[128:131], a[152:155], v[200:203]
ds_read_b64_tr_b16 v[146:147], v14 offset:10240
v_mfma_f32_16x16x32_bf16 v[208:211], v[128:131], a[156:159], v[208:211]
v_mfma_f32_16x16x32_bf16 v[188:191], v[132:135], a[144:147], v[188:191]
buffer_load_dwordx4 v6, s[16:19], s99 offen offset:384  lds
v_mfma_f32_16x16x32_bf16 v[196:199], v[132:135], a[148:151], v[196:199]
ds_read_b64_tr_b16 v[148:149], v15 offset:8192
v_mfma_f32_16x16x32_bf16 v[204:207], v[132:135], a[152:155], v[204:207]
ds_read_b64_tr_b16 v[150:151], v15 offset:10240
v_mfma_f32_16x16x32_bf16 v[212:215], v[132:135], a[156:159], v[212:215]
s_waitcnt lgkmcnt(4)
v_mfma_f32_16x16x32_bf16 v[184:187], v[136:139], a[160:163], v[184:187]
buffer_load_dwordx4 v7, s[16:19], s99 offen offset:1408  lds
s_add_u32 m0, s46, 49152
v_mfma_f32_16x16x32_bf16 v[192:195], v[136:139], a[164:167], v[192:195]
ds_read_b64_tr_b16 v[120:121], v14 offset:49152
v_mfma_f32_16x16x32_bf16 v[200:203], v[136:139], a[168:171], v[200:203]
ds_read_b64_tr_b16 v[122:123], v14 offset:51200
v_mfma_f32_16x16x32_bf16 v[208:211], v[136:139], a[172:175], v[208:211]
v_mfma_f32_16x16x32_bf16 v[188:191], v[140:143], a[160:163], v[188:191]
ds_read_b64_tr_b16 v[124:125], v15 offset:49152
v_mfma_f32_16x16x32_bf16 v[196:199], v[140:143], a[164:167], v[196:199]
v_mfma_f32_16x16x32_bf16 v[204:207], v[140:143], a[168:171], v[204:207]
ds_read_b64_tr_b16 v[126:127], v15 offset:51200
v_mfma_f32_16x16x32_bf16 v[212:215], v[140:143], a[172:175], v[212:215]
s_waitcnt lgkmcnt(4)
v_mfma_f32_16x16x32_bf16 v[184:187], v[144:147], a[176:179], v[184:187]
ds_read_b64_tr_b16 v[128:129], v14 offset:57344
v_mfma_f32_16x16x32_bf16 v[192:195], v[144:147], a[180:183], v[192:195]
v_mfma_f32_16x16x32_bf16 v[200:203], v[144:147], a[184:187], v[200:203]
ds_read_b64_tr_b16 v[130:131], v14 offset:59392
v_mfma_f32_16x16x32_bf16 v[208:211], v[144:147], a[188:191], v[208:211]
v_mfma_f32_16x16x32_bf16 v[188:191], v[148:151], a[176:179], v[188:191]
ds_read_b64_tr_b16 v[132:133], v15 offset:57344
v_mfma_f32_16x16x32_bf16 v[196:199], v[148:151], a[180:183], v[196:199]
v_mfma_f32_16x16x32_bf16 v[204:207], v[148:151], a[184:187], v[204:207]
ds_read_b64_tr_b16 v[134:135], v15 offset:59392
v_mfma_f32_16x16x32_bf16 v[212:215], v[148:151], a[188:191], v[212:215]
buffer_load_dwordx4 v[56:59], v1, s[24:27], s76 offen sc1
buffer_load_dwordx4 v[60:63], v1, s[24:27], s76 offen offset:1024 sc1
ds_read_b128 v[156:159], v230 offset:64
ds_read_b128 v[160:163], v230 offset:128
ds_read_b128 v[164:167], v230 offset:192
v_mul_f32 v180, 0x3eb8aa3b, v22
v_mul_f32 v181, 0x3eb8aa3b, v23
v_mul_f32 v182, 0x3eb8aa3b, v24
v_mul_f32 v183, 0x3eb8aa3b, v25
v_mov_b32 v172, s96
v_mov_b32 v173, s96
v_mov_b32 v174, s96
buffer_load_dword v219, v218, s[24:27], s89 offen sc1
v_mov_b32 v175, s96
v_mov_b32 v176, s44
v_mov_b32 v177, s44
v_mov_b32 v178, s44
v_mov_b32 v179, s44
v_pk_mul_f32 v[64:65], v[64:65], v[180:181] op_sel_hi:[1,0]
v_pk_mul_f32 v[66:67], v[66:67], v[180:181] op_sel_hi:[1,0]
v_cvt_pk_bf16_f32 v64, v64, v65
v_cvt_pk_bf16_f32 v65, v66, v67
v_pk_mul_f32 v[68:69], v[68:69], v[180:181] op_sel:[0,1] op_sel_hi:[1,1]
v_pk_mul_f32 v[70:71], v[70:71], v[180:181] op_sel:[0,1] op_sel_hi:[1,1]
v_cvt_pk_bf16_f32 v66, v68, v69
v_cvt_pk_bf16_f32 v67, v70, v71
v_pk_mul_f32 v[72:73], v[72:73], v[182:183] op_sel_hi:[1,0]
v_pk_mul_f32 v[74:75], v[74:75], v[182:183] op_sel_hi:[1,0]
v_cvt_pk_bf16_f32 v68, v72, v73
v_cvt_pk_bf16_f32 v69, v74, v75
s_xor_b32 s99, s98, 262656
buffer_load_dwordx4 v6, s[16:19], s99 offen offset:0  lds
v_pk_mul_f32 v[76:77], v[76:77], v[182:183] op_sel:[0,1] op_sel_hi:[1,1]
v_pk_mul_f32 v[78:79], v[78:79], v[182:183] op_sel:[0,1] op_sel_hi:[1,1]
v_cvt_pk_bf16_f32 v70, v76, v77
v_cvt_pk_bf16_f32 v71, v78, v79
v_pk_mul_f32 v[84:85], v[84:85], v[22:23] op_sel_hi:[1,0]
v_pk_mul_f32 v[86:87], v[86:87], v[22:23] op_sel_hi:[1,0]
v_cvt_pk_bf16_f32 v82, v84, v85
v_cvt_pk_bf16_f32 v83, v86, v87
v_pk_mul_f32 v[88:89], v[88:89], v[22:23] op_sel:[0,1] op_sel_hi:[1,1]
v_pk_mul_f32 v[90:91], v[90:91], v[22:23] op_sel:[0,1] op_sel_hi:[1,1]
v_cvt_pk_bf16_f32 v84, v88, v89
v_cvt_pk_bf16_f32 v85, v90, v91
v_pk_mul_f32 v[92:93], v[92:93], v[24:25] op_sel_hi:[1,0]
v_pk_mul_f32 v[94:95], v[94:95], v[24:25] op_sel_hi:[1,0]
buffer_load_dwordx4 v7, s[16:19], s99 offen offset:1024  lds
s_add_u32 m0, s46, 81792
v_cvt_pk_bf16_f32 v86, v92, v93
v_cvt_pk_bf16_f32 v87, v94, v95
v_cvt_pk_bf16_f32 v88, v96, v97
v_cvt_pk_bf16_f32 v89, v98, v99
s_waitcnt lgkmcnt(2)
v_pk_mul_f32 v[104:105], v[104:105], v[156:157]
v_pk_mul_f32 v[106:107], v[106:107], v[158:159]
v_cvt_pk_bf16_f32 v102, v104, v105
v_cvt_pk_bf16_f32 v103, v106, v107
s_waitcnt lgkmcnt(1)
v_pk_mul_f32 v[108:109], v[108:109], v[160:161]
v_pk_mul_f32 v[110:111], v[110:111], v[162:163]
v_cvt_pk_bf16_f32 v104, v108, v109
v_cvt_pk_bf16_f32 v105, v110, v111
s_waitcnt lgkmcnt(0)
v_pk_mul_f32 v[112:113], v[112:113], v[164:165]
v_pk_mul_f32 v[114:115], v[114:115], v[166:167]
v_cvt_pk_bf16_f32 v106, v112, v113
buffer_load_dwordx4 v6, s[16:19], s99 offen offset:128  lds
v_cvt_pk_bf16_f32 v107, v114, v115
v_cvt_pk_bf16_f32 v108, v116, v117
v_cvt_pk_bf16_f32 v109, v118, v119
v_mfma_f32_16x16x16_bf16 v[156:159], v[82:83], v[64:65], 0
v_mfma_f32_16x16x16_bf16 v[160:163], v[82:83], v[66:67], 0
v_mfma_f32_16x16x16_bf16 v[164:167], v[84:85], v[66:67], 0
v_mfma_f32_16x16x16_bf16 v[168:171], v[84:85], v[68:69], 0
v_mfma_f32_16x16x16_bf16 v[72:75], v[86:87], v[68:69], 0
buffer_load_dwordx4 v7, s[16:19], s99 offen offset:1152  lds
s_add_u32 m0, s46, 89856
v_mfma_f32_16x16x16_bf16 v[76:79], v[86:87], v[70:71], 0
v_mfma_f32_16x16x16_bf16 v[92:95], v[88:89], v[70:71], 0
s_nop 1
v_cndmask_b32 v164, v164, v165, s[80:81]
v_cndmask_b32 v166, v166, v167, s[80:81]
v_cndmask_b32 v160, v160, v161, s[80:81]
v_cndmask_b32 v162, v162, v163, s[80:81]
v_cndmask_b32 v164, v160, v164, s[82:83]
v_cndmask_b32 v165, v162, v166, s[84:85]
v_max_f32 v166, v164, v165
v_cndmask_b32 v72, v72, v73, s[80:81]
buffer_load_dwordx4 v6, s[16:19], s99 offen offset:256  lds
v_cndmask_b32 v74, v74, v75, s[80:81]
v_cndmask_b32 v168, v168, v169, s[80:81]
v_cndmask_b32 v170, v170, v171, s[80:81]
v_cndmask_b32 v72, v168, v72, s[82:83]
v_cndmask_b32 v73, v170, v74, s[84:85]
v_max_f32 v74, v72, v73
v_cndmask_b32 v92, v92, v93, s[80:81]
v_cndmask_b32 v94, v94, v95, s[80:81]
v_cndmask_b32 v76, v76, v77, s[80:81]
v_cndmask_b32 v78, v78, v79, s[80:81]
v_cndmask_b32 v92, v76, v92, s[82:83]
v_cndmask_b32 v93, v78, v94, s[84:85]
buffer_load_dwordx4 v7, s[16:19], s99 offen offset:1280  lds
s_add_u32 m0, s46, 56960
v_max_f32 v94, v92, v93
v_mov_b32 v167, v166
v_mov_b32 v75, v74
v_mov_b32 v95, v94
v_permlane16_swap_b32 v166, v167
v_permlane16_swap_b32 v74, v75
v_permlane16_swap_b32 v94, v95
v_max_f32 v166, v166, v167
v_max_f32 v74, v74, v75
v_max_f32 v94, v94, v95
buffer_load_dwordx4 v6, s[16:19], s99 offen offset:384  lds
v_mov_b32 v167, v166
v_mov_b32 v75, v74
v_mov_b32 v95, v94
v_permlane32_swap_b32 v166, v167
v_permlane32_swap_b32 v74, v75
v_permlane32_swap_b32 v94, v95
v_max_f32 v166, v166, v167
v_max_f32 v74, v74, v75
v_max_f32 v94, v94, v95
v_sub_f32 v164, v164, v166
buffer_load_dwordx4 v7, s[16:19], s99 offen offset:1408  lds
s_add_u32 m0, s46, 16384
v_sub_f32 v165, v165, v166
v_exp_f32 v164, v164
v_exp_f32 v165, v165
v_sub_f32 v72, v72, v74
s_waitcnt vmcnt(8)
v_cmp_ne_u32 vcc, s45, v219
s_nop 0
s_cbranch_vccnz L_z_5
L_zb_6:
v_sub_f32 v73, v73, v74
v_exp_f32 v72, v72
v_exp_f32 v73, v73
v_sub_f32 v92, v92, v94
s_xor_b32 s99, s98, 263168
buffer_load_dwordx4 v6, s[16:19], s99 offen offset:0  lds
v_sub_f32 v93, v93, v94
v_exp_f32 v92, v92
v_exp_f32 v93, v93
v_cvt_pk_bf16_f32 v164, v164, v165
v_perm_b32 v160, v164, v164, v226
v_perm_b32 v161, v164, v164, v227
v_perm_b32 v162, v164, v164, v228
v_perm_b32 v163, v164, v164, v229
v_cvt_pk_bf16_f32 v72, v72, v73
v_perm_b32 v168, v72, v72, v226
v_perm_b32 v169, v72, v72, v227
buffer_load_dwordx4 v7, s[16:19], s99 offen offset:1024  lds
v_perm_b32 v170, v72, v72, v228
v_perm_b32 v171, v72, v72, v229
v_cvt_pk_bf16_f32 v92, v92, v93
v_perm_b32 v76, v92, v92, v226
v_perm_b32 v77, v92, v92, v227
v_perm_b32 v78, v92, v92, v228
v_perm_b32 v79, v92, v92, v229
v_mfma_f32_16x16x32_bf16 v[68:71], v[172:175], v[160:163], 0
v_mfma_f32_16x16x32_bf16 v[84:87], v[172:175], v[168:171], 0
v_mfma_f32_16x16x32_bf16 v[88:91], v[172:175], v[76:79], 0
s_xor_b32 s72, s100, 0
buffer_load_dwordx4 a[0:3], v1, s[24:27], s72 offen offset:0 sc1
v_mfma_f32_16x16x32_bf16 v[164:167], v[102:105], v[160:163], 0
v_mfma_f32_16x16x32_bf16 v[72:75], v[104:107], v[168:171], 0
v_mfma_f32_16x16x32_bf16 v[92:95], v[106:109], v[76:79], 0
v_xor_b32 v59, s45, v58
v_xor_b32 v63, s45, v62
v_or_b32 v59, v59, v63
v_cmp_ne_u32 vcc, 0, v59
s_nop 0
s_cbranch_vccnz L_kv_3
L_kvb_4:
v_mfma_f32_16x16x16_bf16 v[152:155], v[56:57], v[64:65], v[176:179]
buffer_load_dwordx4 a[4:7], v1, s[24:27], s72 offen offset:1024 sc1
v_mov_b32 v100, v60
v_mov_b32 v101, v61
v_rcp_f32 v68, v68
v_rcp_f32 v84, v84
v_rcp_f32 v88, v88
v_pk_mul_f32 v[164:165], v[164:165], v[68:69] op_sel_hi:[1,0]
v_pk_mul_f32 v[166:167], v[166:167], v[68:69] op_sel_hi:[1,0]
v_cvt_pk_bf16_f32 v164, v164, v165
v_cvt_pk_bf16_f32 v165, v166, v167
ds_write_b64 v231, v[164:165] offset:1024
v_pk_mul_f32 v[72:73], v[72:73], v[84:85] op_sel_hi:[1,0]
buffer_load_dwordx4 a[8:11], v1, s[24:27], s72 offen offset:2048 sc1
v_pk_mul_f32 v[74:75], v[74:75], v[84:85] op_sel_hi:[1,0]
v_cvt_pk_bf16_f32 v72, v72, v73
v_cvt_pk_bf16_f32 v73, v74, v75
ds_write_b64 v231, v[72:73] offset:2048
v_pk_mul_f32 v[92:93], v[92:93], v[88:89] op_sel_hi:[1,0]
v_pk_mul_f32 v[94:95], v[94:95], v[88:89] op_sel_hi:[1,0]
v_cvt_pk_bf16_f32 v92, v92, v93
v_cvt_pk_bf16_f32 v93, v94, v95
ds_write_b64 v231, v[92:93] offset:3072
v_cndmask_b32 v156, v156, v157, s[80:81]
v_cndmask_b32 v158, v158, v159, s[80:81]
v_cndmask_b32 v152, v152, v153, s[80:81]
v_cndmask_b32 v154, v154, v155, s[80:81]
buffer_load_dwordx4 a[12:15], v1, s[24:27], s72 offen offset:3072 sc1
v_cndmask_b32 v156, v152, v156, s[82:83]
v_cndmask_b32 v157, v154, v158, s[84:85]
v_max_f32 v158, v156, v157
v_mov_b32 v159, v158
s_nop 1
v_permlane16_swap_b32 v158, v159
v_max_f32 v158, v158, v159
v_mov_b32 v159, v158
s_nop 1
v_permlane32_swap_b32 v158, v159
v_max_f32 v158, v158, v159
v_sub_f32 v156, v156, v158
v_sub_f32 v157, v157, v158
v_exp_f32 v156, v156
s_xor_b32 s72, s100, 4096
buffer_load_dwordx4 a[16:19], v1, s[24:27], s72 offen offset:0 sc1
v_exp_f32 v157, v157
s_nop 0
v_cvt_pk_bf16_f32 v156, v156, v157
v_perm_b32 v152, v156, v156, v226
v_perm_b32 v153, v156, v156, v227
v_perm_b32 v154, v156, v156, v228
v_perm_b32 v155, v156, v156, v229
s_nop 1
v_mfma_f32_16x16x32_bf16 v[80:83], v[172:175], v[152:155], 0
v_mfma_f32_16x16x32_bf16 v[156:159], v[100:103], v[152:155], 0
v_mov_b32 v226, s45
buffer_load_dwordx4 a[20:23], v1, s[24:27], s72 offen offset:1024 sc1
v_mov_b32 v227, 0
v_add_u32 v228, s46, v1
s_nop 2
v_rcp_f32 v80, v80
s_nop 0
v_pk_mul_f32 v[156:157], v[156:157], v[80:81] op_sel_hi:[1,0]
v_pk_mul_f32 v[158:159], v[158:159], v[80:81] op_sel_hi:[1,0]
v_cvt_pk_bf16_f32 v156, v156, v157
v_cvt_pk_bf16_f32 v157, v158, v159
ds_write_b64 v231, v[156:157] offset:0
s_waitcnt lgkmcnt(0)
s_barrier
buffer_load_dwordx4 a[24:27], v1, s[24:27], s72 offen offset:2048 sc1
s_lshr_b32 s76, s46, 1
v_add_u32 v229, s76, v1
ds_read_b128 v[96:99], v229 offset:8192
ds_read_b128 v[100:103], v229 offset:12288
ds_read_b128 v[176:179], v228 offset:8192
ds_read_b128 v[180:183], v228 offset:9216
s_waitcnt lgkmcnt(1)
buffer_store_dwordx4 v[176:179], v1, s[24:27], s78 offen sc1
s_add_u32 s78, s78, 16384
s_waitcnt lgkmcnt(0)
buffer_store_dwordx4 v[180:183], v1, s[24:27], s78 offen sc1
s_barrier
v_mfma_f32_16x16x32_bf16 v[184:187], v[120:123], a[192:195], v[184:187]
ds_read_b64_tr_b16 v[136:137], v12 offset:32768
v_mul_f32 v233, 0xc0135761, v22
v_mul_f32 v232, v22, v22
v_mul_f32 v232, v232, v233
v_mul_f32 v232, 0x3d372713, v232
v_mul_f32 v235, 0xc0135761, v23
v_mfma_f32_16x16x32_bf16 v[192:195], v[120:123], a[196:199], v[192:195]
v_mul_f32 v234, v23, v23
v_mul_f32 v234, v234, v235
v_mul_f32 v234, 0x3d372713, v234
v_mul_f32 v237, 0xc0135761, v24
v_mul_f32 v236, v24, v24
v_mul_f32 v236, v236, v237
v_mfma_f32_16x16x32_bf16 v[200:203], v[120:123], a[200:203], v[200:203]
buffer_load_dwordx4 a[28:31], v1, s[24:27], s72 offen offset:3072 sc1
v_mul_f32 v236, 0x3d372713, v236
v_mul_f32 v239, 0xc0135761, v25
v_mul_f32 v238, v25, v25
v_mul_f32 v238, v238, v239
v_mfma_f32_16x16x32_bf16 v[208:211], v[120:123], a[204:207], v[208:211]
ds_read_b64_tr_b16 v[138:139], v12 offset:34816
v_mul_f32 v238, 0x3d372713, v238
v_lshrrev_b32 v4, 3, v0
v_and_b32 v5, 7, v0
v_xor_b32 v5, v5, v4
v_lshlrev_b32 v4, 10, v4
v_mfma_f32_16x16x32_bf16 v[188:191], v[124:127], a[192:195], v[188:191]
ds_read_b64_tr_b16 v[140:141], v13 offset:32768
v_lshl_add_u32 v4, v5, 4, v4
v_add_u32 v5, 7168, v4
s_lshl2_add_u32 s55, s41, s40
s_lshl_b32 s55, s55, 14
s_lshl_b32 s48, s1, 7
v_mfma_f32_16x16x32_bf16 v[196:199], v[124:127], a[196:199], v[196:199]
s_xor_b32 s72, s100, 8192
buffer_load_dwordx4 a[32:35], v1, s[24:27], s72 offen offset:0 sc1
s_add_u32 s55, s55, s48
s_mov_b32 s62, s1
s_lshl_b32 s61, s62, 16
v_mfma_f32_16x16x32_bf16 v[204:207], v[124:127], a[200:203], v[204:207]
ds_read_b64_tr_b16 v[142:143], v13 offset:34816
s_lshl_b32 s62, s62, 11
s_lshl2_add_u32 s63, s41, s40
s_lshl_b32 s63, s63, 14
s_add_u32 s62, s62, s63
s_add_u32 s62, s62, 6291456
v_mfma_f32_16x16x32_bf16 v[212:215], v[124:127], a[204:207], v[212:215]
s_lshl_b32 s59, s41, 10
s_add_u32 s58, s59, 1638400
s_add_u32 s59, s59, 1605632
v_mfma_f32_16x16x32_bf16 v[184:187], v[128:131], a[208:211], v[184:187]
buffer_load_dwordx4 a[36:39], v1, s[24:27], s72 offen offset:1024 sc1
v_mfma_f32_16x16x32_bf16 v[192:195], v[128:131], a[212:215], v[192:195]
ds_read_b64_tr_b16 v[144:145], v16 offset:0
v_mfma_f32_16x16x32_bf16 v[200:203], v[128:131], a[216:219], v[200:203]
ds_read_b64_tr_b16 v[146:147], v16 offset:2048
v_mfma_f32_16x16x32_bf16 v[208:211], v[128:131], a[220:223], v[208:211]
v_mfma_f32_16x16x32_bf16 v[188:191], v[132:135], a[208:211], v[188:191]
ds_read_b64_tr_b16 v[148:149], v17 offset:0
v_mfma_f32_16x16x32_bf16 v[196:199], v[132:135], a[212:215], v[196:199]
buffer_load_dwordx4 a[40:43], v1, s[24:27], s72 offen offset:2048 sc1
v_mfma_f32_16x16x32_bf16 v[204:207], v[132:135], a[216:219], v[204:207]
ds_read_b64_tr_b16 v[150:151], v17 offset:2048
v_mfma_f32_16x16x32_bf16 v[212:215], v[132:135], a[220:223], v[212:215]
s_waitcnt lgkmcnt(4)
s_barrier
v_mfma_f32_16x16x32_bf16 v[184:187], v[136:139], a[224:227], v[184:187]
buffer_load_dwordx4 a[44:47], v1, s[24:27], s72 offen offset:3072 sc1
v_mfma_f32_16x16x32_bf16 v[192:195], v[136:139], a[228:231], v[192:195]
ds_read_b128 v[64:67], v224 offset:8192
v_mfma_f32_16x16x32_bf16 v[200:203], v[136:139], a[232:235], v[200:203]
ds_read_b128 v[68:71], v224 offset:10240
v_mfma_f32_16x16x32_bf16 v[208:211], v[136:139], a[236:239], v[208:211]
v_mfma_f32_16x16x32_bf16 v[188:191], v[140:143], a[224:227], v[188:191]
ds_read_b128 v[72:75], v224 offset:12288
v_mfma_f32_16x16x32_bf16 v[196:199], v[140:143], a[228:231], v[196:199]
s_xor_b32 s72, s100, 12288
buffer_load_dwordx4 a[48:51], v1, s[24:27], s72 offen offset:0 sc1
v_mfma_f32_16x16x32_bf16 v[204:207], v[140:143], a[232:235], v[204:207]
ds_read_b128 v[76:79], v224 offset:14336
v_mfma_f32_16x16x32_bf16 v[212:215], v[140:143], a[236:239], v[212:215]
s_waitcnt lgkmcnt(4)
v_mfma_f32_16x16x32_bf16 v[184:187], v[144:147], a[240:243], v[184:187]
ds_read_b128 v[80:83], v225 offset:8192
v_mfma_f32_16x16x32_bf16 v[192:195], v[144:147], a[244:247], v[192:195]
v_mfma_f32_16x16x32_bf16 v[200:203], v[144:147], a[248:251], v[200:203]
buffer_load_dwordx4 a[52:55], v1, s[24:27], s72 offen offset:1024 sc1
v_mfma_f32_16x16x32_bf16 v[208:211], v[144:147], a[252:255], v[208:211]
ds_read_b128 v[84:87], v225 offset:10240
v_mfma_f32_16x16x32_bf16 v[188:191], v[148:151], a[240:243], v[188:191]
ds_read_b128 v[88:91], v225 offset:12288
v_mfma_f32_16x16x32_bf16 v[196:199], v[148:151], a[244:247], v[196:199]
v_mfma_f32_16x16x32_bf16 v[204:207], v[148:151], a[248:251], v[204:207]
ds_read_b128 v[92:95], v225 offset:14336
v_mfma_f32_16x16x32_bf16 v[212:215], v[148:151], a[252:255], v[212:215]
s_waitcnt lgkmcnt(4)
s_barrier
s_waitcnt vmcnt(14)
v_mfma_f32_16x16x32_bf16 v[120:123], a[0:3], v[64:67], 0
buffer_load_dwordx4 a[56:59], v1, s[24:27], s72 offen offset:2048 sc1
v_mul_f32 v240, v184, v184
v_mfma_f32_16x16x32_bf16 v[128:131], a[0:3], v[68:71], 0
ds_read_b128 v[152:155], v220 offset:40960
v_mul_f32 v241, v185, v185
v_mul_f32 v242, v186, v186
v_mfma_f32_16x16x32_bf16 v[136:139], a[0:3], v[72:75], 0
ds_read_b128 v[156:159], v220 offset:43008
v_mul_f32 v243, v187, v187
v_mul_f32 v244, v188, v188
v_mfma_f32_16x16x32_bf16 v[144:147], a[0:3], v[76:79], 0
buffer_load_dwordx4 a[60:63], v1, s[24:27], s72 offen offset:3072 sc1
v_mul_f32 v245, v189, v189
v_mfma_f32_16x16x32_bf16 v[124:127], a[4:7], v[64:67], 0
ds_read_b128 v[160:163], v220 offset:45056
v_mul_f32 v246, v190, v190
v_mul_f32 v247, v191, v191
v_mfma_f32_16x16x32_bf16 v[132:135], a[4:7], v[68:71], 0
v_fma_f32 v240, v240, v232, v233
v_fma_f32 v241, v241, v232, v233
v_fma_f32 v242, v242, v232, v233
v_mfma_f32_16x16x32_bf16 v[140:143], a[4:7], v[72:75], 0
ds_read_b128 v[164:167], v220 offset:47104
v_fma_f32 v243, v243, v232, v233
v_fma_f32 v244, v244, v232, v233
v_mfma_f32_16x16x32_bf16 v[148:151], a[4:7], v[76:79], 0
v_fma_f32 v245, v245, v232, v233
v_fma_f32 v246, v246, v232, v233
s_waitcnt vmcnt(14) lgkmcnt(4)
v_mfma_f32_16x16x32_bf16 v[120:123], a[8:11], v[80:83], v[120:123]
ds_read_b128 v[168:171], v221 offset:40960
v_fma_f32 v247, v247, v232, v233
v_mul_f32 v240, v240, v184
v_mfma_f32_16x16x32_bf16 v[128:131], a[8:11], v[84:87], v[128:131]
s_xor_b32 s72, s100, 16384
buffer_load_dwordx4 a[64:67], v1, s[24:27], s72 offen offset:0 sc1
v_mfma_f32_16x16x32_bf16 v[136:139], a[8:11], v[88:91], v[136:139]
ds_read_b128 v[172:175], v221 offset:43008
v_mul_f32 v241, v241, v185
v_mul_f32 v242, v242, v186
v_mfma_f32_16x16x32_bf16 v[144:147], a[8:11], v[92:95], v[144:147]
v_mul_f32 v243, v243, v187
v_mul_f32 v244, v244, v188
v_mul_f32 v245, v245, v189
v_mfma_f32_16x16x32_bf16 v[124:127], a[12:15], v[80:83], v[124:127]
ds_read_b128 v[176:179], v221 offset:45056
v_mul_f32 v246, v246, v190
v_mul_f32 v247, v247, v191
v_mfma_f32_16x16x32_bf16 v[132:135], a[12:15], v[84:87], v[132:135]
s_waitcnt vmcnt(10)
buffer_store_dword v226, v227, s[24:27], s79 offen sc1
s_lshl2_add_u32 s75, s42, s40
v_mfma_f32_16x16x32_bf16 v[140:143], a[12:15], v[88:91], v[140:143]
ds_read_b128 v[180:183], v221 offset:47104
s_lshl_b32 s74, s41, 5
s_add_u32 s74, s74, s75
v_mfma_f32_16x16x32_bf16 v[148:151], a[12:15], v[92:95], v[148:151]
s_lshl_b32 s86, s74, 13
s_add_u32 s86, s86, 14680064
s_waitcnt lgkmcnt(4)
v_mfma_f32_16x16x32_bf16 v[120:123], a[16:19], v[152:155], v[120:123]
ds_read_b128 v[64:67], v224 offset:16384
s_xor_b32 s87, s86, 0x40000
s_lshl_b32 s74, s74, 5
v_mfma_f32_16x16x32_bf16 v[128:131], a[16:19], v[156:159], v[128:131]
buffer_load_dwordx4 a[68:71], v1, s[24:27], s72 offen offset:1024 sc1
s_add_u32 s88, s74, 1671168
v_mfma_f32_16x16x32_bf16 v[136:139], a[16:19], v[160:163], v[136:139]
ds_read_b128 v[68:71], v224 offset:18432
s_xor_b32 s89, s88, 0x400
s_add_u32 s74, s74, 1638400
v_mfma_f32_16x16x32_bf16 v[144:147], a[16:19], v[164:167], v[144:147]
v_add_u32 v248, 4096, v1
v_exp_f32 v240, v240
v_mfma_f32_16x16x32_bf16 v[124:127], a[20:23], v[152:155], v[124:127]
buffer_load_dwordx4 a[72:75], v1, s[24:27], s72 offen offset:2048 sc1
v_mfma_f32_16x16x32_bf16 v[132:135], a[20:23], v[156:159], v[132:135]
ds_read_b128 v[72:75], v224 offset:20480
v_exp_f32 v241, v241
v_mfma_f32_16x16x32_bf16 v[140:143], a[20:23], v[160:163], v[140:143]
ds_read_b128 v[76:79], v224 offset:22528
v_exp_f32 v242, v242
v_mfma_f32_16x16x32_bf16 v[148:151], a[20:23], v[164:167], v[148:151]
v_exp_f32 v243, v243
s_waitcnt vmcnt(12) lgkmcnt(4)
v_mfma_f32_16x16x32_bf16 v[120:123], a[24:27], v[168:171], v[120:123]
buffer_load_dwordx4 a[76:79], v1, s[24:27], s72 offen offset:3072 sc1
v_mfma_f32_16x16x32_bf16 v[128:131], a[24:27], v[172:175], v[128:131]
ds_read_b128 v[80:83], v225 offset:16384
v_exp_f32 v244, v244
v_mfma_f32_16x16x32_bf16 v[136:139], a[24:27], v[176:179], v[136:139]
ds_read_b128 v[84:87], v225 offset:18432
v_exp_f32 v245, v245
v_mfma_f32_16x16x32_bf16 v[144:147], a[24:27], v[180:183], v[144:147]
s_xor_b32 s72, s100, 20480
buffer_load_dwordx4 a[80:83], v1, s[24:27], s72 offen offset:0 sc1
v_mfma_f32_16x16x32_bf16 v[124:127], a[28:31], v[168:171], v[124:127]
ds_read_b128 v[88:91], v225 offset:20480
v_exp_f32 v246, v246
v_mfma_f32_16x16x32_bf16 v[132:135], a[28:31], v[172:175], v[132:135]
v_exp_f32 v247, v247
v_add_f32 v240, 1.0, v240
v_mfma_f32_16x16x32_bf16 v[140:143], a[28:31], v[176:179], v[140:143]
buffer_load_dwordx4 a[84:87], v1, s[24:27], s72 offen offset:1024 sc1
v_add_f32 v241, 1.0, v241
v_mfma_f32_16x16x32_bf16 v[148:151], a[28:31], v[180:183], v[148:151]
ds_read_b128 v[92:95], v225 offset:22528
v_add_f32 v242, 1.0, v242
s_waitcnt vmcnt(13) lgkmcnt(4)
s_barrier
v_mfma_f32_16x16x32_bf16 v[120:123], a[32:35], v[64:67], v[120:123]
buffer_load_dwordx4 a[88:91], v1, s[24:27], s72 offen offset:2048 sc1
v_add_f32 v243, 1.0, v243
v_mfma_f32_16x16x32_bf16 v[128:131], a[32:35], v[68:71], v[128:131]
ds_read_b128 v[152:155], v224 offset:24576
v_add_f32 v244, 1.0, v244
v_add_f32 v245, 1.0, v245
v_mfma_f32_16x16x32_bf16 v[136:139], a[32:35], v[72:75], v[136:139]
ds_read_b128 v[156:159], v224 offset:26624
v_add_f32 v246, 1.0, v246
v_add_f32 v247, 1.0, v247
v_mfma_f32_16x16x32_bf16 v[144:147], a[32:35], v[76:79], v[144:147]
v_rcp_f32 v240, v240
v_mfma_f32_16x16x32_bf16 v[124:127], a[36:39], v[64:67], v[124:127]
buffer_load_dwordx4 a[92:95], v1, s[24:27], s72 offen offset:3072 sc1
v_mfma_f32_16x16x32_bf16 v[132:135], a[36:39], v[68:71], v[132:135]
ds_read_b128 v[160:163], v224 offset:28672
v_rcp_f32 v241, v241
v_mfma_f32_16x16x32_bf16 v[140:143], a[36:39], v[72:75], v[140:143]
ds_read_b128 v[164:167], v224 offset:30720
v_rcp_f32 v242, v242
v_mfma_f32_16x16x32_bf16 v[148:151], a[36:39], v[76:79], v[148:151]
v_rcp_f32 v243, v243
s_waitcnt vmcnt(13) lgkmcnt(4)
v_mfma_f32_16x16x32_bf16 v[120:123], a[40:43], v[80:83], v[120:123]
s_xor_b32 s72, s100, 24576
buffer_load_dwordx4 a[96:99], v1, s[24:27], s72 offen offset:0 sc1
v_mfma_f32_16x16x32_bf16 v[128:131], a[40:43], v[84:87], v[128:131]
ds_read_b128 v[168:171], v225 offset:24576
v_rcp_f32 v244, v244
v_mfma_f32_16x16x32_bf16 v[136:139], a[40:43], v[88:91], v[136:139]
ds_read_b128 v[172:175], v225 offset:26624
v_rcp_f32 v245, v245
v_mfma_f32_16x16x32_bf16 v[144:147], a[40:43], v[92:95], v[144:147]
buffer_load_dwordx4 a[100:103], v1, s[24:27], s72 offen offset:1024 sc1
v_mfma_f32_16x16x32_bf16 v[124:127], a[44:47], v[80:83], v[124:127]
ds_read_b128 v[176:179], v225 offset:28672
v_rcp_f32 v246, v246
v_mfma_f32_16x16x32_bf16 v[132:135], a[44:47], v[84:87], v[132:135]
v_rcp_f32 v247, v247
v_mul_f32 v184, v184, v240
v_mfma_f32_16x16x32_bf16 v[140:143], a[44:47], v[88:91], v[140:143]
buffer_load_dwordx4 a[104:107], v1, s[24:27], s72 offen offset:2048 sc1
v_mul_f32 v185, v185, v241
v_mfma_f32_16x16x32_bf16 v[148:151], a[44:47], v[92:95], v[148:151]
ds_read_b128 v[180:183], v225 offset:30720
v_mul_f32 v186, v186, v242
s_waitcnt vmcnt(14) lgkmcnt(4)
v_mfma_f32_16x16x32_bf16 v[120:123], a[48:51], v[152:155], v[120:123]
ds_read_b128 v[64:67], v220 offset:49152
v_mul_f32 v187, v187, v243
v_mul_f32 v188, v188, v244
v_mfma_f32_16x16x32_bf16 v[128:131], a[48:51], v[156:159], v[128:131]
buffer_load_dwordx4 a[108:111], v1, s[24:27], s72 offen offset:3072 sc1
s_add_u32 m0, s46, 98176
v_mfma_f32_16x16x32_bf16 v[136:139], a[48:51], v[160:163], v[136:139]
ds_read_b128 v[68:71], v220 offset:51200
v_mul_f32 v189, v189, v245
v_mul_f32 v190, v190, v246
v_mfma_f32_16x16x32_bf16 v[144:147], a[48:51], v[164:167], v[144:147]
v_mul_f32 v191, v191, v247
v_mul_f32 v240, v192, v192
v_mul_f32 v241, v193, v193
v_mfma_f32_16x16x32_bf16 v[124:127], a[52:55], v[152:155], v[124:127]
buffer_load_dwordx4 v6, s[16:19], s99 offen offset:128  lds
v_mul_f32 v242, v194, v194
v_mfma_f32_16x16x32_bf16 v[132:135], a[52:55], v[156:159], v[132:135]
ds_read_b128 v[72:75], v220 offset:53248
v_mul_f32 v243, v195, v195
v_mul_f32 v244, v196, v196
v_mfma_f32_16x16x32_bf16 v[140:143], a[52:55], v[160:163], v[140:143]
ds_read_b128 v[76:79], v220 offset:55296
v_mul_f32 v245, v197, v197
v_mul_f32 v246, v198, v198
v_mfma_f32_16x16x32_bf16 v[148:151], a[52:55], v[164:167], v[148:151]
v_mul_f32 v247, v199, v199
v_fma_f32 v240, v240, v234, v235
s_waitcnt vmcnt(14) lgkmcnt(4)
v_mfma_f32_16x16x32_bf16 v[120:123], a[56:59], v[168:171], v[120:123]
buffer_load_dwordx4 v7, s[16:19], s99 offen offset:1152  lds
s_add_u32 m0, s46, 65280
v_mfma_f32_16x16x32_bf16 v[128:131], a[56:59], v[172:175], v[128:131]
ds_read_b128 v[80:83], v221 offset:49152
v_fma_f32 v241, v241, v234, v235
v_fma_f32 v242, v242, v234, v235
v_mfma_f32_16x16x32_bf16 v[136:139], a[56:59], v[176:179], v[136:139]
ds_read_b128 v[84:87], v221 offset:51200
v_fma_f32 v243, v243, v234, v235
v_fma_f32 v244, v244, v234, v235
v_mfma_f32_16x16x32_bf16 v[144:147], a[56:59], v[180:183], v[144:147]
buffer_load_dwordx4 v6, s[16:19], s99 offen offset:256  lds
v_fma_f32 v245, v245, v234, v235
v_mfma_f32_16x16x32_bf16 v[124:127], a[60:63], v[168:171], v[124:127]
ds_read_b128 v[88:91], v221 offset:53248
v_fma_f32 v246, v246, v234, v235
v_fma_f32 v247, v247, v234, v235
v_mfma_f32_16x16x32_bf16 v[132:135], a[60:63], v[172:175], v[132:135]
v_mul_f32 v240, v240, v192
v_mul_f32 v241, v241, v193
v_mul_f32 v242, v242, v194
v_mfma_f32_16x16x32_bf16 v[140:143], a[60:63], v[176:179], v[140:143]
buffer_load_dwordx4 v7, s[16:19], s99 offen offset:1280  lds
v_mul_f32 v243, v243, v195
v_mfma_f32_16x16x32_bf16 v[148:151], a[60:63], v[180:183], v[148:151]
ds_read_b128 v[92:95], v221 offset:55296
v_mul_f32 v244, v244, v196
s_waitcnt vmcnt(14) lgkmcnt(4)
s_barrier
v_mfma_f32_16x16x32_bf16 v[120:123], a[64:67], v[64:67], v[120:123]
s_xor_b32 s72, s100, 28672
buffer_load_dwordx4 a[112:115], v1, s[24:27], s72 offen offset:0 sc1
v_mfma_f32_16x16x32_bf16 v[128:131], a[64:67], v[68:71], v[128:131]
ds_read_b128 v[152:155], v222 offset:16384
v_mul_f32 v245, v245, v197
v_mul_f32 v246, v246, v198
v_mfma_f32_16x16x32_bf16 v[136:139], a[64:67], v[72:75], v[136:139]
ds_read_b128 v[156:159], v222 offset:18432
v_mul_f32 v247, v247, v199
v_mfma_f32_16x16x32_bf16 v[144:147], a[64:67], v[76:79], v[144:147]
buffer_load_dwordx4 a[116:119], v1, s[24:27], s72 offen offset:1024 sc1
v_mfma_f32_16x16x32_bf16 v[124:127], a[68:71], v[64:67], v[124:127]
ds_read_b128 v[160:163], v222 offset:20480
v_exp_f32 v240, v240
v_mfma_f32_16x16x32_bf16 v[132:135], a[68:71], v[68:71], v[132:135]
v_exp_f32 v241, v241
v_mfma_f32_16x16x32_bf16 v[140:143], a[68:71], v[72:75], v[140:143]
buffer_load_dwordx4 a[120:123], v1, s[24:27], s72 offen offset:2048 sc1
v_mfma_f32_16x16x32_bf16 v[148:151], a[68:71], v[76:79], v[148:151]
ds_read_b128 v[164:167], v222 offset:22528
s_waitcnt vmcnt(15) lgkmcnt(4)
v_mfma_f32_16x16x32_bf16 v[120:123], a[72:75], v[80:83], v[120:123]
ds_read_b128 v[168:171], v223 offset:16384
v_exp_f32 v242, v242
v_mfma_f32_16x16x32_bf16 v[128:131], a[72:75], v[84:87], v[128:131]
v_exp_f32 v243, v243
v_mfma_f32_16x16x32_bf16 v[136:139], a[72:75], v[88:91], v[136:139]
buffer_load_dwordx4 a[124:127], v1, s[24:27], s72 offen offset:3072 sc1
v_mfma_f32_16x16x32_bf16 v[144:147], a[72:75], v[92:95], v[144:147]
ds_read_b128 v[172:175], v223 offset:18432
v_exp_f32 v244, v244
v_mfma_f32_16x16x32_bf16 v[124:127], a[76:79], v[80:83], v[124:127]
ds_read_b128 v[176:179], v223 offset:20480
v_exp_f32 v245, v245
v_mfma_f32_16x16x32_bf16 v[132:135], a[76:79], v[84:87], v[132:135]
v_exp_f32 v246, v246
v_mfma_f32_16x16x32_bf16 v[140:143], a[76:79], v[88:91], v[140:143]
s_xor_b32 s72, s100, 32768
buffer_load_dwordx4 a[128:131], v1, s[24:27], s72 offen offset:0 sc1
v_mfma_f32_16x16x32_bf16 v[148:151], a[76:79], v[92:95], v[148:151]
ds_read_b128 v[180:183], v223 offset:22528
s_waitcnt vmcnt(15) lgkmcnt(4)
v_mfma_f32_16x16x32_bf16 v[120:123], a[80:83], v[152:155], v[120:123]
ds_read_b128 v[64:67], v222 offset:24576
v_exp_f32 v247, v247
v_mfma_f32_16x16x32_bf16 v[128:131], a[80:83], v[156:159], v[128:131]
buffer_load_dwordx4 a[132:135], v1, s[24:27], s72 offen offset:1024 sc1
v_add_f32 v240, 1.0, v240
v_mfma_f32_16x16x32_bf16 v[136:139], a[80:83], v[160:163], v[136:139]
ds_read_b128 v[68:71], v222 offset:26624
v_add_f32 v241, 1.0, v241
v_add_f32 v242, 1.0, v242
v_mfma_f32_16x16x32_bf16 v[144:147], a[80:83], v[164:167], v[144:147]
v_add_f32 v243, 1.0, v243
v_add_f32 v244, 1.0, v244
v_add_f32 v245, 1.0, v245
v_mfma_f32_16x16x32_bf16 v[124:127], a[84:87], v[152:155], v[124:127]
ds_read_b128 v[72:75], v222 offset:28672
v_add_f32 v246, 1.0, v246
v_add_f32 v247, 1.0, v247
v_mfma_f32_16x16x32_bf16 v[132:135], a[84:87], v[156:159], v[132:135]
buffer_load_dwordx4 a[136:139], v1, s[24:27], s72 offen offset:2048 sc1
v_mfma_f32_16x16x32_bf16 v[140:143], a[84:87], v[160:163], v[140:143]
ds_read_b128 v[76:79], v222 offset:30720
v_rcp_f32 v240, v240
v_mfma_f32_16x16x32_bf16 v[148:151], a[84:87], v[164:167], v[148:151]
v_rcp_f32 v241, v241
s_waitcnt vmcnt(15) lgkmcnt(4)
v_mfma_f32_16x16x32_bf16 v[120:123], a[88:91], v[168:171], v[120:123]
ds_read_b128 v[80:83], v223 offset:24576
v_rcp_f32 v242, v242
v_mfma_f32_16x16x32_bf16 v[128:131], a[88:91], v[172:175], v[128:131]
v_rcp_f32 v243, v243
v_mfma_f32_16x16x32_bf16 v[136:139], a[88:91], v[176:179], v[136:139]
buffer_load_dwordx4 a[140:143], v1, s[24:27], s72 offen offset:3072 sc1
v_mfma_f32_16x16x32_bf16 v[144:147], a[88:91], v[180:183], v[144:147]
ds_read_b128 v[84:87], v223 offset:26624
v_rcp_f32 v244, v244
v_mfma_f32_16x16x32_bf16 v[124:127], a[92:95], v[168:171], v[124:127]
ds_read_b128 v[88:91], v223 offset:28672
v_rcp_f32 v245, v245
v_mfma_f32_16x16x32_bf16 v[132:135], a[92:95], v[172:175], v[132:135]
v_rcp_f32 v246, v246
v_mfma_f32_16x16x32_bf16 v[140:143], a[92:95], v[176:179], v[140:143]
s_xor_b32 s72, s100, 36864
buffer_load_dwordx4 a[144:147], v1, s[24:27], s72 offen offset:0 sc1
v_mfma_f32_16x16x32_bf16 v[148:151], a[92:95], v[180:183], v[148:151]
ds_read_b128 v[92:95], v223 offset:30720
s_waitcnt vmcnt(15) lgkmcnt(4)
s_barrier
v_mfma_f32_16x16x32_bf16 v[120:123], a[96:99], v[64:67], v[120:123]
ds_read_b128 v[152:155], v220 offset:57344
v_mfma_f32_16x16x32_bf16 v[128:131], a[96:99], v[68:71], v[128:131]
buffer_load_dwordx4 a[148:151], v1, s[24:27], s72 offen offset:1024 sc1
v_mfma_f32_16x16x32_bf16 v[136:139], a[96:99], v[72:75], v[136:139]
ds_read_b128 v[156:159], v220 offset:59392
v_mfma_f32_16x16x32_bf16 v[144:147], a[96:99], v[76:79], v[144:147]
v_rcp_f32 v247, v247
v_mfma_f32_16x16x32_bf16 v[124:127], a[100:103], v[64:67], v[124:127]
ds_read_b128 v[160:163], v220 offset:61440
v_mul_f32 v192, v192, v240
v_mfma_f32_16x16x32_bf16 v[132:135], a[100:103], v[68:71], v[132:135]
v_mul_f32 v193, v193, v241
v_mul_f32 v194, v194, v242
v_mfma_f32_16x16x32_bf16 v[140:143], a[100:103], v[72:75], v[140:143]
ds_read_b128 v[164:167], v220 offset:63488
v_mul_f32 v195, v195, v243
v_mfma_f32_16x16x32_bf16 v[148:151], a[100:103], v[76:79], v[148:151]
v_mul_f32 v196, v196, v244
s_waitcnt vmcnt(14) lgkmcnt(4)
v_mfma_f32_16x16x32_bf16 v[120:123], a[104:107], v[80:83], v[120:123]
buffer_load_dwordx4 a[152:155], v1, s[24:27], s72 offen offset:2048 sc1
v_mfma_f32_16x16x32_bf16 v[128:131], a[104:107], v[84:87], v[128:131]
ds_read_b128 v[168:171], v221 offset:57344
v_mul_f32 v197, v197, v245
v_mfma_f32_16x16x32_bf16 v[136:139], a[104:107], v[88:91], v[136:139]
ds_read_b128 v[172:175], v221 offset:59392
v_mul_f32 v198, v198, v246
v_mfma_f32_16x16x32_bf16 v[144:147], a[104:107], v[92:95], v[144:147]
v_mul_f32 v199, v199, v247
v_mul_f32 v240, v200, v200
v_mfma_f32_16x16x32_bf16 v[124:127], a[108:111], v[80:83], v[124:127]
buffer_load_dwordx4 a[156:159], v1, s[24:27], s72 offen offset:3072 sc1
s_add_u32 m0, s46, 106112
v_mfma_f32_16x16x32_bf16 v[132:135], a[108:111], v[84:87], v[132:135]
ds_read_b128 v[176:179], v221 offset:61440
v_mul_f32 v241, v201, v201
v_mfma_f32_16x16x32_bf16 v[140:143], a[108:111], v[88:91], v[140:143]
ds_read_b128 v[180:183], v221 offset:63488
v_mul_f32 v242, v202, v202
v_mfma_f32_16x16x32_bf16 v[148:151], a[108:111], v[92:95], v[148:151]
v_mul_f32 v243, v203, v203
s_waitcnt vmcnt(10) lgkmcnt(4)
v_mfma_f32_16x16x32_bf16 v[120:123], a[112:115], v[152:155], v[120:123]
buffer_load_dwordx4 v6, s[16:19], s99 offen offset:384  lds
v_mfma_f32_16x16x32_bf16 v[128:131], a[112:115], v[156:159], v[128:131]
ds_read_b128 v[64:67], v220 offset:16384
v_mul_f32 v244, v204, v204
v_mfma_f32_16x16x32_bf16 v[136:139], a[112:115], v[160:163], v[136:139]
ds_read_b128 v[68:71], v220 offset:18432
v_mul_f32 v245, v205, v205
v_mfma_f32_16x16x32_bf16 v[144:147], a[112:115], v[164:167], v[144:147]
v_mul_f32 v246, v206, v206
v_mul_f32 v247, v207, v207
v_mfma_f32_16x16x32_bf16 v[124:127], a[116:119], v[152:155], v[124:127]
buffer_load_dwordx4 v7, s[16:19], s99 offen offset:1408  lds
s_add_u32 m0, s46, 24576
v_mfma_f32_16x16x32_bf16 v[132:135], a[116:119], v[156:159], v[132:135]
ds_read_b128 v[72:75], v220 offset:20480
v_fma_f32 v240, v240, v236, v237
v_mfma_f32_16x16x32_bf16 v[140:143], a[116:119], v[160:163], v[140:143]
ds_read_b128 v[76:79], v220 offset:22528
v_fma_f32 v241, v241, v236, v237
v_mfma_f32_16x16x32_bf16 v[148:151], a[116:119], v[164:167], v[148:151]
v_fma_f32 v242, v242, v236, v237
s_waitcnt vmcnt(10) lgkmcnt(4)
v_mfma_f32_16x16x32_bf16 v[120:123], a[120:123], v[168:171], v[120:123]
s_xor_b32 s99, s98, 263680
buffer_load_dwordx4 v6, s[16:19], s99 offen offset:0  lds
v_mfma_f32_16x16x32_bf16 v[128:131], a[120:123], v[172:175], v[128:131]
ds_read_b128 v[80:83], v221 offset:16384
v_fma_f32 v243, v243, v236, v237
v_mfma_f32_16x16x32_bf16 v[136:139], a[120:123], v[176:179], v[136:139]
ds_read_b128 v[84:87], v221 offset:18432
v_fma_f32 v244, v244, v236, v237
v_mfma_f32_16x16x32_bf16 v[144:147], a[120:123], v[180:183], v[144:147]
buffer_load_dwordx4 v7, s[16:19], s99 offen offset:1024  lds
v_mfma_f32_16x16x32_bf16 v[124:127], a[124:127], v[168:171], v[124:127]
ds_read_b128 v[88:91], v221 offset:20480
v_fma_f32 v245, v245, v236, v237
v_mfma_f32_16x16x32_bf16 v[132:135], a[124:127], v[172:175], v[132:135]
v_fma_f32 v246, v246, v236, v237
v_fma_f32 v247, v247, v236, v237
v_mfma_f32_16x16x32_bf16 v[140:143], a[124:127], v[176:179], v[140:143]
ds_read_b128 v[92:95], v221 offset:22528
v_mul_f32 v240, v240, v200
v_mfma_f32_16x16x32_bf16 v[148:151], a[124:127], v[180:183], v[148:151]
v_mul_f32 v241, v241, v201
s_waitcnt vmcnt(10) lgkmcnt(4)
s_barrier
v_mfma_f32_16x16x32_bf16 v[120:123], a[128:131], v[64:67], v[120:123]
s_xor_b32 s72, s100, 40960
buffer_load_dwordx4 a[160:163], v1, s[24:27], s72 offen offset:0 sc1
v_mfma_f32_16x16x32_bf16 v[128:131], a[128:131], v[68:71], v[128:131]
ds_read_b128 v[152:155], v222 offset:32768
v_mul_f32 v242, v242, v202
v_mfma_f32_16x16x32_bf16 v[136:139], a[128:131], v[72:75], v[136:139]
ds_read_b128 v[156:159], v222 offset:34816
v_mul_f32 v243, v243, v203
v_mfma_f32_16x16x32_bf16 v[144:147], a[128:131], v[76:79], v[144:147]
v_mul_f32 v244, v244, v204
v_mul_f32 v245, v245, v205
v_mfma_f32_16x16x32_bf16 v[124:127], a[132:135], v[64:67], v[124:127]
buffer_load_dwordx4 a[164:167], v1, s[24:27], s72 offen offset:1024 sc1
v_mfma_f32_16x16x32_bf16 v[132:135], a[132:135], v[68:71], v[132:135]
ds_read_b128 v[160:163], v222 offset:36864
v_mul_f32 v246, v246, v206
v_mfma_f32_16x16x32_bf16 v[140:143], a[132:135], v[72:75], v[140:143]
ds_read_b128 v[164:167], v222 offset:38912
v_mul_f32 v247, v247, v207
v_mfma_f32_16x16x32_bf16 v[148:151], a[132:135], v[76:79], v[148:151]
s_waitcnt vmcnt(10) lgkmcnt(4)
v_mfma_f32_16x16x32_bf16 v[120:123], a[136:139], v[80:83], v[120:123]
buffer_load_dwordx4 a[168:171], v1, s[24:27], s72 offen offset:2048 sc1
v_mfma_f32_16x16x32_bf16 v[128:131], a[136:139], v[84:87], v[128:131]
ds_read_b128 v[168:171], v223 offset:32768
v_mfma_f32_16x16x32_bf16 v[136:139], a[136:139], v[88:91], v[136:139]
ds_read_b128 v[172:175], v223 offset:34816
v_mfma_f32_16x16x32_bf16 v[144:147], a[136:139], v[92:95], v[144:147]
v_exp_f32 v240, v240
v_mfma_f32_16x16x32_bf16 v[124:127], a[140:143], v[80:83], v[124:127]
buffer_load_dwordx4 a[172:175], v1, s[24:27], s72 offen offset:3072 sc1
v_mfma_f32_16x16x32_bf16 v[132:135], a[140:143], v[84:87], v[132:135]
ds_read_b128 v[176:179], v223 offset:36864
v_mfma_f32_16x16x32_bf16 v[140:143], a[140:143], v[88:91], v[140:143]
ds_read_b128 v[180:183], v223 offset:38912
v_mfma_f32_16x16x32_bf16 v[148:151], a[140:143], v[92:95], v[148:151]
s_waitcnt vmcnt(10) lgkmcnt(4)
v_mfma_f32_16x16x32_bf16 v[120:123], a[144:147], v[152:155], v[120:123]
s_xor_b32 s72, s100, 45056
buffer_load_dwordx4 a[176:179], v1, s[24:27], s72 offen offset:0 sc1
v_mfma_f32_16x16x32_bf16 v[128:131], a[144:147], v[156:159], v[128:131]
ds_read_b128 v[64:67], v222 offset:0
v_mfma_f32_16x16x32_bf16 v[136:139], a[144:147], v[160:163], v[136:139]
ds_read_b128 v[68:71], v222 offset:2048
v_mfma_f32_16x16x32_bf16 v[144:147], a[144:147], v[164:167], v[144:147]
v_exp_f32 v241, v241
v_mfma_f32_16x16x32_bf16 v[124:127], a[148:151], v[152:155], v[124:127]
buffer_load_dwordx4 a[180:183], v1, s[24:27], s72 offen offset:1024 sc1
v_mfma_f32_16x16x32_bf16 v[132:135], a[148:151], v[156:159], v[132:135]
ds_read_b128 v[72:75], v222 offset:4096
v_mfma_f32_16x16x32_bf16 v[140:143], a[148:151], v[160:163], v[140:143]
ds_read_b128 v[76:79], v222 offset:6144
v_mfma_f32_16x16x32_bf16 v[148:151], a[148:151], v[164:167], v[148:151]
s_waitcnt vmcnt(10) lgkmcnt(4)
v_mfma_f32_16x16x32_bf16 v[120:123], a[152:155], v[168:171], v[120:123]
buffer_load_dwordx4 a[184:187], v1, s[24:27], s72 offen offset:2048 sc1
v_mfma_f32_16x16x32_bf16 v[128:131], a[152:155], v[172:175], v[128:131]
ds_read_b128 v[80:83], v223 offset:0
v_mfma_f32_16x16x32_bf16 v[136:139], a[152:155], v[176:179], v[136:139]
ds_read_b128 v[84:87], v223 offset:2048
v_mfma_f32_16x16x32_bf16 v[144:147], a[152:155], v[180:183], v[144:147]
v_exp_f32 v242, v242
v_mfma_f32_16x16x32_bf16 v[124:127], a[156:159], v[168:171], v[124:127]
buffer_load_dwordx4 a[188:191], v1, s[24:27], s72 offen offset:3072 sc1
s_add_u32 m0, s46, 73600
v_mfma_f32_16x16x32_bf16 v[132:135], a[156:159], v[172:175], v[132:135]
ds_read_b128 v[88:91], v223 offset:4096
v_mfma_f32_16x16x32_bf16 v[140:143], a[156:159], v[176:179], v[140:143]
ds_read_b128 v[92:95], v223 offset:6144
v_mfma_f32_16x16x32_bf16 v[148:151], a[156:159], v[180:183], v[148:151]
buffer_load_dwordx4 v6, s[16:19], s99 offen offset:128  lds
buffer_load_dwordx4 v7, s[16:19], s99 offen offset:1152  lds
s_add_u32 m0, s46, 114432
s_nop 0
buffer_load_dwordx4 v6, s[16:19], s99 offen offset:256  lds
buffer_load_dwordx4 v7, s[16:19], s99 offen offset:1280  lds
s_xor_b32 s72, s100, 49152
buffer_load_dwordx4 a[192:195], v1, s[24:27], s72 offen offset:0 sc1
s_waitcnt vmcnt(11) lgkmcnt(4)
s_barrier
v_mfma_f32_16x16x32_bf16 v[120:123], a[160:163], v[64:67], v[120:123]
ds_read_b128 v[152:155], v222 offset:40960
v_mfma_f32_16x16x32_bf16 v[128:131], a[160:163], v[68:71], v[128:131]
v_exp_f32 v243, v243
v_mfma_f32_16x16x32_bf16 v[136:139], a[160:163], v[72:75], v[136:139]
buffer_load_dwordx4 a[196:199], v1, s[24:27], s72 offen offset:1024 sc1
v_mfma_f32_16x16x32_bf16 v[144:147], a[160:163], v[76:79], v[144:147]
ds_read_b128 v[156:159], v222 offset:43008
v_mfma_f32_16x16x32_bf16 v[124:127], a[164:167], v[64:67], v[124:127]
ds_read_b128 v[160:163], v222 offset:45056
v_mfma_f32_16x16x32_bf16 v[132:135], a[164:167], v[68:71], v[132:135]
v_exp_f32 v244, v244
v_mfma_f32_16x16x32_bf16 v[140:143], a[164:167], v[72:75], v[140:143]
buffer_load_dwordx4 a[200:203], v1, s[24:27], s72 offen offset:2048 sc1
v_mfma_f32_16x16x32_bf16 v[148:151], a[164:167], v[76:79], v[148:151]
ds_read_b128 v[164:167], v222 offset:47104
s_waitcnt vmcnt(11) lgkmcnt(4)
v_mfma_f32_16x16x32_bf16 v[120:123], a[168:171], v[80:83], v[120:123]
ds_read_b128 v[168:171], v223 offset:40960
v_mfma_f32_16x16x32_bf16 v[128:131], a[168:171], v[84:87], v[128:131]
v_exp_f32 v245, v245
v_mfma_f32_16x16x32_bf16 v[136:139], a[168:171], v[88:91], v[136:139]
buffer_load_dwordx4 a[204:207], v1, s[24:27], s72 offen offset:3072 sc1
s_add_u32 m0, s46, 122496
v_mfma_f32_16x16x32_bf16 v[144:147], a[168:171], v[92:95], v[144:147]
ds_read_b128 v[172:175], v223 offset:43008
v_mfma_f32_16x16x32_bf16 v[124:127], a[172:175], v[80:83], v[124:127]
ds_read_b128 v[176:179], v223 offset:45056
v_mfma_f32_16x16x32_bf16 v[132:135], a[172:175], v[84:87], v[132:135]
v_exp_f32 v246, v246
v_mfma_f32_16x16x32_bf16 v[140:143], a[172:175], v[88:91], v[140:143]
buffer_load_dwordx4 v6, s[16:19], s99 offen offset:384  lds
v_mfma_f32_16x16x32_bf16 v[148:151], a[172:175], v[92:95], v[148:151]
ds_read_b128 v[180:183], v223 offset:47104
s_waitcnt vmcnt(11) lgkmcnt(4)
v_mfma_f32_16x16x32_bf16 v[120:123], a[176:179], v[152:155], v[120:123]
ds_read_b128 v[64:67], v220 offset:24576
v_mfma_f32_16x16x32_bf16 v[128:131], a[176:179], v[156:159], v[128:131]
v_exp_f32 v247, v247
v_mfma_f32_16x16x32_bf16 v[136:139], a[176:179], v[160:163], v[136:139]
buffer_load_dwordx4 v7, s[16:19], s99 offen offset:1408  lds
s_add_u32 m0, s46, 32768
v_mfma_f32_16x16x32_bf16 v[144:147], a[176:179], v[164:167], v[144:147]
ds_read_b128 v[68:71], v220 offset:26624
v_add_f32 v240, 1.0, v240
v_mfma_f32_16x16x32_bf16 v[124:127], a[180:183], v[152:155], v[124:127]
ds_read_b128 v[72:75], v220 offset:28672
v_add_f32 v241, 1.0, v241
v_mfma_f32_16x16x32_bf16 v[132:135], a[180:183], v[156:159], v[132:135]
v_add_f32 v242, 1.0, v242
v_add_f32 v243, 1.0, v243
v_mfma_f32_16x16x32_bf16 v[140:143], a[180:183], v[160:163], v[140:143]
s_xor_b32 s99, s98, 0
buffer_load_dwordx4 v6, s[16:19], s99 offen offset:0  lds
v_mfma_f32_16x16x32_bf16 v[148:151], a[180:183], v[164:167], v[148:151]
ds_read_b128 v[76:79], v220 offset:30720
s_waitcnt vmcnt(11) lgkmcnt(4)
v_mfma_f32_16x16x32_bf16 v[120:123], a[184:187], v[168:171], v[120:123]
ds_read_b128 v[80:83], v221 offset:24576
v_add_f32 v244, 1.0, v244
v_mfma_f32_16x16x32_bf16 v[128:131], a[184:187], v[172:175], v[128:131]
v_add_f32 v245, 1.0, v245
v_add_f32 v246, 1.0, v246
v_mfma_f32_16x16x32_bf16 v[136:139], a[184:187], v[176:179], v[136:139]
ds_read_b128 v[84:87], v221 offset:26624
v_add_f32 v247, 1.0, v247
v_mfma_f32_16x16x32_bf16 v[144:147], a[184:187], v[180:183], v[144:147]
buffer_load_dwordx4 v7, s[16:19], s99 offen offset:1024  lds
v_mfma_f32_16x16x32_bf16 v[124:127], a[188:191], v[168:171], v[124:127]
ds_read_b128 v[88:91], v221 offset:28672
v_mfma_f32_16x16x32_bf16 v[132:135], a[188:191], v[172:175], v[132:135]
v_rcp_f32 v240, v240
v_mfma_f32_16x16x32_bf16 v[140:143], a[188:191], v[176:179], v[140:143]
ds_read_b128 v[92:95], v221 offset:30720
v_mfma_f32_16x16x32_bf16 v[148:151], a[188:191], v[180:183], v[148:151]
s_xor_b32 s72, s100, 53248
buffer_load_dwordx4 a[208:211], v1, s[24:27], s72 offen offset:0 sc1
buffer_load_dwordx4 a[212:215], v1, s[24:27], s72 offen offset:1024 sc1
buffer_load_dwordx4 a[216:219], v1, s[24:27], s72 offen offset:2048 sc1
buffer_load_dwordx4 a[220:223], v1, s[24:27], s72 offen offset:3072 sc1
s_xor_b32 s72, s100, 57344
buffer_load_dwordx4 a[224:227], v1, s[24:27], s72 offen offset:0 sc1
s_waitcnt vmcnt(11) lgkmcnt(4)
s_barrier
v_mfma_f32_16x16x32_bf16 v[120:123], a[192:195], v[64:67], v[120:123]
ds_read_b128 v[152:155], v222 offset:8192
v_mfma_f32_16x16x32_bf16 v[128:131], a[192:195], v[68:71], v[128:131]
v_rcp_f32 v241, v241
v_mfma_f32_16x16x32_bf16 v[136:139], a[192:195], v[72:75], v[136:139]
buffer_load_dwordx4 a[228:231], v1, s[24:27], s72 offen offset:1024 sc1
v_mfma_f32_16x16x32_bf16 v[144:147], a[192:195], v[76:79], v[144:147]
ds_read_b128 v[156:159], v222 offset:10240
v_mfma_f32_16x16x32_bf16 v[124:127], a[196:199], v[64:67], v[124:127]
ds_read_b128 v[160:163], v222 offset:12288
v_mfma_f32_16x16x32_bf16 v[132:135], a[196:199], v[68:71], v[132:135]
v_rcp_f32 v242, v242
v_mfma_f32_16x16x32_bf16 v[140:143], a[196:199], v[72:75], v[140:143]
buffer_load_dwordx4 a[232:235], v1, s[24:27], s72 offen offset:2048 sc1
v_mfma_f32_16x16x32_bf16 v[148:151], a[196:199], v[76:79], v[148:151]
ds_read_b128 v[164:167], v222 offset:14336
s_waitcnt vmcnt(11) lgkmcnt(4)
v_mfma_f32_16x16x32_bf16 v[120:123], a[200:203], v[80:83], v[120:123]
ds_read_b128 v[168:171], v223 offset:8192
v_mfma_f32_16x16x32_bf16 v[128:131], a[200:203], v[84:87], v[128:131]
v_rcp_f32 v243, v243
v_mfma_f32_16x16x32_bf16 v[136:139], a[200:203], v[88:91], v[136:139]
ds_read_b128 v[172:175], v223 offset:10240
v_mfma_f32_16x16x32_bf16 v[144:147], a[200:203], v[92:95], v[144:147]
buffer_load_dwordx4 a[236:239], v1, s[24:27], s72 offen offset:3072 sc1
s_add_u32 m0, s46, 8192
v_mfma_f32_16x16x32_bf16 v[124:127], a[204:207], v[80:83], v[124:127]
ds_read_b128 v[176:179], v223 offset:12288
v_mfma_f32_16x16x32_bf16 v[132:135], a[204:207], v[84:87], v[132:135]
v_rcp_f32 v244, v244
v_mfma_f32_16x16x32_bf16 v[140:143], a[204:207], v[88:91], v[140:143]
ds_read_b128 v[180:183], v223 offset:14336
v_mfma_f32_16x16x32_bf16 v[148:151], a[204:207], v[92:95], v[148:151]
buffer_load_dwordx4 v4, s[4:7], s55 offen lds
buffer_load_dwordx4 v5, s[4:7], s55 offen offset:1024 lds
s_add_u32 m0, s46, 130944
s_nop 0
buffer_load_dwordx4 v6, s[16:19], s99 offen offset:128  lds
buffer_load_dwordx4 v7, s[16:19], s99 offen offset:1152  lds
s_xor_b32 s72, s100, 61440
buffer_load_dwordx4 a[240:243], v1, s[24:27], s72 offen offset:0 sc1
s_waitcnt vmcnt(11) lgkmcnt(4)
v_mfma_f32_16x16x32_bf16 v[120:123], a[208:211], v[152:155], v[120:123]
ds_read_b128 v[64:67], v222 offset:49152
v_mfma_f32_16x16x32_bf16 v[128:131], a[208:211], v[156:159], v[128:131]
v_rcp_f32 v245, v245
v_mfma_f32_16x16x32_bf16 v[136:139], a[208:211], v[160:163], v[136:139]
ds_read_b128 v[68:71], v222 offset:51200
v_mfma_f32_16x16x32_bf16 v[144:147], a[208:211], v[164:167], v[144:147]
buffer_load_dwordx4 a[244:247], v1, s[24:27], s72 offen offset:1024 sc1
v_mfma_f32_16x16x32_bf16 v[124:127], a[212:215], v[152:155], v[124:127]
ds_read_b128 v[72:75], v222 offset:53248
v_mfma_f32_16x16x32_bf16 v[132:135], a[212:215], v[156:159], v[132:135]
v_rcp_f32 v246, v246
v_mfma_f32_16x16x32_bf16 v[140:143], a[212:215], v[160:163], v[140:143]
ds_read_b128 v[76:79], v222 offset:55296
v_mfma_f32_16x16x32_bf16 v[148:151], a[212:215], v[164:167], v[148:151]
s_waitcnt vmcnt(10) lgkmcnt(4)
v_mfma_f32_16x16x32_bf16 v[120:123], a[216:219], v[168:171], v[120:123]
buffer_load_dwordx4 a[248:251], v1, s[24:27], s72 offen offset:2048 sc1
v_mfma_f32_16x16x32_bf16 v[128:131], a[216:219], v[172:175], v[128:131]
ds_read_b128 v[80:83], v223 offset:49152
v_mfma_f32_16x16x32_bf16 v[136:139], a[216:219], v[176:179], v[136:139]
ds_read_b128 v[84:87], v223 offset:51200
v_mfma_f32_16x16x32_bf16 v[144:147], a[216:219], v[180:183], v[144:147]
v_rcp_f32 v247, v247
v_mfma_f32_16x16x32_bf16 v[124:127], a[220:223], v[168:171], v[124:127]
buffer_load_dwordx4 a[252:255], v1, s[24:27], s72 offen offset:3072 sc1
s_add_u32 m0, s46, 139008
v_mfma_f32_16x16x32_bf16 v[132:135], a[220:223], v[172:175], v[132:135]
ds_read_b128 v[88:91], v223 offset:53248
v_mul_f32 v200, v200, v240
v_mfma_f32_16x16x32_bf16 v[140:143], a[220:223], v[176:179], v[140:143]
ds_read_b128 v[92:95], v223 offset:55296
v_mul_f32 v201, v201, v241
v_mfma_f32_16x16x32_bf16 v[148:151], a[220:223], v[180:183], v[148:151]
v_mul_f32 v202, v202, v242
s_waitcnt vmcnt(10) lgkmcnt(4)
s_barrier
v_mfma_f32_16x16x32_bf16 v[120:123], a[224:227], v[64:67], v[120:123]
buffer_load_dwordx4 v6, s[16:19], s99 offen offset:256  lds
v_mfma_f32_16x16x32_bf16 v[128:131], a[224:227], v[68:71], v[128:131]
ds_read_b128 v[152:155], v222 offset:57344
v_mul_f32 v203, v203, v243
v_mfma_f32_16x16x32_bf16 v[136:139], a[224:227], v[72:75], v[136:139]
ds_read_b128 v[156:159], v222 offset:59392
v_mul_f32 v204, v204, v244
v_mfma_f32_16x16x32_bf16 v[144:147], a[224:227], v[76:79], v[144:147]
v_mul_f32 v205, v205, v245
v_mul_f32 v206, v206, v246
v_mfma_f32_16x16x32_bf16 v[124:127], a[228:231], v[64:67], v[124:127]
buffer_load_dwordx4 v7, s[16:19], s99 offen offset:1280  lds
s_add_u32 m0, s46, 40576
v_mfma_f32_16x16x32_bf16 v[132:135], a[228:231], v[68:71], v[132:135]
ds_read_b128 v[160:163], v222 offset:61440
v_mul_f32 v207, v207, v247
v_mfma_f32_16x16x32_bf16 v[140:143], a[228:231], v[72:75], v[140:143]
ds_read_b128 v[164:167], v222 offset:63488
v_mul_f32 v240, v208, v208
v_mfma_f32_16x16x32_bf16 v[148:151], a[228:231], v[76:79], v[148:151]
v_mul_f32 v241, v209, v209
s_waitcnt vmcnt(10) lgkmcnt(4)
v_mfma_f32_16x16x32_bf16 v[120:123], a[232:235], v[80:83], v[120:123]
buffer_load_dwordx4 v6, s[16:19], s99 offen offset:384  lds
v_mfma_f32_16x16x32_bf16 v[128:131], a[232:235], v[84:87], v[128:131]
ds_read_b128 v[168:171], v223 offset:57344
v_mul_f32 v242, v210, v210
v_mfma_f32_16x16x32_bf16 v[136:139], a[232:235], v[88:91], v[136:139]
ds_read_b128 v[172:175], v223 offset:59392
v_mul_f32 v243, v211, v211
v_mfma_f32_16x16x32_bf16 v[144:147], a[232:235], v[92:95], v[144:147]
v_mul_f32 v244, v212, v212
v_mul_f32 v245, v213, v213
v_mfma_f32_16x16x32_bf16 v[124:127], a[236:239], v[80:83], v[124:127]
buffer_load_dwordx4 v7, s[16:19], s99 offen offset:1408  lds
s_add_u32 m0, s46, 147456
v_mfma_f32_16x16x32_bf16 v[132:135], a[236:239], v[84:87], v[132:135]
ds_read_b128 v[176:179], v223 offset:61440
v_mul_f32 v246, v214, v214
v_mfma_f32_16x16x32_bf16 v[140:143], a[236:239], v[88:91], v[140:143]
ds_read_b128 v[180:183], v223 offset:63488
v_mul_f32 v247, v215, v215
v_mfma_f32_16x16x32_bf16 v[148:151], a[236:239], v[92:95], v[148:151]
v_fma_f32 v240, v240, v238, v239
s_xor_b32 s99, s98, 512
buffer_load_dwordx4 v6, s[16:19], s99 offen offset:0  lds
buffer_load_dwordx4 v7, s[16:19], s99 offen offset:1024  lds
s_add_u32 m0, s46, 155520
s_nop 0
buffer_load_dwordx4 v6, s[16:19], s99 offen offset:128  lds
buffer_load_dwordx4 v7, s[16:19], s99 offen offset:1152  lds
s_add_u32 m0, s46, 48896
s_nop 0
buffer_load_dwordx4 v6, s[16:19], s99 offen offset:256  lds
s_waitcnt vmcnt(11) lgkmcnt(4)
v_mfma_f32_16x16x32_bf16 v[120:123], a[240:243], v[152:155], v[120:123]
ds_read_b128 v[64:67], v220 offset:32768
v_fma_f32 v241, v241, v238, v239
v_mfma_f32_16x16x32_bf16 v[128:131], a[240:243], v[156:159], v[128:131]
v_fma_f32 v242, v242, v238, v239
v_fma_f32 v243, v243, v238, v239
v_mfma_f32_16x16x32_bf16 v[136:139], a[240:243], v[160:163], v[136:139]
ds_read_b128 v[68:71], v220 offset:34816
v_fma_f32 v244, v244, v238, v239
v_mfma_f32_16x16x32_bf16 v[144:147], a[240:243], v[164:167], v[144:147]
buffer_load_dwordx4 v7, s[16:19], s99 offen offset:1280  lds
s_add_u32 m0, s46, 81536
v_mfma_f32_16x16x32_bf16 v[124:127], a[244:247], v[152:155], v[124:127]
ds_read_b128 v[72:75], v220 offset:36864
v_fma_f32 v245, v245, v238, v239
v_mfma_f32_16x16x32_bf16 v[132:135], a[244:247], v[156:159], v[132:135]
v_fma_f32 v246, v246, v238, v239
v_fma_f32 v247, v247, v238, v239
v_mfma_f32_16x16x32_bf16 v[140:143], a[244:247], v[160:163], v[140:143]
ds_read_b128 v[76:79], v220 offset:38912
v_mul_f32 v240, v240, v208
v_mfma_f32_16x16x32_bf16 v[148:151], a[244:247], v[164:167], v[148:151]
v_mul_f32 v241, v241, v209
s_waitcnt vmcnt(10) lgkmcnt(4)
v_mfma_f32_16x16x32_bf16 v[120:123], a[248:251], v[168:171], v[120:123]
buffer_load_dwordx4 v6, s[16:19], s99 offen offset:384  lds
v_mfma_f32_16x16x32_bf16 v[128:131], a[248:251], v[172:175], v[128:131]
ds_read_b128 v[80:83], v221 offset:32768
v_mul_f32 v242, v242, v210
v_mfma_f32_16x16x32_bf16 v[136:139], a[248:251], v[176:179], v[136:139]
ds_read_b128 v[84:87], v221 offset:34816
v_mul_f32 v243, v243, v211
v_mfma_f32_16x16x32_bf16 v[144:147], a[248:251], v[180:183], v[144:147]
v_mul_f32 v244, v244, v212
v_mul_f32 v245, v245, v213
v_mfma_f32_16x16x32_bf16 v[124:127], a[252:255], v[168:171], v[124:127]
buffer_load_dwordx4 v7, s[16:19], s99 offen offset:1408  lds
s_add_u32 m0, s46, 90112
v_mfma_f32_16x16x32_bf16 v[132:135], a[252:255], v[172:175], v[132:135]
ds_read_b128 v[88:91], v221 offset:36864
v_mul_f32 v246, v246, v214
v_mfma_f32_16x16x32_bf16 v[140:143], a[252:255], v[176:179], v[140:143]
ds_read_b128 v[92:95], v221 offset:38912
v_mul_f32 v247, v247, v215
v_mfma_f32_16x16x32_bf16 v[148:151], a[252:255], v[180:183], v[148:151]
s_xor_b32 s99, s98, 1024
buffer_load_dwordx4 v6, s[16:19], s99 offen offset:0  lds
s_waitcnt vmcnt(11) lgkmcnt(4)
s_barrier
v_mfma_f32_16x16x32_bf16 v[32:35], a[0:3], v[64:67], 0
ds_read_b128 v[152:155], v224 offset:0
v_mfma_f32_16x16x32_bf16 v[40:43], a[0:3], v[68:71], 0
v_exp_f32 v240, v240
v_mfma_f32_16x16x32_bf16 v[48:51], a[0:3], v[72:75], 0
ds_read_b128 v[156:159], v224 offset:2048
v_cvt_pk_bf16_f32 v120, v120, v121
v_cvt_pk_bf16_f32 v121, v122, v123
v_mfma_f32_16x16x32_bf16 v[56:59], a[0:3], v[76:79], 0
buffer_load_dwordx4 v7, s[16:19], s99 offen offset:1024  lds
s_add_u32 m0, s46, 57216
v_mfma_f32_16x16x32_bf16 v[36:39], a[4:7], v[64:67], 0
ds_read_b128 v[160:163], v224 offset:4096
v_cvt_pk_bf16_f32 v122, v124, v125
v_cvt_pk_bf16_f32 v123, v126, v127
v_mfma_f32_16x16x32_bf16 v[44:47], a[4:7], v[68:71], 0
buffer_store_dwordx4 v[120:123], v1, s[24:27], s87 offen offset:0 sc1
v_cvt_pk_bf16_f32 v128, v128, v129
v_mfma_f32_16x16x32_bf16 v[52:55], a[4:7], v[72:75], 0
ds_read_b128 v[164:167], v224 offset:6144
v_cvt_pk_bf16_f32 v129, v130, v131
v_cvt_pk_bf16_f32 v130, v132, v133
v_mfma_f32_16x16x32_bf16 v[60:63], a[4:7], v[76:79], 0
v_cvt_pk_bf16_f32 v131, v134, v135
s_waitcnt lgkmcnt(4)
v_mfma_f32_16x16x32_bf16 v[32:35], a[8:11], v[80:83], v[32:35]
ds_read_b128 v[168:171], v225 offset:0
buffer_store_dwordx4 v[128:131], v1, s[24:27], s87 offen offset:1024 sc1
v_mfma_f32_16x16x32_bf16 v[40:43], a[8:11], v[84:87], v[40:43]
v_cvt_pk_bf16_f32 v136, v136, v137
v_cvt_pk_bf16_f32 v137, v138, v139
v_cvt_pk_bf16_f32 v138, v140, v141
v_mfma_f32_16x16x32_bf16 v[48:51], a[8:11], v[88:91], v[48:51]
ds_read_b128 v[172:175], v225 offset:2048
v_cvt_pk_bf16_f32 v139, v142, v143
v_mfma_f32_16x16x32_bf16 v[56:59], a[8:11], v[92:95], v[56:59]
buffer_store_dwordx4 v[136:139], v1, s[24:27], s87 offen offset:2048 sc1
v_cvt_pk_bf16_f32 v144, v144, v145
v_mfma_f32_16x16x32_bf16 v[36:39], a[12:15], v[80:83], v[36:39]
ds_read_b128 v[176:179], v225 offset:4096
v_cvt_pk_bf16_f32 v145, v146, v147
v_cvt_pk_bf16_f32 v146, v148, v149
v_mfma_f32_16x16x32_bf16 v[44:47], a[12:15], v[84:87], v[44:47]
v_cvt_pk_bf16_f32 v147, v150, v151
buffer_store_dwordx4 v[144:147], v1, s[24:27], s87 offen offset:3072 sc1
v_mfma_f32_16x16x32_bf16 v[52:55], a[12:15], v[88:91], v[52:55]
ds_read_b128 v[180:183], v225 offset:6144
v_mfma_f32_16x16x32_bf16 v[60:63], a[12:15], v[92:95], v[60:63]
s_waitcnt lgkmcnt(4)
v_mfma_f32_16x16x32_bf16 v[32:35], a[16:19], v[152:155], v[32:35]
ds_read_b128 v[64:67], v224 offset:8192
v_mfma_f32_16x16x32_bf16 v[40:43], a[16:19], v[156:159], v[40:43]
v_exp_f32 v241, v241
v_mfma_f32_16x16x32_bf16 v[48:51], a[16:19], v[160:163], v[48:51]
ds_read_b128 v[68:71], v224 offset:10240
v_mfma_f32_16x16x32_bf16 v[56:59], a[16:19], v[164:167], v[56:59]
buffer_load_dwordx4 v6, s[16:19], s99 offen offset:128  lds
v_mfma_f32_16x16x32_bf16 v[36:39], a[20:23], v[152:155], v[36:39]
ds_read_b128 v[72:75], v224 offset:12288
v_mfma_f32_16x16x32_bf16 v[44:47], a[20:23], v[156:159], v[44:47]
v_exp_f32 v242, v242
v_mfma_f32_16x16x32_bf16 v[52:55], a[20:23], v[160:163], v[52:55]
ds_read_b128 v[76:79], v224 offset:14336
v_mfma_f32_16x16x32_bf16 v[60:63], a[20:23], v[164:167], v[60:63]
s_waitcnt lgkmcnt(4)
v_mfma_f32_16x16x32_bf16 v[32:35], a[24:27], v[168:171], v[32:35]
buffer_load_dwordx4 v7, s[16:19], s99 offen offset:1152  lds
s_add_u32 m0, s46, 16128
v_mfma_f32_16x16x32_bf16 v[40:43], a[24:27], v[172:175], v[40:43]
ds_read_b128 v[80:83], v225 offset:8192
v_mfma_f32_16x16x32_bf16 v[48:51], a[24:27], v[176:179], v[48:51]
ds_read_b128 v[84:87], v225 offset:10240
v_mfma_f32_16x16x32_bf16 v[56:59], a[24:27], v[180:183], v[56:59]
v_exp_f32 v243, v243
v_mfma_f32_16x16x32_bf16 v[36:39], a[28:31], v[168:171], v[36:39]
ds_read_b128 v[88:91], v225 offset:12288
v_mfma_f32_16x16x32_bf16 v[44:47], a[28:31], v[172:175], v[44:47]
buffer_load_dwordx4 v6, s[16:19], s99 offen offset:256  lds
v_mfma_f32_16x16x32_bf16 v[52:55], a[28:31], v[176:179], v[52:55]
ds_read_b128 v[92:95], v225 offset:14336
v_mfma_f32_16x16x32_bf16 v[60:63], a[28:31], v[180:183], v[60:63]
s_waitcnt vmcnt(15) lgkmcnt(4)
s_barrier
v_mfma_f32_16x16x32_bf16 v[32:35], a[32:35], v[64:67], v[32:35]
ds_read_b128 v[152:155], v220 offset:40960
v_mfma_f32_16x16x32_bf16 v[40:43], a[32:35], v[68:71], v[40:43]
buffer_load_dwordx4 v7, s[16:19], s99 offen offset:1280  lds
s_add_u32 m0, s46, 97920
v_mfma_f32_16x16x32_bf16 v[48:51], a[32:35], v[72:75], v[48:51]
ds_read_b128 v[156:159], v220 offset:43008
v_mfma_f32_16x16x32_bf16 v[56:59], a[32:35], v[76:79], v[56:59]
v_exp_f32 v244, v244
v_mfma_f32_16x16x32_bf16 v[36:39], a[36:39], v[64:67], v[36:39]
ds_read_b128 v[160:163], v220 offset:45056
v_mfma_f32_16x16x32_bf16 v[44:47], a[36:39], v[68:71], v[44:47]
v_exp_f32 v245, v245
v_mfma_f32_16x16x32_bf16 v[52:55], a[36:39], v[72:75], v[52:55]
buffer_load_dwordx4 v6, s[16:19], s99 offen offset:384  lds
v_mfma_f32_16x16x32_bf16 v[60:63], a[36:39], v[76:79], v[60:63]
ds_read_b128 v[164:167], v220 offset:47104
s_waitcnt lgkmcnt(4)
v_mfma_f32_16x16x32_bf16 v[32:35], a[40:43], v[80:83], v[32:35]
ds_read_b128 v[168:171], v221 offset:40960
v_mfma_f32_16x16x32_bf16 v[40:43], a[40:43], v[84:87], v[40:43]
v_exp_f32 v246, v246
v_mfma_f32_16x16x32_bf16 v[48:51], a[40:43], v[88:91], v[48:51]
ds_read_b128 v[172:175], v221 offset:43008
v_mfma_f32_16x16x32_bf16 v[56:59], a[40:43], v[92:95], v[56:59]
buffer_load_dwordx4 v7, s[16:19], s99 offen offset:1408  lds
s_add_u32 m0, s46, 65536
v_mfma_f32_16x16x32_bf16 v[36:39], a[44:47], v[80:83], v[36:39]
ds_read_b128 v[176:179], v221 offset:45056
v_mfma_f32_16x16x32_bf16 v[44:47], a[44:47], v[84:87], v[44:47]
v_exp_f32 v247, v247
v_mfma_f32_16x16x32_bf16 v[52:55], a[44:47], v[88:91], v[52:55]
ds_read_b128 v[180:183], v221 offset:47104
v_add_f32 v240, 1.0, v240
v_mfma_f32_16x16x32_bf16 v[60:63], a[44:47], v[92:95], v[60:63]
v_add_f32 v241, 1.0, v241
s_waitcnt lgkmcnt(4)
v_mfma_f32_16x16x32_bf16 v[32:35], a[48:51], v[152:155], v[32:35]
s_xor_b32 s99, s98, 1536
buffer_load_dwordx4 v6, s[16:19], s99 offen offset:0  lds
v_mfma_f32_16x16x32_bf16 v[40:43], a[48:51], v[156:159], v[40:43]
ds_read_b128 v[64:67], v224 offset:16384
v_add_f32 v242, 1.0, v242
v_mfma_f32_16x16x32_bf16 v[48:51], a[48:51], v[160:163], v[48:51]
ds_read_b128 v[68:71], v224 offset:18432
v_add_f32 v243, 1.0, v243
v_mfma_f32_16x16x32_bf16 v[56:59], a[48:51], v[164:167], v[56:59]
v_add_f32 v244, 1.0, v244
v_add_f32 v245, 1.0, v245
v_mfma_f32_16x16x32_bf16 v[36:39], a[52:55], v[152:155], v[36:39]
ds_read_b128 v[72:75], v224 offset:20480
v_add_f32 v246, 1.0, v246
v_mfma_f32_16x16x32_bf16 v[44:47], a[52:55], v[156:159], v[44:47]
v_add_f32 v247, 1.0, v247
v_mfma_f32_16x16x32_bf16 v[52:55], a[52:55], v[160:163], v[52:55]
ds_read_b128 v[76:79], v224 offset:22528
v_mfma_f32_16x16x32_bf16 v[60:63], a[52:55], v[164:167], v[60:63]
s_waitcnt lgkmcnt(4)
v_mfma_f32_16x16x32_bf16 v[32:35], a[56:59], v[168:171], v[32:35]
ds_read_b128 v[80:83], v225 offset:16384
v_mfma_f32_16x16x32_bf16 v[40:43], a[56:59], v[172:175], v[40:43]
v_rcp_f32 v240, v240
v_mfma_f32_16x16x32_bf16 v[48:51], a[56:59], v[176:179], v[48:51]
ds_read_b128 v[84:87], v225 offset:18432
v_mfma_f32_16x16x32_bf16 v[56:59], a[56:59], v[180:183], v[56:59]
v_rcp_f32 v241, v241
v_mfma_f32_16x16x32_bf16 v[36:39], a[60:63], v[168:171], v[36:39]
ds_read_b128 v[88:91], v225 offset:20480
v_mfma_f32_16x16x32_bf16 v[44:47], a[60:63], v[172:175], v[44:47]
v_rcp_f32 v242, v242
v_mfma_f32_16x16x32_bf16 v[52:55], a[60:63], v[176:179], v[52:55]
ds_read_b128 v[92:95], v225 offset:22528
v_mfma_f32_16x16x32_bf16 v[60:63], a[60:63], v[180:183], v[60:63]
s_waitcnt vmcnt(15) lgkmcnt(4)
s_barrier
v_mfma_f32_16x16x32_bf16 v[32:35], a[64:67], v[64:67], v[32:35]
buffer_load_dwordx4 v7, s[16:19], s99 offen offset:1024  lds
s_add_u32 m0, s46, 106368
v_mfma_f32_16x16x32_bf16 v[40:43], a[64:67], v[68:71], v[40:43]
ds_read_b128 v[152:155], v224 offset:24576
v_mfma_f32_16x16x32_bf16 v[48:51], a[64:67], v[72:75], v[48:51]
ds_read_b128 v[156:159], v224 offset:26624
v_mfma_f32_16x16x32_bf16 v[56:59], a[64:67], v[76:79], v[56:59]
v_rcp_f32 v243, v243
v_mfma_f32_16x16x32_bf16 v[36:39], a[68:71], v[64:67], v[36:39]
ds_read_b128 v[160:163], v224 offset:28672
v_mfma_f32_16x16x32_bf16 v[44:47], a[68:71], v[68:71], v[44:47]
v_rcp_f32 v244, v244
v_mfma_f32_16x16x32_bf16 v[52:55], a[68:71], v[72:75], v[52:55]
ds_read_b128 v[164:167], v224 offset:30720
v_mfma_f32_16x16x32_bf16 v[60:63], a[68:71], v[76:79], v[60:63]
s_waitcnt lgkmcnt(4)
v_mfma_f32_16x16x32_bf16 v[32:35], a[72:75], v[80:83], v[32:35]
ds_read_b128 v[168:171], v225 offset:24576
v_mfma_f32_16x16x32_bf16 v[40:43], a[72:75], v[84:87], v[40:43]
v_rcp_f32 v245, v245
v_mfma_f32_16x16x32_bf16 v[48:51], a[72:75], v[88:91], v[48:51]
ds_read_b128 v[172:175], v225 offset:26624
v_mfma_f32_16x16x32_bf16 v[56:59], a[72:75], v[92:95], v[56:59]
v_rcp_f32 v246, v246
v_mfma_f32_16x16x32_bf16 v[36:39], a[76:79], v[80:83], v[36:39]
ds_read_b128 v[176:179], v225 offset:28672
v_mfma_f32_16x16x32_bf16 v[44:47], a[76:79], v[84:87], v[44:47]
v_rcp_f32 v247, v247
v_mfma_f32_16x16x32_bf16 v[52:55], a[76:79], v[88:91], v[52:55]
ds_read_b128 v[180:183], v225 offset:30720
v_mul_f32 v208, v208, v240
v_mfma_f32_16x16x32_bf16 v[60:63], a[76:79], v[92:95], v[60:63]
v_mul_f32 v209, v209, v241
s_waitcnt lgkmcnt(4)
v_mfma_f32_16x16x32_bf16 v[32:35], a[80:83], v[152:155], v[32:35]
buffer_load_dwordx4 v6, s[16:19], s99 offen offset:128  lds
v_mfma_f32_16x16x32_bf16 v[40:43], a[80:83], v[156:159], v[40:43]
ds_read_b128 v[64:67], v220 offset:49152
v_mul_f32 v210, v210, v242
v_mfma_f32_16x16x32_bf16 v[48:51], a[80:83], v[160:163], v[48:51]
ds_read_b128 v[68:71], v220 offset:51200
v_mul_f32 v211, v211, v243
v_mfma_f32_16x16x32_bf16 v[56:59], a[80:83], v[164:167], v[56:59]
v_mul_f32 v212, v212, v244
v_mul_f32 v213, v213, v245
v_mfma_f32_16x16x32_bf16 v[36:39], a[84:87], v[152:155], v[36:39]
ds_read_b128 v[72:75], v220 offset:53248
v_mul_f32 v214, v214, v246
v_mfma_f32_16x16x32_bf16 v[44:47], a[84:87], v[156:159], v[44:47]
v_mul_f32 v215, v215, v247
v_lshlrev_b32 v233, 16, v26
v_mfma_f32_16x16x32_bf16 v[52:55], a[84:87], v[160:163], v[52:55]
ds_read_b128 v[76:79], v220 offset:55296
v_mov_b32 v232, v22
v_mfma_f32_16x16x32_bf16 v[60:63], a[84:87], v[164:167], v[60:63]
v_mul_f32 v233, v233, v22
s_waitcnt lgkmcnt(4)
v_mfma_f32_16x16x32_bf16 v[32:35], a[88:91], v[168:171], v[32:35]
ds_read_b128 v[80:83], v221 offset:49152
v_lshlrev_b32 v235, 16, v27
v_mfma_f32_16x16x32_bf16 v[40:43], a[88:91], v[172:175], v[40:43]
v_mov_b32 v234, v23
v_mul_f32 v235, v235, v23
v_mfma_f32_16x16x32_bf16 v[48:51], a[88:91], v[176:179], v[48:51]
ds_read_b128 v[84:87], v221 offset:51200
v_lshlrev_b32 v237, 16, v28
v_mfma_f32_16x16x32_bf16 v[56:59], a[88:91], v[180:183], v[56:59]
v_mov_b32 v236, v24
v_mul_f32 v237, v237, v24
v_mfma_f32_16x16x32_bf16 v[36:39], a[92:95], v[168:171], v[36:39]
ds_read_b128 v[88:91], v221 offset:53248
v_lshlrev_b32 v239, 16, v29
v_mfma_f32_16x16x32_bf16 v[44:47], a[92:95], v[172:175], v[44:47]
v_mov_b32 v238, v25
v_mul_f32 v239, v239, v25
v_mfma_f32_16x16x32_bf16 v[52:55], a[92:95], v[176:179], v[52:55]
ds_read_b128 v[92:95], v221 offset:55296
v_and_b32 v25, 15, v0
v_mfma_f32_16x16x32_bf16 v[60:63], a[92:95], v[180:183], v[60:63]
v_lshrrev_b32 v26, 5, v0
s_waitcnt vmcnt(13) lgkmcnt(4)
s_barrier
v_mfma_f32_16x16x32_bf16 v[32:35], a[96:99], v[64:67], v[32:35]
buffer_load_dwordx4 v7, s[16:19], s99 offen offset:1152  lds
s_add_u32 m0, s46, 24320
v_mfma_f32_16x16x32_bf16 v[40:43], a[96:99], v[68:71], v[40:43]
ds_read_b128 v[152:155], v222 offset:16384
v_and_b32 v27, 7, v0
v_mfma_f32_16x16x32_bf16 v[48:51], a[96:99], v[72:75], v[48:51]
ds_read_b128 v[156:159], v222 offset:18432
s_waitcnt vmcnt(10)
buffer_store_dword v226, v227, s[24:27], s89 offen sc1
v_mfma_f32_16x16x32_bf16 v[56:59], a[96:99], v[76:79], v[56:59]
v_xor_b32 v26, v26, v27
v_lshlrev_b32 v26, 4, v26
v_mfma_f32_16x16x32_bf16 v[36:39], a[100:103], v[64:67], v[36:39]
ds_read_b128 v[160:163], v222 offset:20480
v_lshl_add_u32 v26, v25, 7, v26
v_mfma_f32_16x16x32_bf16 v[44:47], a[100:103], v[68:71], v[44:47]
v_bfe_u32 v27, v0, 4, 1
v_lshl_add_u32 v26, v27, 3, v26
v_mfma_f32_16x16x32_bf16 v[52:55], a[100:103], v[72:75], v[52:55]
ds_read_b128 v[164:167], v222 offset:22528
s_add_u32 s56, s46, 8192
v_mfma_f32_16x16x32_bf16 v[60:63], a[100:103], v[76:79], v[60:63]
v_add_u32 v24, s56, v26
s_waitcnt lgkmcnt(4)
v_mfma_f32_16x16x32_bf16 v[32:35], a[104:107], v[80:83], v[32:35]
buffer_load_dwordx4 v6, s[16:19], s99 offen offset:256  lds
v_mfma_f32_16x16x32_bf16 v[40:43], a[104:107], v[84:87], v[40:43]
ds_read_b128 v[168:171], v223 offset:16384
v_xor_b32 v25, 32, v24
v_mfma_f32_16x16x32_bf16 v[48:51], a[104:107], v[88:91], v[48:51]
ds_read_b128 v[172:175], v223 offset:18432
v_xor_b32 v26, 64, v24
v_mfma_f32_16x16x32_bf16 v[56:59], a[104:107], v[92:95], v[56:59]
v_xor_b32 v27, 96, v24
v_add_u32 v28, s56, v1
v_mfma_f32_16x16x32_bf16 v[36:39], a[108:111], v[80:83], v[36:39]
ds_read_b128 v[176:179], v223 offset:20480
s_lshl_b32 s56, s40, 5
v_mfma_f32_16x16x32_bf16 v[44:47], a[108:111], v[84:87], v[44:47]
buffer_load_dwordx4 v7, s[16:19], s99 offen offset:1280  lds
s_add_u32 m0, s46, 73344
v_mfma_f32_16x16x32_bf16 v[52:55], a[108:111], v[88:91], v[52:55]
ds_read_b128 v[180:183], v223 offset:22528
v_xor_b32 v29, s56, v18
v_mfma_f32_16x16x32_bf16 v[60:63], a[108:111], v[92:95], v[60:63]
v_xor_b32 v12, 0, v29
s_waitcnt lgkmcnt(4)
v_mfma_f32_16x16x32_bf16 v[32:35], a[112:115], v[152:155], v[32:35]
ds_read_b128 v[64:67], v222 offset:24576
v_xor_b32 v13, 32, v29
v_mfma_f32_16x16x32_bf16 v[40:43], a[112:115], v[156:159], v[40:43]
v_xor_b32 v14, 64, v29
v_xor_b32 v15, 96, v29
v_mfma_f32_16x16x32_bf16 v[48:51], a[112:115], v[160:163], v[48:51]
buffer_load_dwordx4 v6, s[16:19], s99 offen offset:384  lds
v_mfma_f32_16x16x32_bf16 v[56:59], a[112:115], v[164:167], v[56:59]
ds_read_b128 v[68:71], v222 offset:26624
v_xor_b32 v16, 65536, v29
v_mfma_f32_16x16x32_bf16 v[36:39], a[116:119], v[152:155], v[36:39]
ds_read_b128 v[72:75], v222 offset:28672
v_xor_b32 v17, 65568, v29
v_mfma_f32_16x16x32_bf16 v[44:47], a[116:119], v[156:159], v[44:47]
v_xor_b32 v18, 65600, v29
v_xor_b32 v19, 65632, v29
v_mfma_f32_16x16x32_bf16 v[52:55], a[116:119], v[160:163], v[52:55]
ds_read_b128 v[76:79], v222 offset:30720
v_xor_b32 v20, 131072, v29
v_mfma_f32_16x16x32_bf16 v[60:63], a[116:119], v[164:167], v[60:63]
v_xor_b32 v21, 131104, v29
s_waitcnt lgkmcnt(4)
v_mfma_f32_16x16x32_bf16 v[32:35], a[120:123], v[168:171], v[32:35]
buffer_load_dwordx4 v7, s[16:19], s99 offen offset:1408  lds
s_add_u32 m0, s46, 114688
v_mfma_f32_16x16x32_bf16 v[40:43], a[120:123], v[172:175], v[40:43]
ds_read_b128 v[80:83], v223 offset:24576
v_xor_b32 v22, 131136, v29
v_mfma_f32_16x16x32_bf16 v[48:51], a[120:123], v[176:179], v[48:51]
ds_read_b128 v[84:87], v223 offset:26624
v_xor_b32 v23, 131168, v29
v_mfma_f32_16x16x32_bf16 v[56:59], a[120:123], v[180:183], v[56:59]
v_and_b32 v29, 2, v0
v_lshlrev_b32 v29, 10, v29
v_mfma_f32_16x16x32_bf16 v[36:39], a[124:127], v[168:171], v[36:39]
s_xor_b32 s60, s61, 0
buffer_load_dwordx4 v8, s[36:39], s60 offen offset:0  lds
v_mfma_f32_16x16x32_bf16 v[44:47], a[124:127], v[172:175], v[44:47]
ds_read_b128 v[88:91], v223 offset:28672
s_lshl2_add_u32 s56, s41, s40
v_mfma_f32_16x16x32_bf16 v[52:55], a[124:127], v[176:179], v[52:55]
ds_read_b128 v[92:95], v223 offset:30720
s_mul_i32 s56, s56, 28672
v_mfma_f32_16x16x32_bf16 v[60:63], a[124:127], v[180:183], v[60:63]
s_add_u32 s56, s56, 8388608
s_waitcnt vmcnt(12) lgkmcnt(4)
s_barrier
v_mfma_f32_16x16x32_bf16 v[32:35], a[128:131], v[64:67], v[32:35]
buffer_load_dwordx4 v9, s[36:39], s60 offen offset:1024  lds
s_add_u32 m0, s46, 122880
v_mfma_f32_16x16x32_bf16 v[40:43], a[128:131], v[68:71], v[40:43]
ds_read_b128 v[152:155], v220 offset:57344
s_mov_b32 s68, s56
v_mfma_f32_16x16x32_bf16 v[48:51], a[128:131], v[72:75], v[48:51]
ds_read_b128 v[156:159], v220 offset:59392
s_add_u32 s48, s47, 0
v_mfma_f32_16x16x32_bf16 v[56:59], a[128:131], v[76:79], v[56:59]
s_mul_i32 s57, s48, 37
s_lshr_b32 s57, s57, 8
v_mfma_f32_16x16x32_bf16 v[36:39], a[132:135], v[64:67], v[36:39]
ds_read_b128 v[160:163], v220 offset:61440
s_mul_i32 s57, s57, 7
v_mfma_f32_16x16x32_bf16 v[44:47], a[132:135], v[68:71], v[44:47]
s_xor_b32 s60, s61, 65536
buffer_load_dwordx4 v8, s[36:39], s60 offen offset:0  lds
v_mfma_f32_16x16x32_bf16 v[52:55], a[132:135], v[72:75], v[52:55]
ds_read_b128 v[164:167], v220 offset:63488
s_sub_u32 s48, s48, s57
v_mfma_f32_16x16x32_bf16 v[60:63], a[132:135], v[76:79], v[60:63]
s_lshl_b32 s48, s48, 12
s_waitcnt lgkmcnt(4)
v_mfma_f32_16x16x32_bf16 v[32:35], a[136:139], v[80:83], v[32:35]
ds_read_b128 v[168:171], v221 offset:57344
s_add_u32 s48, s48, s56
v_mfma_f32_16x16x32_bf16 v[40:43], a[136:139], v[84:87], v[40:43]
s_add_u32 s49, s47, 1
s_mul_i32 s57, s49, 37
v_mfma_f32_16x16x32_bf16 v[48:51], a[136:139], v[88:91], v[48:51]
buffer_load_dwordx4 v9, s[36:39], s60 offen offset:1024  lds
s_add_u32 m0, s46, 32768
v_mfma_f32_16x16x32_bf16 v[56:59], a[136:139], v[92:95], v[56:59]
ds_read_b128 v[172:175], v221 offset:59392
buffer_load_dword v219, v227, s[24:27], s88 offen sc1
v_mfma_f32_16x16x32_bf16 v[36:39], a[140:143], v[80:83], v[36:39]
ds_read_b128 v[176:179], v221 offset:61440
s_lshr_b32 s57, s57, 8
v_mfma_f32_16x16x32_bf16 v[44:47], a[140:143], v[84:87], v[44:47]
s_mul_i32 s57, s57, 7
s_sub_u32 s49, s49, s57
v_mfma_f32_16x16x32_bf16 v[52:55], a[140:143], v[88:91], v[52:55]
ds_read_b128 v[180:183], v221 offset:63488
s_lshl_b32 s49, s49, 12
v_mfma_f32_16x16x32_bf16 v[60:63], a[140:143], v[92:95], v[60:63]
s_add_u32 s49, s49, s56
s_waitcnt lgkmcnt(4)
v_mfma_f32_16x16x32_bf16 v[32:35], a[144:147], v[152:155], v[32:35]
ds_read_b128 v[64:67], v220 offset:16384
s_add_u32 s50, s47, 2
v_mfma_f32_16x16x32_bf16 v[40:43], a[144:147], v[156:159], v[40:43]
s_xor_b32 s60, s61, 131072
buffer_load_dwordx4 v8, s[36:39], s60 offen offset:0  lds
v_mfma_f32_16x16x32_bf16 v[48:51], a[144:147], v[160:163], v[48:51]
ds_read_b128 v[68:71], v220 offset:18432
s_mul_i32 s57, s50, 37
v_mfma_f32_16x16x32_bf16 v[56:59], a[144:147], v[164:167], v[56:59]
s_lshr_b32 s57, s57, 8
s_mul_i32 s57, s57, 7
v_mfma_f32_16x16x32_bf16 v[36:39], a[148:151], v[152:155], v[36:39]
ds_read_b128 v[72:75], v220 offset:20480
s_sub_u32 s50, s50, s57
v_mfma_f32_16x16x32_bf16 v[44:47], a[148:151], v[156:159], v[44:47]
buffer_load_dwordx4 v9, s[36:39], s60 offen offset:1024  lds
s_add_u32 m0, s46, 131072
v_mfma_f32_16x16x32_bf16 v[52:55], a[148:151], v[160:163], v[52:55]
ds_read_b128 v[76:79], v220 offset:22528
s_lshl_b32 s50, s50, 12
v_mfma_f32_16x16x32_bf16 v[60:63], a[148:151], v[164:167], v[60:63]
s_add_u32 s50, s50, s56
s_waitcnt lgkmcnt(4)
v_mfma_f32_16x16x32_bf16 v[32:35], a[152:155], v[168:171], v[32:35]
ds_read_b128 v[80:83], v221 offset:16384
s_add_u32 s51, s47, 3
v_mfma_f32_16x16x32_bf16 v[40:43], a[152:155], v[172:175], v[40:43]
s_xor_b32 s60, s61, 196608
buffer_load_dwordx4 v8, s[36:39], s60 offen offset:0  lds
v_mfma_f32_16x16x32_bf16 v[48:51], a[152:155], v[176:179], v[48:51]
ds_read_b128 v[84:87], v221 offset:18432
s_mul_i32 s57, s51, 37
v_mfma_f32_16x16x32_bf16 v[56:59], a[152:155], v[180:183], v[56:59]
s_lshr_b32 s57, s57, 8
s_mul_i32 s57, s57, 7
v_mfma_f32_16x16x32_bf16 v[36:39], a[156:159], v[168:171], v[36:39]
ds_read_b128 v[88:91], v221 offset:20480
s_sub_u32 s51, s51, s57
v_mfma_f32_16x16x32_bf16 v[44:47], a[156:159], v[172:175], v[44:47]
buffer_load_dwordx4 v9, s[36:39], s60 offen offset:1024  lds
s_add_u32 m0, s46, 139264
v_mfma_f32_16x16x32_bf16 v[52:55], a[156:159], v[176:179], v[52:55]
ds_read_b128 v[92:95], v221 offset:22528
s_lshl_b32 s51, s51, 12
v_mfma_f32_16x16x32_bf16 v[60:63], a[156:159], v[180:183], v[60:63]
s_add_u32 s51, s51, s56
s_waitcnt vmcnt(16) lgkmcnt(4)
s_barrier
v_mfma_f32_16x16x32_bf16 v[32:35], a[160:163], v[64:67], v[32:35]
s_xor_b32 s60, s61, 262144
buffer_load_dwordx4 v8, s[36:39], s60 offen offset:0  lds
v_mfma_f32_16x16x32_bf16 v[40:43], a[160:163], v[68:71], v[40:43]
ds_read_b128 v[152:155], v222 offset:32768
s_add_u32 s52, s47, 4
v_mfma_f32_16x16x32_bf16 v[48:51], a[160:163], v[72:75], v[48:51]
ds_read_b128 v[156:159], v222 offset:34816
s_mul_i32 s57, s52, 37
v_mfma_f32_16x16x32_bf16 v[56:59], a[160:163], v[76:79], v[56:59]
s_lshr_b32 s57, s57, 8
s_mul_i32 s57, s57, 7
v_mfma_f32_16x16x32_bf16 v[36:39], a[164:167], v[64:67], v[36:39]
ds_read_b128 v[160:163], v222 offset:36864
s_sub_u32 s52, s52, s57
v_mfma_f32_16x16x32_bf16 v[44:47], a[164:167], v[68:71], v[44:47]
buffer_load_dwordx4 v9, s[36:39], s60 offen offset:1024  lds
s_add_u32 m0, s46, 40960
v_mfma_f32_16x16x32_bf16 v[52:55], a[164:167], v[72:75], v[52:55]
ds_read_b128 v[164:167], v222 offset:38912
s_lshl_b32 s52, s52, 12
v_mfma_f32_16x16x32_bf16 v[60:63], a[164:167], v[76:79], v[60:63]
s_add_u32 s52, s52, s56
s_waitcnt lgkmcnt(4)
v_mfma_f32_16x16x32_bf16 v[32:35], a[168:171], v[80:83], v[32:35]
ds_read_b128 v[168:171], v223 offset:32768
s_add_u32 s53, s47, 5
v_mfma_f32_16x16x32_bf16 v[40:43], a[168:171], v[84:87], v[40:43]
s_mul_i32 s57, s53, 37
s_lshr_b32 s57, s57, 8
v_mfma_f32_16x16x32_bf16 v[48:51], a[168:171], v[88:91], v[48:51]
s_xor_b32 s60, s61, 327680
buffer_load_dwordx4 v8, s[36:39], s60 offen offset:0  lds
v_mfma_f32_16x16x32_bf16 v[56:59], a[168:171], v[92:95], v[56:59]
ds_read_b128 v[172:175], v223 offset:34816
s_mul_i32 s57, s57, 7
v_mfma_f32_16x16x32_bf16 v[36:39], a[172:175], v[80:83], v[36:39]
ds_read_b128 v[176:179], v223 offset:36864
s_sub_u32 s53, s53, s57
v_mfma_f32_16x16x32_bf16 v[44:47], a[172:175], v[84:87], v[44:47]
s_lshl_b32 s53, s53, 12
s_add_u32 s53, s53, s56
v_mfma_f32_16x16x32_bf16 v[52:55], a[172:175], v[88:91], v[52:55]
buffer_load_dwordx4 v9, s[36:39], s60 offen offset:1024  lds
s_add_u32 m0, s46, 147456
v_mfma_f32_16x16x32_bf16 v[60:63], a[172:175], v[92:95], v[60:63]
ds_read_b128 v[180:183], v223 offset:38912
buffer_load_dword v228, v218, s[24:27], s59 offen sc1
s_waitcnt lgkmcnt(4)
v_mfma_f32_16x16x32_bf16 v[32:35], a[176:179], v[152:155], v[32:35]
ds_read_b128 v[64:67], v222 offset:0
s_add_u32 s54, s47, 6
v_mfma_f32_16x16x32_bf16 v[40:43], a[176:179], v[156:159], v[40:43]
s_mul_i32 s57, s54, 37
s_lshr_b32 s57, s57, 8
v_mfma_f32_16x16x32_bf16 v[48:51], a[176:179], v[160:163], v[48:51]
ds_read_b128 v[68:71], v222 offset:2048
s_mul_i32 s57, s57, 7
v_mfma_f32_16x16x32_bf16 v[56:59], a[176:179], v[164:167], v[56:59]
s_waitcnt vmcnt(9)
v_cmp_ne_u32 vcc, s45, v219
s_nop 0
s_cbranch_vccnz L_x_7
L_xb_8:
v_mfma_f32_16x16x32_bf16 v[36:39], a[180:183], v[152:155], v[36:39]
s_xor_b32 s60, s61, 393216
buffer_load_dwordx4 v8, s[36:39], s60 offen offset:0  lds
v_mfma_f32_16x16x32_bf16 v[44:47], a[180:183], v[156:159], v[44:47]
ds_read_b128 v[72:75], v222 offset:4096
buffer_load_dwordx4 v[124:127], v1, s[24:27], s86 offen offset:0 sc1
v_mfma_f32_16x16x32_bf16 v[52:55], a[180:183], v[160:163], v[52:55]
ds_read_b128 v[76:79], v222 offset:6144
s_sub_u32 s54, s54, s57
v_mfma_f32_16x16x32_bf16 v[60:63], a[180:183], v[164:167], v[60:63]
s_lshl_b32 s54, s54, 12
s_waitcnt lgkmcnt(4)
v_mfma_f32_16x16x32_bf16 v[32:35], a[184:187], v[168:171], v[32:35]
ds_read_b128 v[80:83], v223 offset:0
buffer_load_dwordx4 v[132:135], v1, s[24:27], s86 offen offset:1024 sc1
v_mfma_f32_16x16x32_bf16 v[40:43], a[184:187], v[172:175], v[40:43]
s_add_u32 s54, s54, s56
v_mfma_f32_16x16x32_bf16 v[48:51], a[184:187], v[176:179], v[48:51]
ds_read_b128 v[84:87], v223 offset:2048
v_mfma_f32_16x16x32_bf16 v[56:59], a[184:187], v[180:183], v[56:59]
buffer_load_dwordx4 v[140:143], v1, s[24:27], s86 offen offset:2048 sc1
v_mfma_f32_16x16x32_bf16 v[36:39], a[188:191], v[168:171], v[36:39]
ds_read_b128 v[88:91], v223 offset:4096
v_mfma_f32_16x16x32_bf16 v[44:47], a[188:191], v[172:175], v[44:47]
v_mfma_f32_16x16x32_bf16 v[52:55], a[188:191], v[176:179], v[52:55]
ds_read_b128 v[92:95], v223 offset:6144
buffer_load_dwordx4 v[148:151], v1, s[24:27], s86 offen offset:3072 sc1
v_mfma_f32_16x16x32_bf16 v[60:63], a[188:191], v[180:183], v[60:63]
s_waitcnt lgkmcnt(4)
s_barrier
v_mfma_f32_16x16x32_bf16 v[32:35], a[192:195], v[64:67], v[32:35]
ds_read_b128 v[152:155], v222 offset:40960
v_mfma_f32_16x16x32_bf16 v[40:43], a[192:195], v[68:71], v[40:43]
v_mfma_f32_16x16x32_bf16 v[48:51], a[192:195], v[72:75], v[48:51]
buffer_load_dwordx4 v9, s[36:39], s60 offen offset:1024  lds
s_add_u32 m0, s46, 155648
v_mfma_f32_16x16x32_bf16 v[56:59], a[192:195], v[76:79], v[56:59]
ds_read_b128 v[156:159], v222 offset:43008
v_mfma_f32_16x16x32_bf16 v[36:39], a[196:199], v[64:67], v[36:39]
ds_read_b128 v[160:163], v222 offset:45056
v_mfma_f32_16x16x32_bf16 v[44:47], a[196:199], v[68:71], v[44:47]
v_mfma_f32_16x16x32_bf16 v[52:55], a[196:199], v[72:75], v[52:55]
s_xor_b32 s60, s61, 458752
buffer_load_dwordx4 v8, s[36:39], s60 offen offset:0  lds
v_mfma_f32_16x16x32_bf16 v[60:63], a[196:199], v[76:79], v[60:63]
ds_read_b128 v[164:167], v222 offset:47104
s_waitcnt lgkmcnt(4)
v_mfma_f32_16x16x32_bf16 v[32:35], a[200:203], v[80:83], v[32:35]
ds_read_b128 v[168:171], v223 offset:40960
v_mfma_f32_16x16x32_bf16 v[40:43], a[200:203], v[84:87], v[40:43]
v_mfma_f32_16x16x32_bf16 v[48:51], a[200:203], v[88:91], v[48:51]
buffer_load_dwordx4 v9, s[36:39], s60 offen offset:1024  lds
s_add_u32 m0, s46, 49152
v_mfma_f32_16x16x32_bf16 v[56:59], a[200:203], v[92:95], v[56:59]
ds_read_b128 v[172:175], v223 offset:43008
v_mfma_f32_16x16x32_bf16 v[36:39], a[204:207], v[80:83], v[36:39]
ds_read_b128 v[176:179], v223 offset:45056
v_mfma_f32_16x16x32_bf16 v[44:47], a[204:207], v[84:87], v[44:47]
v_mfma_f32_16x16x32_bf16 v[52:55], a[204:207], v[88:91], v[52:55]
ds_read_b128 v[180:183], v223 offset:47104
v_mfma_f32_16x16x32_bf16 v[60:63], a[204:207], v[92:95], v[60:63]
s_waitcnt lgkmcnt(4)
v_mfma_f32_16x16x32_bf16 v[32:35], a[208:211], v[152:155], v[32:35]
buffer_load_dwordx4 v8, s[20:23], s97 offen offset:0  lds
v_mfma_f32_16x16x32_bf16 v[40:43], a[208:211], v[156:159], v[40:43]
ds_read_b128 v[64:67], v220 offset:24576
v_mfma_f32_16x16x32_bf16 v[48:51], a[208:211], v[160:163], v[48:51]
ds_read_b128 v[68:71], v220 offset:26624
v_mfma_f32_16x16x32_bf16 v[56:59], a[208:211], v[164:167], v[56:59]
v_mfma_f32_16x16x32_bf16 v[36:39], a[212:215], v[152:155], v[36:39]
buffer_load_dwordx4 v9, s[20:23], s97 offen offset:1024  lds
s_add_u32 s97, s97, 0x10000
s_cmp_eq_u32 s97, 917504
s_cselect_b32 s97, 0, s97
v_mfma_f32_16x16x32_bf16 v[44:47], a[212:215], v[156:159], v[44:47]
ds_read_b128 v[72:75], v220 offset:28672
v_mfma_f32_16x16x32_bf16 v[52:55], a[212:215], v[160:163], v[52:55]
ds_read_b128 v[76:79], v220 offset:30720
v_mfma_f32_16x16x32_bf16 v[60:63], a[212:215], v[164:167], v[60:63]
s_waitcnt lgkmcnt(4)
v_mfma_f32_16x16x32_bf16 v[32:35], a[216:219], v[168:171], v[32:35]
s_add_u32 m0, s46, 81920
s_nop 0
buffer_load_dwordx4 v8, s[20:23], s97 offen offset:0  lds
v_mfma_f32_16x16x32_bf16 v[40:43], a[216:219], v[172:175], v[40:43]
ds_read_b128 v[80:83], v221 offset:24576
v_mfma_f32_16x16x32_bf16 v[48:51], a[216:219], v[176:179], v[48:51]
ds_read_b128 v[84:87], v221 offset:26624
v_mfma_f32_16x16x32_bf16 v[56:59], a[216:219], v[180:183], v[56:59]
v_mfma_f32_16x16x32_bf16 v[36:39], a[220:223], v[168:171], v[36:39]
buffer_load_dwordx4 v9, s[20:23], s97 offen offset:1024  lds
s_add_u32 s97, s97, 0x10000
s_cmp_eq_u32 s97, 917504
s_cselect_b32 s97, 0, s97
v_mfma_f32_16x16x32_bf16 v[44:47], a[220:223], v[172:175], v[44:47]
ds_read_b128 v[88:91], v221 offset:28672
v_mfma_f32_16x16x32_bf16 v[52:55], a[220:223], v[176:179], v[52:55]
ds_read_b128 v[92:95], v221 offset:30720
v_mfma_f32_16x16x32_bf16 v[60:63], a[220:223], v[180:183], v[60:63]
s_waitcnt lgkmcnt(4)
s_barrier
v_mfma_f32_16x16x32_bf16 v[32:35], a[224:227], v[64:67], v[32:35]
s_add_u32 m0, s46, 90112
s_nop 0
buffer_load_dwordx4 v8, s[20:23], s97 offen offset:0  lds
v_mfma_f32_16x16x32_bf16 v[40:43], a[224:227], v[68:71], v[40:43]
ds_read_b128 v[152:155], v222 offset:8192
v_mfma_f32_16x16x32_bf16 v[48:51], a[224:227], v[72:75], v[48:51]
ds_read_b128 v[156:159], v222 offset:10240
v_mfma_f32_16x16x32_bf16 v[56:59], a[224:227], v[76:79], v[56:59]
v_mfma_f32_16x16x32_bf16 v[36:39], a[228:231], v[64:67], v[36:39]
buffer_load_dwordx4 v9, s[20:23], s97 offen offset:1024  lds
s_add_u32 s97, s97, 0x10000
s_cmp_eq_u32 s97, 917504
s_cselect_b32 s97, 0, s97
v_mfma_f32_16x16x32_bf16 v[44:47], a[228:231], v[68:71], v[44:47]
ds_read_b128 v[160:163], v222 offset:12288
v_mfma_f32_16x16x32_bf16 v[52:55], a[228:231], v[72:75], v[52:55]
ds_read_b128 v[164:167], v222 offset:14336
s_waitcnt vmcnt(12)
v_lshlrev_b32 v120, 16, v124
v_and_b32 v121, 0xffff0000, v124
v_mfma_f32_16x16x32_bf16 v[60:63], a[228:231], v[76:79], v[60:63]
v_lshlrev_b32 v122, 16, v125
v_and_b32 v123, 0xffff0000, v125
s_waitcnt lgkmcnt(4)
v_mfma_f32_16x16x32_bf16 v[32:35], a[232:235], v[80:83], v[32:35]
s_add_u32 m0, s46, 57344
s_nop 0
buffer_load_dwordx4 v8, s[20:23], s97 offen offset:0  lds
v_mfma_f32_16x16x32_bf16 v[40:43], a[232:235], v[84:87], v[40:43]
ds_read_b128 v[168:171], v223 offset:8192
v_lshlrev_b32 v124, 16, v126
v_and_b32 v125, 0xffff0000, v126
v_mfma_f32_16x16x32_bf16 v[48:51], a[232:235], v[88:91], v[48:51]
ds_read_b128 v[172:175], v223 offset:10240
v_lshlrev_b32 v126, 16, v127
v_and_b32 v127, 0xffff0000, v127
v_mfma_f32_16x16x32_bf16 v[56:59], a[232:235], v[92:95], v[56:59]
s_waitcnt vmcnt(12)
v_lshlrev_b32 v128, 16, v132
v_and_b32 v129, 0xffff0000, v132
v_lshlrev_b32 v130, 16, v133
v_mfma_f32_16x16x32_bf16 v[36:39], a[236:239], v[80:83], v[36:39]
buffer_load_dwordx4 v9, s[20:23], s97 offen offset:1024  lds
s_add_u32 s97, s97, 0x10000
s_cmp_eq_u32 s97, 917504
s_cselect_b32 s97, 0, s97
v_mfma_f32_16x16x32_bf16 v[44:47], a[236:239], v[84:87], v[44:47]
ds_read_b128 v[176:179], v223 offset:12288
v_and_b32 v131, 0xffff0000, v133
v_lshlrev_b32 v132, 16, v134
v_mfma_f32_16x16x32_bf16 v[52:55], a[236:239], v[88:91], v[52:55]
ds_read_b128 v[180:183], v223 offset:14336
v_and_b32 v133, 0xffff0000, v134
v_lshlrev_b32 v134, 16, v135
v_mfma_f32_16x16x32_bf16 v[60:63], a[236:239], v[92:95], v[60:63]
v_and_b32 v135, 0xffff0000, v135
s_waitcnt vmcnt(12)
v_lshlrev_b32 v136, 16, v140
v_cmp_ne_u32 vcc, s45, v228
s_nop 0
s_cbranch_vccnz L_of_9
L_ofb_10:
s_waitcnt lgkmcnt(4)
v_mfma_f32_16x16x32_bf16 v[32:35], a[240:243], v[152:155], v[32:35]
s_xor_b32 s63, s62, 2048
buffer_load_dwordx4 a[8:11], v1, s[24:27], s63 offen offset:0 sc1
v_mfma_f32_16x16x32_bf16 v[40:43], a[240:243], v[156:159], v[40:43]
v_and_b32 v137, 0xffff0000, v140
v_lshlrev_b32 v138, 16, v141
v_and_b32 v139, 0xffff0000, v141
v_mfma_f32_16x16x32_bf16 v[48:51], a[240:243], v[160:163], v[48:51]
v_lshlrev_b32 v140, 16, v142
v_and_b32 v141, 0xffff0000, v142
v_lshlrev_b32 v142, 16, v143
v_mfma_f32_16x16x32_bf16 v[56:59], a[240:243], v[164:167], v[56:59]
v_and_b32 v143, 0xffff0000, v143
s_waitcnt vmcnt(12)
v_lshlrev_b32 v144, 16, v148
v_and_b32 v145, 0xffff0000, v148
v_mfma_f32_16x16x32_bf16 v[36:39], a[244:247], v[152:155], v[36:39]
buffer_load_dwordx4 a[12:15], v1, s[24:27], s63 offen offset:1024 sc1
v_lshlrev_b32 v146, 16, v149
v_mfma_f32_16x16x32_bf16 v[44:47], a[244:247], v[156:159], v[44:47]
v_and_b32 v147, 0xffff0000, v149
v_lshlrev_b32 v148, 16, v150
v_and_b32 v149, 0xffff0000, v150
v_mfma_f32_16x16x32_bf16 v[52:55], a[244:247], v[160:163], v[52:55]
v_lshlrev_b32 v150, 16, v151
v_and_b32 v151, 0xffff0000, v151
v_mfma_f32_16x16x32_bf16 v[60:63], a[244:247], v[164:167], v[60:63]
s_waitcnt lgkmcnt(0)
v_mfma_f32_16x16x32_bf16 v[32:35], a[248:251], v[168:171], v[32:35]
s_xor_b32 s63, s62, 4096
buffer_load_dwordx4 a[16:19], v1, s[24:27], s63 offen offset:0 sc1
v_mfma_f32_16x16x32_bf16 v[40:43], a[248:251], v[172:175], v[40:43]
v_mfma_f32_16x16x32_bf16 v[48:51], a[248:251], v[176:179], v[48:51]
v_mfma_f32_16x16x32_bf16 v[56:59], a[248:251], v[180:183], v[56:59]
v_mfma_f32_16x16x32_bf16 v[36:39], a[252:255], v[168:171], v[36:39]
buffer_load_dwordx4 a[20:23], v1, s[24:27], s63 offen offset:1024 sc1
v_mfma_f32_16x16x32_bf16 v[44:47], a[252:255], v[172:175], v[44:47]
v_mfma_f32_16x16x32_bf16 v[52:55], a[252:255], v[176:179], v[52:55]
v_mfma_f32_16x16x32_bf16 v[60:63], a[252:255], v[180:183], v[60:63]
v_pk_add_f32 v[32:33], v[32:33], v[120:121]
v_pk_add_f32 v[34:35], v[34:35], v[122:123]
s_nop 1
v_pk_add_f32 v[36:37], v[36:37], v[124:125]
v_pk_add_f32 v[38:39], v[38:39], v[126:127]
v_pk_fma_f32 v[32:33], v[32:33], v[232:233], v[232:233] op_sel:[0,0,1] op_sel_hi:[1,0,1]
v_pk_fma_f32 v[34:35], v[34:35], v[232:233], v[232:233] op_sel:[0,0,1] op_sel_hi:[1,0,1]
v_pk_fma_f32 v[36:37], v[36:37], v[232:233], v[232:233] op_sel:[0,0,1] op_sel_hi:[1,0,1]
v_pk_fma_f32 v[38:39], v[38:39], v[232:233], v[232:233] op_sel:[0,0,1] op_sel_hi:[1,0,1]
v_pk_mul_f32 v[32:33], v[32:33], v[184:185]
v_pk_mul_f32 v[34:35], v[34:35], v[186:187]
v_pk_mul_f32 v[36:37], v[36:37], v[188:189]
v_pk_mul_f32 v[38:39], v[38:39], v[190:191]
v_cvt_pk_bf16_f32 v32, v32, v33
v_cvt_pk_bf16_f32 v33, v34, v35
v_cvt_pk_bf16_f32 v34, v36, v37
v_cvt_pk_bf16_f32 v35, v38, v39
buffer_store_dwordx4 v[32:35], v1, s[24:27], s73 offen sc1
s_add_u32 s73, s73, 28672
v_pk_add_f32 v[40:41], v[40:41], v[128:129]
v_pk_add_f32 v[42:43], v[42:43], v[130:131]
v_pk_add_f32 v[44:45], v[44:45], v[132:133]
v_pk_add_f32 v[46:47], v[46:47], v[134:135]
v_pk_fma_f32 v[40:41], v[40:41], v[234:235], v[234:235] op_sel:[0,0,1] op_sel_hi:[1,0,1]
v_pk_fma_f32 v[42:43], v[42:43], v[234:235], v[234:235] op_sel:[0,0,1] op_sel_hi:[1,0,1]
v_pk_fma_f32 v[44:45], v[44:45], v[234:235], v[234:235] op_sel:[0,0,1] op_sel_hi:[1,0,1]
v_pk_fma_f32 v[46:47], v[46:47], v[234:235], v[234:235] op_sel:[0,0,1] op_sel_hi:[1,0,1]
v_pk_mul_f32 v[40:41], v[40:41], v[192:193]
v_pk_mul_f32 v[42:43], v[42:43], v[194:195]
v_pk_mul_f32 v[44:45], v[44:45], v[196:197]
v_pk_mul_f32 v[46:47], v[46:47], v[198:199]
v_cvt_pk_bf16_f32 v40, v40, v41
v_cvt_pk_bf16_f32 v41, v42, v43
v_cvt_pk_bf16_f32 v42, v44, v45
v_cvt_pk_bf16_f32 v43, v46, v47
buffer_store_dwordx4 v[40:43], v1, s[24:27], s73 offen sc1
s_add_u32 s73, s73, 28672
v_pk_add_f32 v[48:49], v[48:49], v[136:137]
v_pk_add_f32 v[50:51], v[50:51], v[138:139]
v_pk_add_f32 v[52:53], v[52:53], v[140:141]
v_pk_add_f32 v[54:55], v[54:55], v[142:143]
v_pk_fma_f32 v[48:49], v[48:49], v[236:237], v[236:237] op_sel:[0,0,1] op_sel_hi:[1,0,1]
v_pk_fma_f32 v[50:51], v[50:51], v[236:237], v[236:237] op_sel:[0,0,1] op_sel_hi:[1,0,1]
v_pk_fma_f32 v[52:53], v[52:53], v[236:237], v[236:237] op_sel:[0,0,1] op_sel_hi:[1,0,1]
v_pk_fma_f32 v[54:55], v[54:55], v[236:237], v[236:237] op_sel:[0,0,1] op_sel_hi:[1,0,1]
v_pk_mul_f32 v[48:49], v[48:49], v[200:201]
v_pk_mul_f32 v[50:51], v[50:51], v[202:203]
v_pk_mul_f32 v[52:53], v[52:53], v[204:205]
v_pk_mul_f32 v[54:55], v[54:55], v[206:207]
v_cvt_pk_bf16_f32 v48, v48, v49
v_cvt_pk_bf16_f32 v49, v50, v51
v_cvt_pk_bf16_f32 v50, v52, v53
v_cvt_pk_bf16_f32 v51, v54, v55
buffer_store_dwordx4 v[48:51], v1, s[24:27], s73 offen sc1
s_add_u32 s73, s73, 28672
v_pk_add_f32 v[56:57], v[56:57], v[144:145]
v_pk_add_f32 v[58:59], v[58:59], v[146:147]
v_pk_add_f32 v[60:61], v[60:61], v[148:149]
v_pk_add_f32 v[62:63], v[62:63], v[150:151]
v_pk_fma_f32 v[56:57], v[56:57], v[238:239], v[238:239] op_sel:[0,0,1] op_sel_hi:[1,0,1]
v_pk_fma_f32 v[58:59], v[58:59], v[238:239], v[238:239] op_sel:[0,0,1] op_sel_hi:[1,0,1]
v_pk_fma_f32 v[60:61], v[60:61], v[238:239], v[238:239] op_sel:[0,0,1] op_sel_hi:[1,0,1]
v_pk_fma_f32 v[62:63], v[62:63], v[238:239], v[238:239] op_sel:[0,0,1] op_sel_hi:[1,0,1]
v_pk_mul_f32 v[56:57], v[56:57], v[208:209]
v_pk_mul_f32 v[58:59], v[58:59], v[210:211]
v_pk_mul_f32 v[60:61], v[60:61], v[212:213]
v_pk_mul_f32 v[62:63], v[62:63], v[214:215]
v_cvt_pk_bf16_f32 v56, v56, v57
v_cvt_pk_bf16_f32 v57, v58, v59
v_cvt_pk_bf16_f32 v58, v60, v61
v_cvt_pk_bf16_f32 v59, v62, v63
buffer_store_dwordx4 v[56:59], v1, s[24:27], s73 offen sc1
v_min_u32 v246, 6, v0
s_lshl_b32 s72, s40, 28
v_lshl_add_u32 v246, v246, 7, s72
v_mov_b32 v249, s45
v_mov_b32 v248, 0
s_barrier
s_lshr_b32 s72, s46, 1
v_add_u32 v250, s72, v1
v_add_u32 v251, 24576, v250
ds_write_b128 v251, v[32:35] offset:0
ds_write_b128 v251, v[40:43] offset:4096
v_add_u32 v251, 73728, v250
ds_write_b128 v251, v[48:51] offset:0
ds_write_b128 v251, v[56:59] offset:4096
s_lshr_b32 s72, s40, 1
s_mul_i32 s72, s72, 40960
s_lshl_b32 s73, s40, 12
s_add_u32 s72, s72, s73
s_add_u32 s72, s72, 24576
v_add_u32 v251, s72, v1
ds_read_b64 v[224:225], v24
ds_read_b64 v[226:227], v25
ds_read_b64 v[228:229], v26
ds_read_b64 v[230:231], v27
ds_read_b64_tr_b16 a[64:65], v16 offset:49152
s_xor_b32 s63, s62, 6144
buffer_load_dwordx4 a[24:27], v1, s[24:27], s63 offen offset:0 sc1
ds_read_b64_tr_b16 a[66:67], v16 offset:51200
ds_read_b64_tr_b16 a[68:69], v17 offset:49152
ds_read_b64_tr_b16 a[70:71], v17 offset:51200
ds_read_b64_tr_b16 a[72:73], v18 offset:49152
ds_read_b64_tr_b16 a[74:75], v18 offset:51200
ds_read_b64_tr_b16 a[76:77], v19 offset:49152
ds_read_b64_tr_b16 a[78:79], v19 offset:51200
ds_read_b64_tr_b16 a[80:81], v16 offset:53248
ds_read_b64_tr_b16 a[82:83], v16 offset:55296
ds_read_b64_tr_b16 a[84:85], v17 offset:53248
buffer_load_dwordx4 a[28:31], v1, s[24:27], s63 offen offset:1024 sc1
ds_read_b64_tr_b16 a[86:87], v17 offset:55296
ds_read_b64_tr_b16 a[88:89], v18 offset:53248
ds_read_b64_tr_b16 a[90:91], v18 offset:55296
ds_read_b64_tr_b16 a[92:93], v19 offset:53248
ds_read_b64_tr_b16 a[94:95], v19 offset:55296
ds_read_b64_tr_b16 a[96:97], v16 offset:57344
ds_read_b64_tr_b16 a[98:99], v16 offset:59392
ds_read_b64_tr_b16 a[100:101], v17 offset:57344
ds_read_b64_tr_b16 a[102:103], v17 offset:59392
ds_read_b64_tr_b16 a[104:105], v18 offset:57344
s_xor_b32 s63, s62, 8192
buffer_load_dwordx4 a[32:35], v1, s[24:27], s63 offen offset:0 sc1
ds_read_b64_tr_b16 a[106:107], v18 offset:59392
ds_read_b64_tr_b16 a[108:109], v19 offset:57344
ds_read_b64_tr_b16 a[110:111], v19 offset:59392
s_waitcnt lgkmcnt(15)
v_mfma_f32_16x16x32_bf16 v[48:51], a[64:67], v[96:99], 0
ds_read_b64_tr_b16 a[112:113], v16 offset:61440
ds_read_b64_tr_b16 a[114:115], v16 offset:63488
v_mfma_f32_16x16x32_bf16 v[52:55], a[68:71], v[96:99], 0
ds_read_b64_tr_b16 a[116:117], v17 offset:61440
ds_read_b64_tr_b16 a[118:119], v17 offset:63488
v_mfma_f32_16x16x32_bf16 v[56:59], a[72:75], v[96:99], 0
buffer_load_dwordx4 a[36:39], v1, s[24:27], s63 offen offset:1024 sc1
ds_read_b64_tr_b16 a[120:121], v18 offset:61440
ds_read_b64_tr_b16 a[122:123], v18 offset:63488
v_mfma_f32_16x16x32_bf16 v[60:63], a[76:79], v[96:99], 0
ds_read_b64_tr_b16 a[124:125], v19 offset:61440
ds_read_b64_tr_b16 a[126:127], v19 offset:63488
s_waitcnt lgkmcnt(15)
v_mfma_f32_16x16x32_bf16 v[48:51], a[80:83], v[100:103], v[48:51]
ds_read_b64_tr_b16 a[128:129], v12 offset:32768
ds_read_b64_tr_b16 a[130:131], v12 offset:34816
v_mfma_f32_16x16x32_bf16 v[52:55], a[84:87], v[100:103], v[52:55]
s_xor_b32 s63, s62, 10240
buffer_load_dwordx4 a[40:43], v1, s[24:27], s63 offen offset:0 sc1
ds_read_b64_tr_b16 a[132:133], v13 offset:32768
ds_read_b64_tr_b16 a[134:135], v13 offset:34816
v_mfma_f32_16x16x32_bf16 v[56:59], a[88:91], v[100:103], v[56:59]
ds_read_b64_tr_b16 a[136:137], v14 offset:32768
ds_read_b64_tr_b16 a[138:139], v14 offset:34816
v_mfma_f32_16x16x32_bf16 v[60:63], a[92:95], v[100:103], v[60:63]
ds_read_b64_tr_b16 a[140:141], v15 offset:32768
ds_read_b64_tr_b16 a[142:143], v15 offset:34816
s_waitcnt vmcnt(12) lgkmcnt(15)
v_mfma_f32_16x16x32_bf16 v[48:51], a[96:99], a[8:11], v[48:51]
buffer_load_dwordx4 a[44:47], v1, s[24:27], s63 offen offset:1024 sc1
ds_read_b64_tr_b16 a[144:145], v12 offset:36864
ds_read_b64_tr_b16 a[146:147], v12 offset:38912
v_mfma_f32_16x16x32_bf16 v[52:55], a[100:103], a[8:11], v[52:55]
ds_read_b64_tr_b16 a[148:149], v13 offset:36864
ds_read_b64_tr_b16 a[150:151], v13 offset:38912
v_mfma_f32_16x16x32_bf16 v[56:59], a[104:107], a[8:11], v[56:59]
ds_read_b64_tr_b16 a[152:153], v14 offset:36864
ds_read_b64_tr_b16 a[154:155], v14 offset:38912
v_mfma_f32_16x16x32_bf16 v[60:63], a[108:111], a[8:11], v[60:63]
s_xor_b32 s63, s62, 12288
buffer_load_dwordx4 a[48:51], v1, s[24:27], s63 offen offset:0 sc1
ds_read_b64_tr_b16 a[156:157], v15 offset:36864
ds_read_b64_tr_b16 a[158:159], v15 offset:38912
s_waitcnt vmcnt(13) lgkmcnt(15)
v_mfma_f32_16x16x32_bf16 v[48:51], a[112:115], a[12:15], v[48:51]
ds_read_b64_tr_b16 a[160:161], v20 offset:0
ds_read_b64_tr_b16 a[162:163], v20 offset:2048
v_mfma_f32_16x16x32_bf16 v[52:55], a[116:119], a[12:15], v[52:55]
ds_read_b64_tr_b16 a[164:165], v21 offset:0
ds_read_b64_tr_b16 a[166:167], v21 offset:2048
v_mfma_f32_16x16x32_bf16 v[56:59], a[120:123], a[12:15], v[56:59]
buffer_load_dwordx4 a[52:55], v1, s[24:27], s63 offen offset:1024 sc1
ds_read_b64_tr_b16 a[168:169], v22 offset:0
ds_read_b64_tr_b16 a[170:171], v22 offset:2048
v_mfma_f32_16x16x32_bf16 v[60:63], a[124:127], a[12:15], v[60:63]
ds_read_b64_tr_b16 a[172:173], v23 offset:0
ds_read_b64_tr_b16 a[174:175], v23 offset:2048
s_waitcnt vmcnt(8)
s_barrier
s_cmp_lg_u32 s40, 0
s_cbranch_scc1 L_w0_13
buffer_store_dword v249, v248, s[24:27], s74 offen sc1
L_w0_13:
ds_read_b128 v[64:67], v251 offset:0
ds_read_b128 v[68:71], v251 offset:1024
ds_read_b128 v[72:75], v251 offset:2048
ds_read_b128 v[76:79], v251 offset:3072
s_waitcnt lgkmcnt(15)
v_mfma_f32_16x16x32_bf16 v[48:51], a[128:131], a[16:19], v[48:51]
ds_read_b64_tr_b16 a[176:177], v20 offset:4096
ds_read_b64_tr_b16 a[178:179], v20 offset:6144
v_mfma_f32_16x16x32_bf16 v[52:55], a[132:135], a[16:19], v[52:55]
s_xor_b32 s63, s62, 14336
buffer_load_dwordx4 a[56:59], v1, s[24:27], s63 offen offset:0 sc1
ds_read_b64_tr_b16 a[180:181], v21 offset:4096
ds_read_b64_tr_b16 a[182:183], v21 offset:6144
v_mfma_f32_16x16x32_bf16 v[56:59], a[136:139], a[16:19], v[56:59]
ds_read_b64_tr_b16 a[184:185], v22 offset:4096
ds_read_b64_tr_b16 a[186:187], v22 offset:6144
v_mfma_f32_16x16x32_bf16 v[60:63], a[140:143], a[16:19], v[60:63]
ds_read_b64_tr_b16 a[188:189], v23 offset:4096
ds_read_b64_tr_b16 a[190:191], v23 offset:6144
s_waitcnt lgkmcnt(15)
v_mfma_f32_16x16x32_bf16 v[48:51], a[144:147], a[20:23], v[48:51]
buffer_load_dwordx4 a[60:63], v1, s[24:27], s63 offen offset:1024 sc1
s_add_u32 m0, s46, 16384
ds_read_b64_tr_b16 a[192:193], v20 offset:8192
ds_read_b64_tr_b16 a[194:195], v20 offset:10240
v_mfma_f32_16x16x32_bf16 v[52:55], a[148:151], a[20:23], v[52:55]
ds_read_b64_tr_b16 a[196:197], v21 offset:8192
ds_read_b64_tr_b16 a[198:199], v21 offset:10240
v_mfma_f32_16x16x32_bf16 v[56:59], a[152:155], a[20:23], v[56:59]
ds_read_b64_tr_b16 a[200:201], v22 offset:8192
ds_read_b64_tr_b16 a[202:203], v22 offset:10240
v_mfma_f32_16x16x32_bf16 v[60:63], a[156:159], a[20:23], v[60:63]
buffer_load_dwordx4 v8, s[20:23], s97 offen offset:0  lds
ds_read_b64_tr_b16 a[204:205], v23 offset:8192
ds_read_b64_tr_b16 a[206:207], v23 offset:10240
s_waitcnt vmcnt(10) lgkmcnt(15)
v_mfma_f32_16x16x32_bf16 v[48:51], a[160:163], a[24:27], v[48:51]
ds_read_b64_tr_b16 a[208:209], v20 offset:12288
ds_read_b64_tr_b16 a[210:211], v20 offset:14336
v_mfma_f32_16x16x32_bf16 v[52:55], a[164:167], a[24:27], v[52:55]
ds_read_b64_tr_b16 a[212:213], v21 offset:12288
ds_read_b64_tr_b16 a[214:215], v21 offset:14336
v_mfma_f32_16x16x32_bf16 v[56:59], a[168:171], a[24:27], v[56:59]
buffer_load_dwordx4 v9, s[20:23], s97 offen offset:1024  lds
s_add_u32 s97, s97, 0x10000
s_cmp_eq_u32 s97, 917504
s_cselect_b32 s97, 0, s97
ds_read_b64_tr_b16 a[216:217], v22 offset:12288
ds_read_b64_tr_b16 a[218:219], v22 offset:14336
v_mfma_f32_16x16x32_bf16 v[60:63], a[172:175], a[24:27], v[60:63]
ds_read_b64_tr_b16 a[220:221], v23 offset:12288
ds_read_b64_tr_b16 a[222:223], v23 offset:14336
s_waitcnt vmcnt(10) lgkmcnt(15)
v_mfma_f32_16x16x32_bf16 v[48:51], a[176:179], a[28:31], v[48:51]
s_add_u32 m0, s46, 98304
s_nop 0
buffer_load_dwordx4 v8, s[20:23], s97 offen offset:0  lds
v_mfma_f32_16x16x32_bf16 v[52:55], a[180:183], a[28:31], v[52:55]
v_mfma_f32_16x16x32_bf16 v[56:59], a[184:187], a[28:31], v[56:59]
v_mfma_f32_16x16x32_bf16 v[60:63], a[188:191], a[28:31], v[60:63]
buffer_load_dwordx4 v9, s[20:23], s97 offen offset:1024  lds
s_add_u32 s97, s97, 0x10000
s_cmp_eq_u32 s97, 917504
s_cselect_b32 s97, 0, s97
s_waitcnt lgkmcnt(8)
s_barrier
s_waitcnt vmcnt(11)
v_mfma_f32_16x16x32_bf16 v[48:51], a[192:195], a[32:35], v[48:51]
s_add_u32 m0, s46, 65536
s_nop 0
buffer_load_dwordx4 v8, s[20:23], s97 offen offset:0  lds
ds_read_b64_tr_b16 a[224:225], v12 offset:40960
ds_read_b64_tr_b16 a[226:227], v12 offset:43008
v_mfma_f32_16x16x32_bf16 v[52:55], a[196:199], a[32:35], v[52:55]
ds_read_b64_tr_b16 a[228:229], v13 offset:40960
ds_read_b64_tr_b16 a[230:231], v13 offset:43008
v_mfma_f32_16x16x32_bf16 v[56:59], a[200:203], a[32:35], v[56:59]
ds_read_b64_tr_b16 a[232:233], v14 offset:40960
ds_read_b64_tr_b16 a[234:235], v14 offset:43008
v_mfma_f32_16x16x32_bf16 v[60:63], a[204:207], a[32:35], v[60:63]
buffer_load_dwordx4 v9, s[20:23], s97 offen offset:1024  lds
s_add_u32 s97, s97, 0x10000
s_cmp_eq_u32 s97, 917504
s_cselect_b32 s97, 0, s97
ds_read_b64_tr_b16 a[236:237], v15 offset:40960
ds_read_b64_tr_b16 a[238:239], v15 offset:43008
s_waitcnt vmcnt(12) lgkmcnt(8)
v_mfma_f32_16x16x32_bf16 v[48:51], a[208:211], a[36:39], v[48:51]
ds_read_b64_tr_b16 a[240:241], v12 offset:45056
ds_read_b64_tr_b16 a[242:243], v12 offset:47104
v_mfma_f32_16x16x32_bf16 v[52:55], a[212:215], a[36:39], v[52:55]
s_add_u32 m0, s46, 106496
s_nop 0
buffer_load_dwordx4 v8, s[20:23], s97 offen offset:0  lds
ds_read_b64_tr_b16 a[244:245], v13 offset:45056
ds_read_b64_tr_b16 a[246:247], v13 offset:47104
v_mfma_f32_16x16x32_bf16 v[56:59], a[216:219], a[36:39], v[56:59]
ds_read_b64_tr_b16 a[248:249], v14 offset:45056
ds_read_b64_tr_b16 a[250:251], v14 offset:47104
v_mfma_f32_16x16x32_bf16 v[60:63], a[220:223], a[36:39], v[60:63]
ds_read_b64_tr_b16 a[252:253], v15 offset:45056
ds_read_b64_tr_b16 a[254:255], v15 offset:47104
s_waitcnt vmcnt(12) lgkmcnt(8)
v_mfma_f32_16x16x32_bf16 v[48:51], a[224:227], a[40:43], v[48:51]
buffer_load_dwordx4 v9, s[20:23], s97 offen offset:1024  lds
s_add_u32 s97, s97, 0x10000
s_cmp_eq_u32 s97, 917504
s_cselect_b32 s97, 0, s97
ds_read_b64_tr_b16 a[64:65], v20 offset:16384
ds_read_b64_tr_b16 a[66:67], v20 offset:18432
v_mfma_f32_16x16x32_bf16 v[52:55], a[228:231], a[40:43], v[52:55]
ds_read_b64_tr_b16 a[68:69], v21 offset:16384
ds_read_b64_tr_b16 a[70:71], v21 offset:18432
v_mfma_f32_16x16x32_bf16 v[56:59], a[232:235], a[40:43], v[56:59]
s_add_u32 m0, s46, 24576
s_nop 0
buffer_load_dwordx4 v8, s[20:23], s97 offen offset:0  lds
ds_read_b64_tr_b16 a[72:73], v22 offset:16384
ds_read_b64_tr_b16 a[74:75], v22 offset:18432
v_mfma_f32_16x16x32_bf16 v[60:63], a[236:239], a[40:43], v[60:63]
ds_read_b64_tr_b16 a[76:77], v23 offset:16384
ds_read_b64_tr_b16 a[78:79], v23 offset:18432
s_waitcnt vmcnt(13) lgkmcnt(8)
v_mfma_f32_16x16x32_bf16 v[48:51], a[240:243], a[44:47], v[48:51]
ds_read_b64_tr_b16 a[80:81], v20 offset:20480
ds_read_b64_tr_b16 a[82:83], v20 offset:22528
v_mfma_f32_16x16x32_bf16 v[52:55], a[244:247], a[44:47], v[52:55]
buffer_load_dwordx4 v9, s[20:23], s97 offen offset:1024  lds
s_add_u32 s97, s97, 0x10000
s_cmp_eq_u32 s97, 917504
s_cselect_b32 s97, 0, s97
ds_read_b64_tr_b16 a[84:85], v21 offset:20480
ds_read_b64_tr_b16 a[86:87], v21 offset:22528
v_mfma_f32_16x16x32_bf16 v[56:59], a[248:251], a[44:47], v[56:59]
ds_read_b64_tr_b16 a[88:89], v22 offset:20480
ds_read_b64_tr_b16 a[90:91], v22 offset:22528
v_mfma_f32_16x16x32_bf16 v[60:63], a[252:255], a[44:47], v[60:63]
s_add_u32 m0, s46, 73728
s_nop 0
buffer_load_dwordx4 v8, s[20:23], s97 offen offset:0  lds
ds_read_b64_tr_b16 a[92:93], v23 offset:20480
ds_read_b64_tr_b16 a[94:95], v23 offset:22528
s_waitcnt vmcnt(14) lgkmcnt(8)
v_mfma_f32_16x16x32_bf16 v[48:51], a[64:67], a[48:51], v[48:51]
ds_read_b64_tr_b16 a[96:97], v20 offset:24576
ds_read_b64_tr_b16 a[98:99], v20 offset:26624
v_mfma_f32_16x16x32_bf16 v[52:55], a[68:71], a[48:51], v[52:55]
ds_read_b64_tr_b16 a[100:101], v21 offset:24576
ds_read_b64_tr_b16 a[102:103], v21 offset:26624
v_mfma_f32_16x16x32_bf16 v[56:59], a[72:75], a[48:51], v[56:59]
buffer_load_dwordx4 v9, s[20:23], s97 offen offset:1024  lds
s_add_u32 s97, s97, 0x10000
s_cmp_eq_u32 s97, 917504
s_cselect_b32 s97, 0, s97
ds_read_b64_tr_b16 a[104:105], v22 offset:24576
ds_read_b64_tr_b16 a[106:107], v22 offset:26624
v_mfma_f32_16x16x32_bf16 v[60:63], a[76:79], a[48:51], v[60:63]
ds_read_b64_tr_b16 a[108:109], v23 offset:24576
ds_read_b64_tr_b16 a[110:111], v23 offset:26624
s_waitcnt vmcnt(14) lgkmcnt(8)
v_mfma_f32_16x16x32_bf16 v[48:51], a[80:83], a[52:55], v[48:51]
s_add_u32 m0, s46, 114688
s_nop 0
buffer_load_dwordx4 v8, s[20:23], s97 offen offset:0  lds
ds_read_b64_tr_b16 a[112:113], v20 offset:28672
ds_read_b64_tr_b16 a[114:115], v20 offset:30720
v_mfma_f32_16x16x32_bf16 v[52:55], a[84:87], a[52:55], v[52:55]
ds_read_b64_tr_b16 a[116:117], v21 offset:28672
ds_read_b64_tr_b16 a[118:119], v21 offset:30720
v_mfma_f32_16x16x32_bf16 v[56:59], a[88:91], a[52:55], v[56:59]
ds_read_b64_tr_b16 a[120:121], v22 offset:28672
ds_read_b64_tr_b16 a[122:123], v22 offset:30720
v_mfma_f32_16x16x32_bf16 v[60:63], a[92:95], a[52:55], v[60:63]
buffer_load_dwordx4 v9, s[20:23], s97 offen offset:1024  lds
s_add_u32 s97, s97, 0x10000
s_cmp_eq_u32 s97, 917504
s_cselect_b32 s97, 0, s97
ds_read_b64_tr_b16 a[124:125], v23 offset:28672
ds_read_b64_tr_b16 a[126:127], v23 offset:30720
buffer_load_dword v245, v246, s[24:27], s58 offen sc1
s_waitcnt vmcnt(16) lgkmcnt(8)
v_mfma_f32_16x16x32_bf16 v[48:51], a[96:99], a[56:59], v[48:51]
ds_read_b64_tr_b16 a[128:129], v12 offset:49152
ds_read_b64_tr_b16 a[130:131], v12 offset:51200
v_mfma_f32_16x16x32_bf16 v[52:55], a[100:103], a[56:59], v[52:55]
s_add_u32 m0, s46, 122880
s_nop 0
buffer_load_dwordx4 v8, s[20:23], s97 offen offset:0  lds
ds_read_b64_tr_b16 a[132:133], v13 offset:49152
ds_read_b64_tr_b16 a[134:135], v13 offset:51200
v_mfma_f32_16x16x32_bf16 v[56:59], a[104:107], a[56:59], v[56:59]
ds_read_b64_tr_b16 a[136:137], v14 offset:49152
ds_read_b64_tr_b16 a[138:139], v14 offset:51200
v_mfma_f32_16x16x32_bf16 v[60:63], a[108:111], a[56:59], v[60:63]
ds_read_b64_tr_b16 a[140:141], v15 offset:49152
ds_read_b64_tr_b16 a[142:143], v15 offset:51200
s_waitcnt vmcnt(16) lgkmcnt(8)
v_mfma_f32_16x16x32_bf16 v[48:51], a[112:115], a[60:63], v[48:51]
buffer_load_dwordx4 v9, s[20:23], s97 offen offset:1024  lds
s_add_u32 s97, s97, 0x10000
s_cmp_eq_u32 s97, 917504
s_cselect_b32 s97, 0, s97
ds_read_b64_tr_b16 a[144:145], v12 offset:53248
ds_read_b64_tr_b16 a[146:147], v12 offset:55296
v_mfma_f32_16x16x32_bf16 v[52:55], a[116:119], a[60:63], v[52:55]
ds_read_b64_tr_b16 a[148:149], v13 offset:53248
ds_read_b64_tr_b16 a[150:151], v13 offset:55296
v_mfma_f32_16x16x32_bf16 v[56:59], a[120:123], a[60:63], v[56:59]
s_add_u32 m0, s46, 32768
s_nop 0
buffer_load_dwordx4 v8, s[20:23], s97 offen offset:0  lds
ds_read_b64_tr_b16 a[152:153], v14 offset:53248
ds_read_b64_tr_b16 a[154:155], v14 offset:55296
v_mfma_f32_16x16x32_bf16 v[60:63], a[124:127], a[60:63], v[60:63]
ds_read_b64_tr_b16 a[156:157], v15 offset:53248
ds_read_b64_tr_b16 a[158:159], v15 offset:55296
buffer_load_dwordx4 v9, s[20:23], s97 offen offset:1024  lds
s_add_u32 s97, s97, 0x10000
s_cmp_eq_u32 s97, 917504
s_cselect_b32 s97, 0, s97
s_add_u32 m0, s46, 131072
s_nop 0
buffer_load_dwordx4 v8, s[20:23], s97 offen offset:0  lds
buffer_load_dwordx4 v9, s[20:23], s97 offen offset:1024  lds
s_add_u32 s97, s97, 0x10000
s_cmp_eq_u32 s97, 917504
s_cselect_b32 s97, 0, s97
v_lshlrev_b32 v32, 16, v224
v_and_b32 v33, 0xffff0000, v224
v_lshlrev_b32 v34, 16, v225
v_and_b32 v35, 0xffff0000, v225
v_lshlrev_b32 v36, 16, v226
v_and_b32 v37, 0xffff0000, v226
v_lshlrev_b32 v38, 16, v227
v_and_b32 v39, 0xffff0000, v227
v_lshlrev_b32 v40, 16, v228
v_and_b32 v41, 0xffff0000, v228
v_lshlrev_b32 v42, 16, v229
v_and_b32 v43, 0xffff0000, v229
v_lshlrev_b32 v44, 16, v230
v_and_b32 v45, 0xffff0000, v230
v_lshlrev_b32 v46, 16, v231
v_and_b32 v47, 0xffff0000, v231
v_add_u32 v5, 1024, v5
s_waitcnt vmcnt(17)
s_barrier
ds_read_b64_tr_b16 a[160:161], v16 offset:16384
ds_read_b64_tr_b16 a[162:163], v16 offset:18432
ds_read_b64_tr_b16 a[164:165], v17 offset:16384
ds_read_b64_tr_b16 a[166:167], v17 offset:18432
ds_read_b64_tr_b16 a[168:169], v18 offset:16384
ds_read_b64_tr_b16 a[170:171], v18 offset:18432
ds_read_b64_tr_b16 a[172:173], v19 offset:16384
ds_read_b64_tr_b16 a[174:175], v19 offset:18432
ds_read_b64_tr_b16 a[176:177], v16 offset:20480
ds_read_b64_tr_b16 a[178:179], v16 offset:22528
ds_read_b64_tr_b16 a[180:181], v17 offset:20480
ds_read_b64_tr_b16 a[182:183], v17 offset:22528
ds_read_b64_tr_b16 a[184:185], v18 offset:20480
ds_read_b64_tr_b16 a[186:187], v18 offset:22528
ds_read_b64_tr_b16 a[188:189], v19 offset:20480
ds_read_b64_tr_b16 a[190:191], v19 offset:22528
ds_read_b64_tr_b16 a[192:193], v16 offset:24576
ds_read_b64_tr_b16 a[194:195], v16 offset:26624
ds_read_b64_tr_b16 a[196:197], v17 offset:24576
ds_read_b64_tr_b16 a[198:199], v17 offset:26624
ds_read_b64_tr_b16 a[200:201], v18 offset:24576
ds_read_b64_tr_b16 a[202:203], v18 offset:26624
ds_read_b64_tr_b16 a[204:205], v19 offset:24576
ds_read_b64_tr_b16 a[206:207], v19 offset:26624
ds_read_b64_tr_b16 a[208:209], v16 offset:28672
ds_read_b64_tr_b16 a[210:211], v16 offset:30720
ds_read_b64_tr_b16 a[212:213], v17 offset:28672
ds_read_b64_tr_b16 a[214:215], v17 offset:30720
ds_read_b64_tr_b16 a[216:217], v18 offset:28672
ds_read_b64_tr_b16 a[218:219], v18 offset:30720
ds_read_b64_tr_b16 a[220:221], v19 offset:28672
ds_read_b64_tr_b16 a[222:223], v19 offset:30720
s_waitcnt lgkmcnt(15)
v_mfma_f32_16x16x32_bf16 v[176:179], a[128:131], v[64:67], 0
ds_read_b64_tr_b16 a[224:225], v12 offset:57344
ds_read_b64_tr_b16 a[226:227], v12 offset:59392
v_mfma_f32_16x16x32_bf16 v[180:183], a[132:135], v[64:67], 0
ds_read_b64_tr_b16 a[228:229], v13 offset:57344
ds_read_b64_tr_b16 a[230:231], v13 offset:59392
v_mfma_f32_16x16x32_bf16 v[184:187], a[136:139], v[64:67], 0
ds_read_b64_tr_b16 a[232:233], v14 offset:57344
ds_read_b64_tr_b16 a[234:235], v14 offset:59392
v_mfma_f32_16x16x32_bf16 v[188:191], a[140:143], v[64:67], 0
ds_read_b64_tr_b16 a[236:237], v15 offset:57344
v_mfma_f32_16x16x32_bf16 v[176:179], a[144:147], v[68:71], v[176:179]
ds_read_b64_tr_b16 a[238:239], v15 offset:59392
ds_read_b64_tr_b16 a[240:241], v12 offset:61440
v_mfma_f32_16x16x32_bf16 v[180:183], a[148:151], v[68:71], v[180:183]
ds_read_b64_tr_b16 a[242:243], v12 offset:63488
ds_read_b64_tr_b16 a[244:245], v13 offset:61440
v_mfma_f32_16x16x32_bf16 v[184:187], a[152:155], v[68:71], v[184:187]
ds_read_b64_tr_b16 a[246:247], v13 offset:63488
ds_read_b64_tr_b16 a[248:249], v14 offset:61440
v_mfma_f32_16x16x32_bf16 v[188:191], a[156:159], v[68:71], v[188:191]
ds_read_b64_tr_b16 a[250:251], v14 offset:63488
v_mfma_f32_16x16x32_bf16 v[176:179], a[160:163], v[72:75], v[176:179]
ds_read_b64_tr_b16 a[252:253], v15 offset:61440
ds_read_b64_tr_b16 a[254:255], v15 offset:63488
v_mfma_f32_16x16x32_bf16 v[180:183], a[164:167], v[72:75], v[180:183]
ds_read_b64_tr_b16 a[0:1], v12 offset:16384
ds_read_b64_tr_b16 a[2:3], v12 offset:18432
v_mfma_f32_16x16x32_bf16 v[184:187], a[168:171], v[72:75], v[184:187]
ds_read_b64_tr_b16 a[4:5], v13 offset:16384
ds_read_b64_tr_b16 a[6:7], v13 offset:18432
v_mfma_f32_16x16x32_bf16 v[188:191], a[172:175], v[72:75], v[188:191]
ds_read_b64_tr_b16 a[8:9], v14 offset:16384
v_mfma_f32_16x16x32_bf16 v[176:179], a[176:179], v[76:79], v[176:179]
ds_read_b64_tr_b16 a[10:11], v14 offset:18432
ds_read_b64_tr_b16 a[12:13], v15 offset:16384
v_mfma_f32_16x16x32_bf16 v[180:183], a[180:183], v[76:79], v[180:183]
ds_read_b64_tr_b16 a[14:15], v15 offset:18432
ds_read_b64_tr_b16 a[16:17], v12 offset:20480
v_mfma_f32_16x16x32_bf16 v[184:187], a[184:187], v[76:79], v[184:187]
ds_read_b64_tr_b16 a[18:19], v12 offset:22528
ds_read_b64_tr_b16 a[20:21], v13 offset:20480
v_mfma_f32_16x16x32_bf16 v[188:191], a[188:191], v[76:79], v[188:191]
ds_read_b64_tr_b16 a[22:23], v13 offset:22528
s_waitcnt vmcnt(6)
s_cmp_lg_u32 s40, 0
s_cbranch_scc1 L_w0_14
v_cmp_ne_u32 vcc, s45, v245
s_nop 1
s_cbranch_vccnz L_hf_11
L_hfb_12:
L_w0_14:
s_waitcnt vmcnt(0)
s_barrier
buffer_load_dwordx4 v[80:83], v1, s[24:27], s49 offen offset:0 sc1
buffer_load_dwordx4 v[84:87], v1, s[24:27], s49 offen offset:1024 sc1
buffer_load_dwordx4 v[88:91], v1, s[24:27], s49 offen offset:2048 sc1
buffer_load_dwordx4 v[92:95], v1, s[24:27], s49 offen offset:3072 sc1
buffer_load_dwordx4 v[96:99], v1, s[24:27], s50 offen offset:0 sc1
buffer_load_dwordx4 v[100:103], v1, s[24:27], s50 offen offset:1024 sc1
buffer_load_dwordx4 v[104:107], v1, s[24:27], s50 offen offset:2048 sc1
buffer_load_dwordx4 v[108:111], v1, s[24:27], s50 offen offset:3072 sc1
ds_read_b64_tr_b16 a[24:25], v14 offset:20480
ds_read_b64_tr_b16 a[26:27], v14 offset:22528
ds_read_b64_tr_b16 a[28:29], v15 offset:20480
ds_read_b64_tr_b16 a[30:31], v15 offset:22528
ds_read_b64_tr_b16 a[32:33], v16 offset:32768
ds_read_b64_tr_b16 a[34:35], v16 offset:34816
ds_read_b64_tr_b16 a[36:37], v17 offset:32768
ds_read_b64_tr_b16 a[38:39], v17 offset:34816
ds_read_b64_tr_b16 a[40:41], v18 offset:32768
ds_read_b64_tr_b16 a[42:43], v18 offset:34816
ds_read_b64_tr_b16 a[44:45], v19 offset:32768
ds_read_b64_tr_b16 a[46:47], v19 offset:34816
ds_read_b64_tr_b16 a[48:49], v16 offset:36864
ds_read_b64_tr_b16 a[50:51], v16 offset:38912
ds_read_b64_tr_b16 a[52:53], v17 offset:36864
ds_read_b64_tr_b16 a[54:55], v17 offset:38912
ds_read_b64_tr_b16 a[56:57], v18 offset:36864
ds_read_b64_tr_b16 a[58:59], v18 offset:38912
ds_read_b64_tr_b16 a[60:61], v19 offset:36864
ds_read_b64_tr_b16 a[62:63], v19 offset:38912
ds_read_b64_tr_b16 a[64:65], v16 offset:0
ds_read_b64_tr_b16 a[66:67], v16 offset:2048
ds_read_b64_tr_b16 a[68:69], v17 offset:0
ds_read_b64_tr_b16 a[70:71], v17 offset:2048
ds_read_b64_tr_b16 a[72:73], v18 offset:0
ds_read_b64_tr_b16 a[74:75], v18 offset:2048
ds_read_b64_tr_b16 a[76:77], v19 offset:0
ds_read_b64_tr_b16 a[78:79], v19 offset:2048
ds_read_b64_tr_b16 a[80:81], v16 offset:4096
ds_read_b64_tr_b16 a[82:83], v16 offset:6144
ds_read_b64_tr_b16 a[84:85], v17 offset:4096
ds_read_b64_tr_b16 a[86:87], v17 offset:6144
ds_read_b64_tr_b16 a[88:89], v18 offset:4096
ds_read_b64_tr_b16 a[90:91], v18 offset:6144
ds_read_b64_tr_b16 a[92:93], v19 offset:4096
ds_read_b64_tr_b16 a[94:95], v19 offset:6144
ds_read_b64_tr_b16 a[96:97], v16 offset:40960
ds_read_b64_tr_b16 a[98:99], v16 offset:43008
ds_read_b64_tr_b16 a[100:101], v17 offset:40960
ds_read_b64_tr_b16 a[102:103], v17 offset:43008
ds_read_b64_tr_b16 a[104:105], v18 offset:40960
ds_read_b64_tr_b16 a[106:107], v18 offset:43008
ds_read_b64_tr_b16 a[108:109], v19 offset:40960
ds_read_b64_tr_b16 a[110:111], v19 offset:43008
ds_read_b64_tr_b16 a[112:113], v16 offset:45056
ds_read_b64_tr_b16 a[114:115], v16 offset:47104
ds_read_b64_tr_b16 a[116:117], v17 offset:45056
ds_read_b64_tr_b16 a[118:119], v17 offset:47104
s_waitcnt vmcnt(7) lgkmcnt(15)
v_mfma_f32_16x16x32_bf16 v[176:179], a[192:195], v[80:83], v[176:179]
buffer_load_dwordx4 v[112:115], v1, s[24:27], s51 offen offset:0 sc1
v_mfma_f32_16x16x32_bf16 v[180:183], a[196:199], v[80:83], v[180:183]
ds_read_b64_tr_b16 a[120:121], v18 offset:45056
ds_read_b64_tr_b16 a[122:123], v18 offset:47104
v_mfma_f32_16x16x32_bf16 v[184:187], a[200:203], v[80:83], v[184:187]
ds_read_b64_tr_b16 a[124:125], v19 offset:45056
ds_read_b64_tr_b16 a[126:127], v19 offset:47104
v_mfma_f32_16x16x32_bf16 v[188:191], a[204:207], v[80:83], v[188:191]
buffer_load_dwordx4 v[116:119], v1, s[24:27], s51 offen offset:1024 sc1
ds_read_b64_tr_b16 a[128:129], v12 offset:24576
s_waitcnt vmcnt(8)
v_mfma_f32_16x16x32_bf16 v[176:179], a[208:211], v[84:87], v[176:179]
ds_read_b64_tr_b16 a[130:131], v12 offset:26624
ds_read_b64_tr_b16 a[132:133], v13 offset:24576
v_mfma_f32_16x16x32_bf16 v[180:183], a[212:215], v[84:87], v[180:183]
buffer_load_dwordx4 v[120:123], v1, s[24:27], s51 offen offset:2048 sc1
v_mfma_f32_16x16x32_bf16 v[184:187], a[216:219], v[84:87], v[184:187]
ds_read_b64_tr_b16 a[134:135], v13 offset:26624
ds_read_b64_tr_b16 a[136:137], v14 offset:24576
v_mfma_f32_16x16x32_bf16 v[188:191], a[220:223], v[84:87], v[188:191]
ds_read_b64_tr_b16 a[138:139], v14 offset:26624
s_waitcnt vmcnt(8)
v_mfma_f32_16x16x32_bf16 v[176:179], a[224:227], v[88:91], v[176:179]
buffer_load_dwordx4 v[124:127], v1, s[24:27], s51 offen offset:3072 sc1
v_mfma_f32_16x16x32_bf16 v[180:183], a[228:231], v[88:91], v[180:183]
ds_read_b64_tr_b16 a[140:141], v15 offset:24576
ds_read_b64_tr_b16 a[142:143], v15 offset:26624
v_mfma_f32_16x16x32_bf16 v[184:187], a[232:235], v[88:91], v[184:187]
ds_read_b64_tr_b16 a[144:145], v12 offset:28672
ds_read_b64_tr_b16 a[146:147], v12 offset:30720
v_mfma_f32_16x16x32_bf16 v[188:191], a[236:239], v[88:91], v[188:191]
buffer_load_dwordx4 v[128:131], v1, s[24:27], s52 offen offset:0 sc1
ds_read_b64_tr_b16 a[148:149], v13 offset:28672
s_waitcnt vmcnt(9)
v_mfma_f32_16x16x32_bf16 v[176:179], a[240:243], v[92:95], v[176:179]
ds_read_b64_tr_b16 a[150:151], v13 offset:30720
ds_read_b64_tr_b16 a[152:153], v14 offset:28672
v_mfma_f32_16x16x32_bf16 v[180:183], a[244:247], v[92:95], v[180:183]
buffer_load_dwordx4 v[132:135], v1, s[24:27], s52 offen offset:1024 sc1
v_mfma_f32_16x16x32_bf16 v[184:187], a[248:251], v[92:95], v[184:187]
ds_read_b64_tr_b16 a[154:155], v14 offset:30720
ds_read_b64_tr_b16 a[156:157], v15 offset:28672
v_mfma_f32_16x16x32_bf16 v[188:191], a[252:255], v[92:95], v[188:191]
ds_read_b64_tr_b16 a[158:159], v15 offset:30720
s_waitcnt vmcnt(9)
v_mfma_f32_16x16x32_bf16 v[176:179], a[0:3], v[96:99], v[176:179]
buffer_load_dwordx4 v[136:139], v1, s[24:27], s52 offen offset:2048 sc1
v_mfma_f32_16x16x32_bf16 v[180:183], a[4:7], v[96:99], v[180:183]
ds_read_b64_tr_b16 a[160:161], v16 offset:8192
ds_read_b64_tr_b16 a[162:163], v16 offset:10240
v_mfma_f32_16x16x32_bf16 v[184:187], a[8:11], v[96:99], v[184:187]
ds_read_b64_tr_b16 a[164:165], v17 offset:8192
ds_read_b64_tr_b16 a[166:167], v17 offset:10240
v_mfma_f32_16x16x32_bf16 v[188:191], a[12:15], v[96:99], v[188:191]
buffer_load_dwordx4 v[140:143], v1, s[24:27], s52 offen offset:3072 sc1
ds_read_b64_tr_b16 a[168:169], v18 offset:8192
s_waitcnt vmcnt(10)
v_mfma_f32_16x16x32_bf16 v[176:179], a[16:19], v[100:103], v[176:179]
ds_read_b64_tr_b16 a[170:171], v18 offset:10240
ds_read_b64_tr_b16 a[172:173], v19 offset:8192
v_mfma_f32_16x16x32_bf16 v[180:183], a[20:23], v[100:103], v[180:183]
buffer_load_dwordx4 v[144:147], v1, s[24:27], s53 offen offset:0 sc1
v_mfma_f32_16x16x32_bf16 v[184:187], a[24:27], v[100:103], v[184:187]
ds_read_b64_tr_b16 a[174:175], v19 offset:10240
ds_read_b64_tr_b16 a[176:177], v16 offset:12288
v_mfma_f32_16x16x32_bf16 v[188:191], a[28:31], v[100:103], v[188:191]
ds_read_b64_tr_b16 a[178:179], v16 offset:14336
s_waitcnt vmcnt(10)
v_mfma_f32_16x16x32_bf16 v[176:179], a[32:35], v[104:107], v[176:179]
buffer_load_dwordx4 v[148:151], v1, s[24:27], s53 offen offset:1024 sc1
v_mfma_f32_16x16x32_bf16 v[180:183], a[36:39], v[104:107], v[180:183]
ds_read_b64_tr_b16 a[180:181], v17 offset:12288
ds_read_b64_tr_b16 a[182:183], v17 offset:14336
v_mfma_f32_16x16x32_bf16 v[184:187], a[40:43], v[104:107], v[184:187]
ds_read_b64_tr_b16 a[184:185], v18 offset:12288
ds_read_b64_tr_b16 a[186:187], v18 offset:14336
v_mfma_f32_16x16x32_bf16 v[188:191], a[44:47], v[104:107], v[188:191]
buffer_load_dwordx4 v[152:155], v1, s[24:27], s53 offen offset:2048 sc1
ds_read_b64_tr_b16 a[188:189], v19 offset:12288
s_waitcnt vmcnt(11)
v_mfma_f32_16x16x32_bf16 v[176:179], a[48:51], v[108:111], v[176:179]
ds_read_b64_tr_b16 a[190:191], v19 offset:14336
ds_read_b64_tr_b16 a[192:193], v16 offset:49152
v_mfma_f32_16x16x32_bf16 v[180:183], a[52:55], v[108:111], v[180:183]
buffer_load_dwordx4 v[156:159], v1, s[24:27], s53 offen offset:3072 sc1
v_mfma_f32_16x16x32_bf16 v[184:187], a[56:59], v[108:111], v[184:187]
ds_read_b64_tr_b16 a[194:195], v16 offset:51200
ds_read_b64_tr_b16 a[196:197], v17 offset:49152
v_mfma_f32_16x16x32_bf16 v[188:191], a[60:63], v[108:111], v[188:191]
ds_read_b64_tr_b16 a[198:199], v17 offset:51200
s_waitcnt vmcnt(11)
v_mfma_f32_16x16x32_bf16 v[176:179], a[64:67], v[112:115], v[176:179]
buffer_load_dwordx4 v[160:163], v1, s[24:27], s54 offen offset:0 sc1
v_mfma_f32_16x16x32_bf16 v[180:183], a[68:71], v[112:115], v[180:183]
ds_read_b64_tr_b16 a[200:201], v18 offset:49152
ds_read_b64_tr_b16 a[202:203], v18 offset:51200
v_mfma_f32_16x16x32_bf16 v[184:187], a[72:75], v[112:115], v[184:187]
ds_read_b64_tr_b16 a[204:205], v19 offset:49152
ds_read_b64_tr_b16 a[206:207], v19 offset:51200
v_mfma_f32_16x16x32_bf16 v[188:191], a[76:79], v[112:115], v[188:191]
buffer_load_dwordx4 v[164:167], v1, s[24:27], s54 offen offset:1024 sc1
ds_read_b64_tr_b16 a[208:209], v16 offset:53248
s_waitcnt vmcnt(12) lgkmcnt(15)
v_mfma_f32_16x16x32_bf16 v[176:179], a[80:83], v[116:119], v[176:179]
ds_read_b64_tr_b16 a[210:211], v16 offset:55296
ds_read_b64_tr_b16 a[212:213], v17 offset:53248
v_mfma_f32_16x16x32_bf16 v[180:183], a[84:87], v[116:119], v[180:183]
buffer_load_dwordx4 v[168:171], v1, s[24:27], s54 offen offset:2048 sc1
v_mfma_f32_16x16x32_bf16 v[184:187], a[88:91], v[116:119], v[184:187]
ds_read_b64_tr_b16 a[214:215], v17 offset:55296
ds_read_b64_tr_b16 a[216:217], v18 offset:53248
v_mfma_f32_16x16x32_bf16 v[188:191], a[92:95], v[116:119], v[188:191]
ds_read_b64_tr_b16 a[218:219], v18 offset:55296
s_waitcnt vmcnt(12)
v_mfma_f32_16x16x32_bf16 v[176:179], a[96:99], v[120:123], v[176:179]
buffer_load_dwordx4 v[172:175], v1, s[24:27], s54 offen offset:3072 sc1
v_mfma_f32_16x16x32_bf16 v[180:183], a[100:103], v[120:123], v[180:183]
ds_read_b64_tr_b16 a[220:221], v19 offset:53248
ds_read_b64_tr_b16 a[222:223], v19 offset:55296
v_mfma_f32_16x16x32_bf16 v[184:187], a[104:107], v[120:123], v[184:187]
ds_read_b64_tr_b16 a[224:225], v16 offset:57344
ds_read_b64_tr_b16 a[226:227], v16 offset:59392
v_mfma_f32_16x16x32_bf16 v[188:191], a[108:111], v[120:123], v[188:191]
ds_read_b64_tr_b16 a[228:229], v17 offset:57344
s_waitcnt vmcnt(12)
v_mfma_f32_16x16x32_bf16 v[176:179], a[112:115], v[124:127], v[176:179]
ds_read_b64_tr_b16 a[230:231], v17 offset:59392
ds_read_b64_tr_b16 a[232:233], v18 offset:57344
v_mfma_f32_16x16x32_bf16 v[180:183], a[116:119], v[124:127], v[180:183]
ds_read_b64_tr_b16 a[234:235], v18 offset:59392
v_mfma_f32_16x16x32_bf16 v[184:187], a[120:123], v[124:127], v[184:187]
ds_read_b64_tr_b16 a[236:237], v19 offset:57344
v_mfma_f32_16x16x32_bf16 v[188:191], a[124:127], v[124:127], v[188:191]
ds_read_b64_tr_b16 a[238:239], v19 offset:59392
s_waitcnt vmcnt(11)
v_mfma_f32_16x16x32_bf16 v[176:179], a[128:131], v[128:131], v[176:179]
ds_read_b64_tr_b16 a[240:241], v16 offset:61440
ds_read_b64_tr_b16 a[242:243], v16 offset:63488
v_mfma_f32_16x16x32_bf16 v[180:183], a[132:135], v[128:131], v[180:183]
ds_read_b64_tr_b16 a[244:245], v17 offset:61440
v_mfma_f32_16x16x32_bf16 v[184:187], a[136:139], v[128:131], v[184:187]
ds_read_b64_tr_b16 a[246:247], v17 offset:63488
v_mfma_f32_16x16x32_bf16 v[188:191], a[140:143], v[128:131], v[188:191]
ds_read_b64_tr_b16 a[248:249], v18 offset:61440
s_waitcnt vmcnt(10)
v_mfma_f32_16x16x32_bf16 v[176:179], a[144:147], v[132:135], v[176:179]
ds_read_b64_tr_b16 a[250:251], v18 offset:63488
ds_read_b64_tr_b16 a[252:253], v19 offset:61440
v_mfma_f32_16x16x32_bf16 v[180:183], a[148:151], v[132:135], v[180:183]
ds_read_b64_tr_b16 a[254:255], v19 offset:63488
v_mfma_f32_16x16x32_bf16 v[184:187], a[152:155], v[132:135], v[184:187]
ds_read_b64_tr_b16 a[0:1], v12 offset:32768
v_mfma_f32_16x16x32_bf16 v[188:191], a[156:159], v[132:135], v[188:191]
ds_read_b64_tr_b16 a[2:3], v12 offset:34816
s_waitcnt vmcnt(9)
v_mfma_f32_16x16x32_bf16 v[176:179], a[160:163], v[136:139], v[176:179]
ds_read_b64_tr_b16 a[4:5], v13 offset:32768
ds_read_b64_tr_b16 a[6:7], v13 offset:34816
v_mfma_f32_16x16x32_bf16 v[180:183], a[164:167], v[136:139], v[180:183]
ds_read_b64_tr_b16 a[8:9], v14 offset:32768
v_mfma_f32_16x16x32_bf16 v[184:187], a[168:171], v[136:139], v[184:187]
ds_read_b64_tr_b16 a[10:11], v14 offset:34816
v_mfma_f32_16x16x32_bf16 v[188:191], a[172:175], v[136:139], v[188:191]
ds_read_b64_tr_b16 a[12:13], v15 offset:32768
s_waitcnt vmcnt(8) lgkmcnt(15)
v_mfma_f32_16x16x32_bf16 v[176:179], a[176:179], v[140:143], v[176:179]
ds_read_b64_tr_b16 a[14:15], v15 offset:34816
ds_read_b64_tr_b16 a[16:17], v12 offset:36864
v_mfma_f32_16x16x32_bf16 v[180:183], a[180:183], v[140:143], v[180:183]
ds_read_b64_tr_b16 a[18:19], v12 offset:38912
v_mfma_f32_16x16x32_bf16 v[184:187], a[184:187], v[140:143], v[184:187]
ds_read_b64_tr_b16 a[20:21], v13 offset:36864
v_mfma_f32_16x16x32_bf16 v[188:191], a[188:191], v[140:143], v[188:191]
ds_read_b64_tr_b16 a[22:23], v13 offset:38912
s_waitcnt vmcnt(7)
v_mfma_f32_16x16x32_bf16 v[176:179], a[192:195], v[144:147], v[176:179]
ds_read_b64_tr_b16 a[24:25], v14 offset:36864
ds_read_b64_tr_b16 a[26:27], v14 offset:38912
v_mfma_f32_16x16x32_bf16 v[180:183], a[196:199], v[144:147], v[180:183]
ds_read_b64_tr_b16 a[28:29], v15 offset:36864
v_mfma_f32_16x16x32_bf16 v[184:187], a[200:203], v[144:147], v[184:187]
ds_read_b64_tr_b16 a[30:31], v15 offset:38912
v_mfma_f32_16x16x32_bf16 v[188:191], a[204:207], v[144:147], v[188:191]
ds_read_b64_tr_b16 a[32:33], v20 offset:0
s_waitcnt vmcnt(6)
v_mfma_f32_16x16x32_bf16 v[176:179], a[208:211], v[148:151], v[176:179]
ds_read_b64_tr_b16 a[34:35], v20 offset:2048
ds_read_b64_tr_b16 a[36:37], v21 offset:0
v_mfma_f32_16x16x32_bf16 v[180:183], a[212:215], v[148:151], v[180:183]
ds_read_b64_tr_b16 a[38:39], v21 offset:2048
v_mfma_f32_16x16x32_bf16 v[184:187], a[216:219], v[148:151], v[184:187]
ds_read_b64_tr_b16 a[40:41], v22 offset:0
v_mfma_f32_16x16x32_bf16 v[188:191], a[220:223], v[148:151], v[188:191]
ds_read_b64_tr_b16 a[42:43], v22 offset:2048
s_waitcnt vmcnt(5)
v_mfma_f32_16x16x32_bf16 v[176:179], a[224:227], v[152:155], v[176:179]
ds_read_b64_tr_b16 a[44:45], v23 offset:0
ds_read_b64_tr_b16 a[46:47], v23 offset:2048
v_mfma_f32_16x16x32_bf16 v[180:183], a[228:231], v[152:155], v[180:183]
ds_read_b64_tr_b16 a[48:49], v20 offset:4096
v_mfma_f32_16x16x32_bf16 v[184:187], a[232:235], v[152:155], v[184:187]
ds_read_b64_tr_b16 a[50:51], v20 offset:6144
v_mfma_f32_16x16x32_bf16 v[188:191], a[236:239], v[152:155], v[188:191]
ds_read_b64_tr_b16 a[52:53], v21 offset:4096
s_waitcnt vmcnt(4) lgkmcnt(15)
v_mfma_f32_16x16x32_bf16 v[176:179], a[240:243], v[156:159], v[176:179]
ds_read_b64_tr_b16 a[54:55], v21 offset:6144
ds_read_b64_tr_b16 a[56:57], v22 offset:4096
v_mfma_f32_16x16x32_bf16 v[180:183], a[244:247], v[156:159], v[180:183]
ds_read_b64_tr_b16 a[58:59], v22 offset:6144
v_mfma_f32_16x16x32_bf16 v[184:187], a[248:251], v[156:159], v[184:187]
ds_read_b64_tr_b16 a[60:61], v23 offset:4096
v_mfma_f32_16x16x32_bf16 v[188:191], a[252:255], v[156:159], v[188:191]
ds_read_b64_tr_b16 a[62:63], v23 offset:6144
s_waitcnt vmcnt(3)
v_mfma_f32_16x16x32_bf16 v[176:179], a[0:3], v[160:163], v[176:179]
v_mfma_f32_16x16x32_bf16 v[180:183], a[4:7], v[160:163], v[180:183]
v_mfma_f32_16x16x32_bf16 v[184:187], a[8:11], v[160:163], v[184:187]
v_mfma_f32_16x16x32_bf16 v[188:191], a[12:15], v[160:163], v[188:191]
s_waitcnt vmcnt(2) lgkmcnt(15)
v_mfma_f32_16x16x32_bf16 v[176:179], a[16:19], v[164:167], v[176:179]
v_mfma_f32_16x16x32_bf16 v[180:183], a[20:23], v[164:167], v[180:183]
v_mfma_f32_16x16x32_bf16 v[184:187], a[24:27], v[164:167], v[184:187]
v_mfma_f32_16x16x32_bf16 v[188:191], a[28:31], v[164:167], v[188:191]
s_waitcnt vmcnt(1) lgkmcnt(8)
v_mfma_f32_16x16x32_bf16 v[176:179], a[32:35], v[168:171], v[176:179]
v_mfma_f32_16x16x32_bf16 v[180:183], a[36:39], v[168:171], v[180:183]
v_mfma_f32_16x16x32_bf16 v[184:187], a[40:43], v[168:171], v[184:187]
v_mfma_f32_16x16x32_bf16 v[188:191], a[44:47], v[168:171], v[188:191]
s_waitcnt vmcnt(0) lgkmcnt(0)
v_mfma_f32_16x16x32_bf16 v[176:179], a[48:51], v[172:175], v[176:179]
v_mfma_f32_16x16x32_bf16 v[180:183], a[52:55], v[172:175], v[180:183]
v_mfma_f32_16x16x32_bf16 v[184:187], a[56:59], v[172:175], v[184:187]
v_mfma_f32_16x16x32_bf16 v[188:191], a[60:63], v[172:175], v[188:191]
s_mov_b32 s72, 0xbfb8aa3b
s_mov_b32 s73, 0xbfb8aa3b
s_nop 2
v_pk_mul_f32 v[64:65], v[176:177], s[72:73]
v_pk_mul_f32 v[66:67], v[178:179], s[72:73]
v_pk_mul_f32 v[68:69], v[180:181], s[72:73]
v_pk_mul_f32 v[70:71], v[182:183], s[72:73]
v_pk_mul_f32 v[72:73], v[184:185], s[72:73]
v_pk_mul_f32 v[74:75], v[186:187], s[72:73]
v_pk_mul_f32 v[76:77], v[188:189], s[72:73]
v_pk_mul_f32 v[78:79], v[190:191], s[72:73]
v_exp_f32 v64, v64
v_exp_f32 v65, v65
v_pk_mul_f32 v[176:177], v[176:177], v[48:49]
v_exp_f32 v66, v66
v_exp_f32 v67, v67
v_pk_mul_f32 v[178:179], v[178:179], v[50:51]
v_exp_f32 v68, v68
v_exp_f32 v69, v69
v_pk_mul_f32 v[180:181], v[180:181], v[52:53]
v_exp_f32 v70, v70
v_exp_f32 v71, v71
v_pk_mul_f32 v[182:183], v[182:183], v[54:55]
v_exp_f32 v72, v72
v_exp_f32 v73, v73
v_pk_mul_f32 v[184:185], v[184:185], v[56:57]
v_exp_f32 v74, v74
v_exp_f32 v75, v75
v_pk_mul_f32 v[186:187], v[186:187], v[58:59]
v_exp_f32 v76, v76
v_exp_f32 v77, v77
v_pk_mul_f32 v[188:189], v[188:189], v[60:61]
v_exp_f32 v78, v78
v_exp_f32 v79, v79
v_pk_mul_f32 v[190:191], v[190:191], v[62:63]
v_pk_add_f32 v[64:65], v[64:65], 1.0 op_sel_hi:[1,0]
v_pk_add_f32 v[66:67], v[66:67], 1.0 op_sel_hi:[1,0]
v_pk_add_f32 v[68:69], v[68:69], 1.0 op_sel_hi:[1,0]
v_pk_add_f32 v[70:71], v[70:71], 1.0 op_sel_hi:[1,0]
v_pk_add_f32 v[72:73], v[72:73], 1.0 op_sel_hi:[1,0]
v_pk_add_f32 v[74:75], v[74:75], 1.0 op_sel_hi:[1,0]
v_pk_add_f32 v[76:77], v[76:77], 1.0 op_sel_hi:[1,0]
v_pk_add_f32 v[78:79], v[78:79], 1.0 op_sel_hi:[1,0]
v_rcp_f32 v64, v64
v_rcp_f32 v65, v65
v_rcp_f32 v66, v66
v_rcp_f32 v67, v67
v_rcp_f32 v68, v68
v_rcp_f32 v69, v69
v_rcp_f32 v70, v70
v_rcp_f32 v71, v71
v_rcp_f32 v72, v72
v_rcp_f32 v73, v73
v_rcp_f32 v74, v74
v_rcp_f32 v75, v75
v_rcp_f32 v76, v76
v_rcp_f32 v77, v77
v_rcp_f32 v78, v78
v_rcp_f32 v79, v79
v_pk_fma_f32 v[176:177], v[176:177], v[64:65], v[32:33]
v_pk_fma_f32 v[178:179], v[178:179], v[66:67], v[34:35]
v_pk_fma_f32 v[180:181], v[180:181], v[68:69], v[36:37]
v_pk_fma_f32 v[182:183], v[182:183], v[70:71], v[38:39]
v_pk_fma_f32 v[184:185], v[184:185], v[72:73], v[40:41]
v_pk_fma_f32 v[186:187], v[186:187], v[74:75], v[42:43]
v_pk_fma_f32 v[188:189], v[188:189], v[76:77], v[44:45]
v_pk_fma_f32 v[190:191], v[190:191], v[78:79], v[46:47]
v_cvt_pk_bf16_f32 v64, v176, v177
v_cvt_pk_bf16_f32 v65, v178, v179
ds_write_b64 v24, v[64:65]
v_cvt_pk_bf16_f32 v66, v180, v181
v_cvt_pk_bf16_f32 v67, v182, v183
ds_write_b64 v25, v[66:67]
v_cvt_pk_bf16_f32 v68, v184, v185
v_cvt_pk_bf16_f32 v69, v186, v187
ds_write_b64 v26, v[68:69]
v_cvt_pk_bf16_f32 v70, v188, v189
v_cvt_pk_bf16_f32 v71, v190, v191
ds_write_b64 v27, v[70:71]
ds_read_b128 v[72:75], v28 offset:0
ds_read_b128 v[76:79], v28 offset:1024
s_waitcnt lgkmcnt(1)
buffer_store_dwordx4 v[72:75], v4, s[28:31], s55 offen sc1
s_waitcnt lgkmcnt(0)
buffer_store_dwordx4 v[76:79], v5, s[28:31], s55 offen sc1
s_cmp_lg_u32 s2, 0
s_cbranch_scc1 L_end
v_mov_b32 v32, s45
v_mov_b32 v33, 0
buffer_store_dword v32, v33, s[24:27], 0 offen sc1
s_endpgm
L_roleS:
s_lshl2_add_u32 s72, s41, s40
s_mul_i32 s73, s72, 12288
v_lshlrev_b32 v196, 7, v0
v_lshlrev_b32 v197, 6, v0
buffer_load_dword v255, v196, s[8:11], s73 offen
s_add_u32 s73, s73, 8192
buffer_load_dword v255, v197, s[8:11], s73 offen
v_lshrrev_b32 v196, 4, v0
v_mul_u32_u24 v196, 3584, v196
v_and_b32 v197, 15, v0
v_min_u32 v197, 13, v197
v_lshl_add_u32 v196, v197, 7, v196
s_mul_i32 s73, s72, 14336
buffer_load_dword v255, v196, s[12:15], s73 offen
s_waitcnt lgkmcnt(0)
s_add_u32 s74, s45, 0x9e3779b9
s_lshl_b32 s72, s41, 13
s_lshl_b32 s73, s40, 8
s_add_u32 s72, s72, s73
s_add_u32 s72, s72, 72704
v_mov_b32 v192, 0
v_mov_b32 v193, 0
v_mov_b32 v194, s74
v_mov_b32 v195, s74
v_and_b32 v198, 0xf0, v1
buffer_store_dwordx4 v[192:195], v198, s[24:27], s72 offen sc1
v_and_b32 v248, 6, v233
v_xor_b32 v248, v248, v232
v_lshlrev_b32 v248, 4, v248
v_lshrrev_b32 v249, 5, v0
v_lshlrev_b32 v249, 3, v249
v_and_b32 v250, 3, v233
v_add_u32 v249, v249, v250
s_and_b32 s72, s40, 1
s_lshr_b32 s73, s40, 1
s_lshl_b32 s74, s72, 4
v_add_u32 v250, s74, v233
v_lshlrev_b32 v250, 10, v250
s_lshl_b32 s74, s73, 7
v_add3_u32 v2, v250, v248, s74
v_add_u32 v3, 7168, v2
s_lshl_b32 s74, s72, 2
s_lshl_b32 s76, s73, 5
s_add_u32 s74, s74, s76
v_add_u32 v250, s74, v249
v_mul_u32_u24 v250, 3072, v250
s_mov_b32 s1, 3
s_lshl_b32 s74, s1, 7
v_add3_u32 v4, v250, v248, s74
v_add_u32 v5, 48128, v4
s_mul_i32 s48, s80, 512
s_add_u32 s56, s48, 32768
s_mul_i32 s64, s80, 1536
s_mul_i32 s49, s81, 512
s_add_u32 s57, s49, 32768
s_mul_i32 s65, s81, 1536
s_mul_i32 s50, s82, 512
s_add_u32 s58, s50, 32768
s_mul_i32 s66, s82, 1536
s_mul_i32 s51, s83, 512
s_add_u32 s59, s51, 32768
s_mul_i32 s67, s83, 1536
s_mul_i32 s52, s84, 512
s_add_u32 s60, s52, 32768
s_mul_i32 s68, s84, 1536
s_mul_i32 s53, s85, 512
s_add_u32 s61, s53, 32768
s_mul_i32 s69, s85, 1536
s_mul_i32 s54, s86, 512
s_add_u32 s62, s54, 32768
s_mul_i32 s70, s86, 1536
s_mul_i32 s55, s87, 512
s_add_u32 s63, s55, 32768
s_mul_i32 s71, s87, 1536
s_lshl_b32 s76, s40, 4
v_add_u32 v250, s76, v233
v_lshlrev_b32 v251, 10, v250
v_add3_u32 v8, v251, v248, s74
v_add_u32 v9, 7168, v8
s_and_b32 s47, s101, 0
s_cmp_ge_u32 s47, 7
s_cselect_b32 s76, 7, 0
s_sub_u32 s47, s47, s76
s_lshl_b32 s97, s47, 17
s_lshl_b32 s74, s41, 18
s_and_b32 s76, s41, 1
s_lshl_b32 s76, s76, 11
s_add_u32 s74, s74, s76
s_and_b32 s76, s101, 1
s_lshl_b32 s76, s76, 9
s_add_u32 s98, s74, s76
s_cmp_eq_u32 s41, 0
s_cselect_b32 s44, 0xf149f2ca, 0
s_lshl_b32 s77, s40, 7
v_lshl_add_u32 v21, v0, 12, s77
v_lshrrev_b32 v250, 2, v232
v_lshlrev_b32 v250, 10, v250
v_and_b32 v251, 3, v232
v_lshl_add_u32 v250, v251, 8, v250
s_add_u32 s74, s46, 16384
v_xor_b32 v251, v234, v232
v_lshl_add_u32 v237, v251, 4, v250
v_add_u32 v237, s74, v237
v_xor_b32 v238, 128, v237
v_and_b32 v250, 15, v0
v_lshrrev_b32 v251, 4, v0
v_xor_b32 v249, v250, v251
v_lshlrev_b32 v249, 4, v249
v_lshl_add_u32 v249, v251, 8, v249
v_add_u32 v10, 16384, v249
v_xor_b32 v11, 1088, v10
v_lshrrev_b32 v249, 2, v250
v_cmp_eq_u32 vcc, v249, v251
v_and_b32 v249, 1, v0
v_lshlrev_b32 v249, 4, v249
v_mov_b32 v176, 0x3f80
v_lshlrev_b32 v249, v249, v176
v_cndmask_b32 v249, 0, v249, vcc
v_and_b32 v250, 2, v0
v_cmp_eq_u32 vcc, 0, v250
v_mov_b32 v176, 0
v_mov_b32 v177, 0
v_mov_b32 v180, 0
v_mov_b32 v181, 0
v_cndmask_b32 v178, 0, v249, vcc
v_sub_u32 v179, v249, v178
v_lshrrev_b32 v249, 2, v0
v_lshlrev_b32 v249, 7, v249
v_and_b32 v250, 3, v0
v_lshl_add_u32 v249, v250, 3, v249
v_and_b32 v250, 3, v233
v_lshl_add_u32 v249, v250, 5, v249
s_lshl_b32 s74, s40, 5
v_xor_b32 v18, s74, v249
s_lshl_b32 s74, s72, 6
s_lshl_b32 s76, s73, 12
s_or_b32 s74, s74, s76
v_xor_b32 v12, s74, v249
v_xor_b32 v13, 32, v12
v_add_u32 v19, 65536, v18
v_add_u32 v14, 65536, v12
v_add_u32 v15, 65536, v13
v_add_u32 v20, 131072, v18
v_add_u32 v16, 131072, v12
v_add_u32 v17, 131072, v13
s_lshl_b32 s74, s40, 6
s_add_u32 s74, s74, 64
v_lshl_add_u32 v240, v234, 2, s74
v_xor_b32 v241, 32, v240
v_and_b32 v243, 15, v0
v_lshlrev_b32 v243, 2, v243
v_and_b32 v218, 31, v0
v_lshlrev_b32 v218, 5, v218
s_xor_b32 s99, s98, 262144
buffer_load_dword v255, v21, s[16:19], s99 offen
s_xor_b32 s99, s98, 262656
buffer_load_dword v255, v21, s[16:19], s99 offen
s_xor_b32 s99, s98, 263168
buffer_load_dword v255, v21, s[16:19], s99 offen
s_xor_b32 s99, s98, 263680
buffer_load_dword v255, v21, s[16:19], s99 offen
s_xor_b32 s99, s98, 0
buffer_load_dword v255, v21, s[16:19], s99 offen
buffer_load_dwordx4 v[96:99], v236, s[4:7], s80 offen
buffer_load_dwordx4 v[100:103], v236, s[4:7], s81 offen
buffer_load_dwordx4 v[104:107], v236, s[4:7], s82 offen
buffer_load_dwordx4 v[108:111], v236, s[4:7], s83 offen
buffer_load_dwordx4 v[112:115], v236, s[4:7], s84 offen
buffer_load_dwordx4 v[116:119], v236, s[4:7], s85 offen
buffer_load_dwordx4 v[120:123], v236, s[4:7], s86 offen
buffer_load_dwordx4 v[124:127], v236, s[4:7], s87 offen
s_add_u32 m0, s46, 81920
s_nop 0
buffer_load_dwordx4 v4, s[8:11], s64 offen offset:0  lds
buffer_load_dwordx4 v5, s[8:11], s64 offen offset:1024  lds
s_add_u32 m0, s46, 89088
s_nop 0
buffer_load_dwordx4 v4, s[8:11], s64 offen offset:1024  lds
buffer_load_dwordx4 v5, s[8:11], s64 offen offset:2048  lds
s_add_u32 m0, s46, 96256
s_nop 0
buffer_load_dwordx4 v4, s[8:11], s64 offen offset:2048  lds
buffer_load_dwordx4 v5, s[8:11], s64 offen offset:3072  lds
s_add_u32 m0, s46, 106496
s_nop 0
buffer_load_dwordx4 v4, s[8:11], s65 offen offset:0  lds
buffer_load_dwordx4 v5, s[8:11], s65 offen offset:1024  lds
s_add_u32 m0, s46, 113664
s_nop 0
buffer_load_dwordx4 v4, s[8:11], s65 offen offset:1024  lds
buffer_load_dwordx4 v5, s[8:11], s65 offen offset:2048  lds
s_add_u32 m0, s46, 120832
s_nop 0
buffer_load_dwordx4 v4, s[8:11], s65 offen offset:2048  lds
buffer_load_dwordx4 v5, s[8:11], s65 offen offset:3072  lds
s_add_u32 m0, s46, 131072
s_nop 0
buffer_load_dwordx4 v4, s[8:11], s66 offen offset:0  lds
buffer_load_dwordx4 v5, s[8:11], s66 offen offset:1024  lds
s_add_u32 m0, s46, 138240
s_nop 0
buffer_load_dwordx4 v4, s[8:11], s66 offen offset:1024  lds
buffer_load_dwordx4 v5, s[8:11], s66 offen offset:2048  lds
s_add_u32 m0, s46, 145408
s_nop 0
buffer_load_dwordx4 v4, s[8:11], s66 offen offset:2048  lds
buffer_load_dwordx4 v5, s[8:11], s66 offen offset:3072  lds
s_add_u32 m0, s46, 155648
s_nop 0
buffer_load_dwordx4 v4, s[8:11], s67 offen offset:0  lds
buffer_load_dwordx4 v5, s[8:11], s67 offen offset:1024  lds
s_xor_b32 s99, s98, 512
buffer_load_dword v255, v21, s[16:19], s99 offen
v_mov_b32 v252, 0
v_mov_b32 v253, 0
s_waitcnt vmcnt(45)
v_dot2c_f32_bf16 v252, s96, v64
v_dot2c_f32_bf16 v253, v64, v64
v_dot2c_f32_bf16 v252, s96, v65
v_dot2c_f32_bf16 v253, v65, v65
v_dot2c_f32_bf16 v252, s96, v66
v_dot2c_f32_bf16 v253, v66, v66
v_dot2c_f32_bf16 v252, s96, v67
v_dot2c_f32_bf16 v253, v67, v67
s_waitcnt vmcnt(44)
v_dot2c_f32_bf16 v252, s96, v68
v_dot2c_f32_bf16 v253, v68, v68
v_dot2c_f32_bf16 v252, s96, v69
v_dot2c_f32_bf16 v253, v69, v69
v_dot2c_f32_bf16 v252, s96, v70
v_dot2c_f32_bf16 v253, v70, v70
v_dot2c_f32_bf16 v252, s96, v71
v_dot2c_f32_bf16 v253, v71, v71
s_waitcnt vmcnt(43)
v_dot2c_f32_bf16 v252, s96, v72
v_dot2c_f32_bf16 v253, v72, v72
v_dot2c_f32_bf16 v252, s96, v73
v_dot2c_f32_bf16 v253, v73, v73
v_dot2c_f32_bf16 v252, s96, v74
v_dot2c_f32_bf16 v253, v74, v74
v_dot2c_f32_bf16 v252, s96, v75
v_dot2c_f32_bf16 v253, v75, v75
s_waitcnt vmcnt(42)
v_dot2c_f32_bf16 v252, s96, v76
v_dot2c_f32_bf16 v253, v76, v76
v_dot2c_f32_bf16 v252, s96, v77
v_dot2c_f32_bf16 v253, v77, v77
v_dot2c_f32_bf16 v252, s96, v78
v_dot2c_f32_bf16 v253, v78, v78
v_dot2c_f32_bf16 v252, s96, v79
v_dot2c_f32_bf16 v253, v79, v79
s_waitcnt vmcnt(41)
v_dot2c_f32_bf16 v252, s96, v80
v_dot2c_f32_bf16 v253, v80, v80
v_dot2c_f32_bf16 v252, s96, v81
v_dot2c_f32_bf16 v253, v81, v81
v_dot2c_f32_bf16 v252, s96, v82
v_dot2c_f32_bf16 v253, v82, v82
v_dot2c_f32_bf16 v252, s96, v83
v_dot2c_f32_bf16 v253, v83, v83
s_waitcnt vmcnt(40)
v_dot2c_f32_bf16 v252, s96, v84
v_dot2c_f32_bf16 v253, v84, v84
v_dot2c_f32_bf16 v252, s96, v85
v_dot2c_f32_bf16 v253, v85, v85
v_dot2c_f32_bf16 v252, s96, v86
v_dot2c_f32_bf16 v253, v86, v86
v_dot2c_f32_bf16 v252, s96, v87
v_dot2c_f32_bf16 v253, v87, v87
s_waitcnt vmcnt(39)
v_dot2c_f32_bf16 v252, s96, v88
v_dot2c_f32_bf16 v253, v88, v88
v_dot2c_f32_bf16 v252, s96, v89
v_dot2c_f32_bf16 v253, v89, v89
v_dot2c_f32_bf16 v252, s96, v90
v_dot2c_f32_bf16 v253, v90, v90
v_dot2c_f32_bf16 v252, s96, v91
v_dot2c_f32_bf16 v253, v91, v91
s_waitcnt vmcnt(38)
v_dot2c_f32_bf16 v252, s96, v92
v_dot2c_f32_bf16 v253, v92, v92
v_dot2c_f32_bf16 v252, s96, v93
v_dot2c_f32_bf16 v253, v93, v93
v_dot2c_f32_bf16 v252, s96, v94
v_dot2c_f32_bf16 v253, v94, v94
v_dot2c_f32_bf16 v252, s96, v95
v_dot2c_f32_bf16 v253, v95, v95
s_nop 1
v_add_f32_dpp v252, v252, v252 quad_perm:[1,0,3,2] row_mask:0xf bank_mask:0xf
v_add_f32_dpp v253, v253, v253 quad_perm:[1,0,3,2] row_mask:0xf bank_mask:0xf
s_nop 0
v_add_f32_dpp v252, v252, v252 quad_perm:[2,3,0,1] row_mask:0xf bank_mask:0xf
v_add_f32_dpp v253, v253, v253 quad_perm:[2,3,0,1] row_mask:0xf bank_mask:0xf
s_nop 0
v_add_f32_dpp v252, v252, v252 row_half_mirror row_mask:0xf bank_mask:0xf
v_add_f32_dpp v253, v253, v253 row_half_mirror row_mask:0xf bank_mask:0xf
v_mul_f32 v184, 0xbb000000, v252
v_mul_f32 v185, 0xbb000000, v252
v_mul_f32 v186, 0xbb000000, v252
v_mul_f32 v187, 0xbb000000, v252
s_nop 1
v_mfma_f32_16x16x32_bf16 v[144:147], v[178:181], v[64:67], v[184:187]
v_mul_f32 v253, 0x3b000000, v253
v_fma_f32 v253, -v184, v184, v253
v_mfma_f32_16x16x32_bf16 v[148:151], v[176:179], v[64:67], v[184:187]
v_max_f32 v253, 0, v253
v_mfma_f32_16x16x32_bf16 v[152:155], v[178:181], v[68:71], v[184:187]
v_add_f32 v253, 0x3727c5ac, v253
v_rsq_f32 v253, v253
v_mfma_f32_16x16x32_bf16 v[156:159], v[176:179], v[68:71], v[184:187]
ds_write_b32 v240, v253
v_mfma_f32_16x16x32_bf16 v[160:163], v[178:181], v[72:75], v[184:187]
v_cvt_pk_bf16_f32 v64, v144, v145
v_cvt_pk_bf16_f32 v65, v146, v147
v_mfma_f32_16x16x32_bf16 v[164:167], v[176:179], v[72:75], v[184:187]
v_cvt_pk_bf16_f32 v66, v148, v149
v_cvt_pk_bf16_f32 v67, v150, v151
ds_write_b128 v237, v[64:67] offset:0
v_mfma_f32_16x16x32_bf16 v[168:171], v[178:181], v[76:79], v[184:187]
v_cvt_pk_bf16_f32 v68, v152, v153
v_cvt_pk_bf16_f32 v69, v154, v155
v_mfma_f32_16x16x32_bf16 v[172:175], v[176:179], v[76:79], v[184:187]
v_cvt_pk_bf16_f32 v70, v156, v157
v_cvt_pk_bf16_f32 v71, v158, v159
v_mfma_f32_16x16x32_bf16 v[144:147], v[178:181], v[80:83], v[184:187]
v_cvt_pk_bf16_f32 v72, v160, v161
v_cvt_pk_bf16_f32 v73, v162, v163
v_mfma_f32_16x16x32_bf16 v[148:151], v[176:179], v[80:83], v[184:187]
v_cvt_pk_bf16_f32 v74, v164, v165
v_cvt_pk_bf16_f32 v75, v166, v167
ds_write_b128 v237, v[72:75] offset:16384
v_mfma_f32_16x16x32_bf16 v[152:155], v[178:181], v[84:87], v[184:187]
v_cvt_pk_bf16_f32 v76, v168, v169
v_cvt_pk_bf16_f32 v77, v170, v171
v_mfma_f32_16x16x32_bf16 v[156:159], v[176:179], v[84:87], v[184:187]
v_cvt_pk_bf16_f32 v78, v172, v173
v_cvt_pk_bf16_f32 v79, v174, v175
v_mfma_f32_16x16x32_bf16 v[160:163], v[178:181], v[88:91], v[184:187]
v_cvt_pk_bf16_f32 v80, v144, v145
v_cvt_pk_bf16_f32 v81, v146, v147
v_mfma_f32_16x16x32_bf16 v[164:167], v[176:179], v[88:91], v[184:187]
v_cvt_pk_bf16_f32 v82, v148, v149
v_cvt_pk_bf16_f32 v83, v150, v151
ds_write_b128 v237, v[80:83] offset:32768
v_mfma_f32_16x16x32_bf16 v[168:171], v[178:181], v[92:95], v[184:187]
v_cvt_pk_bf16_f32 v84, v152, v153
v_cvt_pk_bf16_f32 v85, v154, v155
v_mfma_f32_16x16x32_bf16 v[172:175], v[176:179], v[92:95], v[184:187]
v_cvt_pk_bf16_f32 v86, v156, v157
v_cvt_pk_bf16_f32 v87, v158, v159
v_cvt_pk_bf16_f32 v88, v160, v161
v_cvt_pk_bf16_f32 v89, v162, v163
v_cvt_pk_bf16_f32 v90, v164, v165
v_cvt_pk_bf16_f32 v91, v166, v167
ds_write_b128 v237, v[88:91] offset:49152
v_cvt_pk_bf16_f32 v92, v168, v169
v_cvt_pk_bf16_f32 v93, v170, v171
v_cvt_pk_bf16_f32 v94, v172, v173
v_cvt_pk_bf16_f32 v95, v174, v175
v_mov_b32 v252, 0
v_mov_b32 v253, 0
s_waitcnt vmcnt(28)
v_dot2c_f32_bf16 v252, s96, v96
v_dot2c_f32_bf16 v253, v96, v96
v_dot2c_f32_bf16 v252, s96, v97
v_dot2c_f32_bf16 v253, v97, v97
ds_write_b128 v237, v[68:71] offset:8192
v_dot2c_f32_bf16 v252, s96, v98
v_dot2c_f32_bf16 v253, v98, v98
v_dot2c_f32_bf16 v252, s96, v99
v_dot2c_f32_bf16 v253, v99, v99
s_waitcnt vmcnt(27)
v_dot2c_f32_bf16 v252, s96, v100
v_dot2c_f32_bf16 v253, v100, v100
v_dot2c_f32_bf16 v252, s96, v101
v_dot2c_f32_bf16 v253, v101, v101
v_dot2c_f32_bf16 v252, s96, v102
v_dot2c_f32_bf16 v253, v102, v102
v_dot2c_f32_bf16 v252, s96, v103
v_dot2c_f32_bf16 v253, v103, v103
s_waitcnt vmcnt(26)
v_dot2c_f32_bf16 v252, s96, v104
v_dot2c_f32_bf16 v253, v104, v104
v_dot2c_f32_bf16 v252, s96, v105
v_dot2c_f32_bf16 v253, v105, v105
ds_write_b128 v237, v[76:79] offset:24576
v_dot2c_f32_bf16 v252, s96, v106
v_dot2c_f32_bf16 v253, v106, v106
v_dot2c_f32_bf16 v252, s96, v107
v_dot2c_f32_bf16 v253, v107, v107
s_waitcnt vmcnt(25)
v_dot2c_f32_bf16 v252, s96, v108
v_dot2c_f32_bf16 v253, v108, v108
v_dot2c_f32_bf16 v252, s96, v109
v_dot2c_f32_bf16 v253, v109, v109
v_dot2c_f32_bf16 v252, s96, v110
v_dot2c_f32_bf16 v253, v110, v110
v_dot2c_f32_bf16 v252, s96, v111
v_dot2c_f32_bf16 v253, v111, v111
s_waitcnt vmcnt(24)
v_dot2c_f32_bf16 v252, s96, v112
v_dot2c_f32_bf16 v253, v112, v112
v_dot2c_f32_bf16 v252, s96, v113
v_dot2c_f32_bf16 v253, v113, v113
ds_write_b128 v237, v[84:87] offset:40960
v_dot2c_f32_bf16 v252, s96, v114
v_dot2c_f32_bf16 v253, v114, v114
v_dot2c_f32_bf16 v252, s96, v115
v_dot2c_f32_bf16 v253, v115, v115
s_waitcnt vmcnt(23)
v_dot2c_f32_bf16 v252, s96, v116
v_dot2c_f32_bf16 v253, v116, v116
v_dot2c_f32_bf16 v252, s96, v117
v_dot2c_f32_bf16 v253, v117, v117
v_dot2c_f32_bf16 v252, s96, v118
v_dot2c_f32_bf16 v253, v118, v118
v_dot2c_f32_bf16 v252, s96, v119
v_dot2c_f32_bf16 v253, v119, v119
s_waitcnt vmcnt(22)
v_dot2c_f32_bf16 v252, s96, v120
v_dot2c_f32_bf16 v253, v120, v120
v_dot2c_f32_bf16 v252, s96, v121
v_dot2c_f32_bf16 v253, v121, v121
ds_write_b128 v237, v[92:95] offset:57344
v_dot2c_f32_bf16 v252, s96, v122
v_dot2c_f32_bf16 v253, v122, v122
v_dot2c_f32_bf16 v252, s96, v123
v_dot2c_f32_bf16 v253, v123, v123
s_waitcnt vmcnt(21)
v_dot2c_f32_bf16 v252, s96, v124
v_dot2c_f32_bf16 v253, v124, v124
v_dot2c_f32_bf16 v252, s96, v125
v_dot2c_f32_bf16 v253, v125, v125
v_dot2c_f32_bf16 v252, s96, v126
v_dot2c_f32_bf16 v253, v126, v126
v_dot2c_f32_bf16 v252, s96, v127
v_dot2c_f32_bf16 v253, v127, v127
s_nop 1
v_add_f32_dpp v252, v252, v252 quad_perm:[1,0,3,2] row_mask:0xf bank_mask:0xf
v_add_f32_dpp v253, v253, v253 quad_perm:[1,0,3,2] row_mask:0xf bank_mask:0xf
s_nop 0
v_add_f32_dpp v252, v252, v252 quad_perm:[2,3,0,1] row_mask:0xf bank_mask:0xf
v_add_f32_dpp v253, v253, v253 quad_perm:[2,3,0,1] row_mask:0xf bank_mask:0xf
s_nop 0
v_add_f32_dpp v252, v252, v252 row_half_mirror row_mask:0xf bank_mask:0xf
v_add_f32_dpp v253, v253, v253 row_half_mirror row_mask:0xf bank_mask:0xf
v_mul_f32 v188, 0xbb000000, v252
v_mul_f32 v189, 0xbb000000, v252
v_mul_f32 v190, 0xbb000000, v252
v_mul_f32 v191, 0xbb000000, v252
s_nop 1
v_mfma_f32_16x16x32_bf16 v[144:147], v[178:181], v[96:99], v[188:191]
v_mul_f32 v253, 0x3b000000, v253
v_fma_f32 v253, -v188, v188, v253
v_mfma_f32_16x16x32_bf16 v[148:151], v[176:179], v[96:99], v[188:191]
v_max_f32 v253, 0, v253
v_mfma_f32_16x16x32_bf16 v[152:155], v[178:181], v[100:103], v[188:191]
v_add_f32 v253, 0x3727c5ac, v253
v_rsq_f32 v253, v253
v_mfma_f32_16x16x32_bf16 v[156:159], v[176:179], v[100:103], v[188:191]
ds_write_b32 v241, v253
v_mfma_f32_16x16x32_bf16 v[160:163], v[178:181], v[104:107], v[188:191]
v_cvt_pk_bf16_f32 v96, v144, v145
v_cvt_pk_bf16_f32 v97, v146, v147
v_mfma_f32_16x16x32_bf16 v[164:167], v[176:179], v[104:107], v[188:191]
v_cvt_pk_bf16_f32 v98, v148, v149
v_cvt_pk_bf16_f32 v99, v150, v151
ds_write_b128 v238, v[96:99] offset:0
v_mfma_f32_16x16x32_bf16 v[168:171], v[178:181], v[108:111], v[188:191]
v_cvt_pk_bf16_f32 v100, v152, v153
v_cvt_pk_bf16_f32 v101, v154, v155
v_mfma_f32_16x16x32_bf16 v[172:175], v[176:179], v[108:111], v[188:191]
v_cvt_pk_bf16_f32 v102, v156, v157
v_cvt_pk_bf16_f32 v103, v158, v159
ds_write_b128 v238, v[100:103] offset:8192
v_mfma_f32_16x16x32_bf16 v[144:147], v[178:181], v[112:115], v[188:191]
v_cvt_pk_bf16_f32 v104, v160, v161
v_cvt_pk_bf16_f32 v105, v162, v163
v_mfma_f32_16x16x32_bf16 v[148:151], v[176:179], v[112:115], v[188:191]
v_cvt_pk_bf16_f32 v106, v164, v165
v_cvt_pk_bf16_f32 v107, v166, v167
ds_write_b128 v238, v[104:107] offset:16384
v_mfma_f32_16x16x32_bf16 v[152:155], v[178:181], v[116:119], v[188:191]
v_cvt_pk_bf16_f32 v108, v168, v169
v_cvt_pk_bf16_f32 v109, v170, v171
v_mfma_f32_16x16x32_bf16 v[156:159], v[176:179], v[116:119], v[188:191]
v_cvt_pk_bf16_f32 v110, v172, v173
v_cvt_pk_bf16_f32 v111, v174, v175
ds_write_b128 v238, v[108:111] offset:24576
v_mfma_f32_16x16x32_bf16 v[160:163], v[178:181], v[120:123], v[188:191]
v_cvt_pk_bf16_f32 v112, v144, v145
v_cvt_pk_bf16_f32 v113, v146, v147
v_mfma_f32_16x16x32_bf16 v[164:167], v[176:179], v[120:123], v[188:191]
v_cvt_pk_bf16_f32 v114, v148, v149
v_cvt_pk_bf16_f32 v115, v150, v151
ds_write_b128 v238, v[112:115] offset:32768
v_mfma_f32_16x16x32_bf16 v[168:171], v[178:181], v[124:127], v[188:191]
v_cvt_pk_bf16_f32 v116, v152, v153
v_cvt_pk_bf16_f32 v117, v154, v155
v_mfma_f32_16x16x32_bf16 v[172:175], v[176:179], v[124:127], v[188:191]
v_cvt_pk_bf16_f32 v118, v156, v157
v_cvt_pk_bf16_f32 v119, v158, v159
ds_write_b128 v238, v[116:119] offset:40960
v_cvt_pk_bf16_f32 v120, v160, v161
v_cvt_pk_bf16_f32 v121, v162, v163
v_cvt_pk_bf16_f32 v122, v164, v165
v_cvt_pk_bf16_f32 v123, v166, v167
ds_write_b128 v238, v[120:123] offset:49152
v_cvt_pk_bf16_f32 v124, v168, v169
v_cvt_pk_bf16_f32 v125, v170, v171
v_cvt_pk_bf16_f32 v126, v172, v173
v_cvt_pk_bf16_f32 v127, v174, v175
ds_write_b128 v238, v[124:127] offset:57344
s_add_u32 s45, s45, 0x9e3779b9
s_xor_b32 s99, s98, 1024
buffer_load_dword v255, v21, s[16:19], s99 offen
s_waitcnt vmcnt(16) lgkmcnt(0)
s_barrier
ds_read_b64_tr_b16 v[120:121], v19 offset:16384
ds_read_b64_tr_b16 v[122:123], v19 offset:18432
ds_read_b64_tr_b16 v[124:125], v19 offset:24576
ds_read_b64_tr_b16 v[126:127], v19 offset:26624
ds_read_b64_tr_b16 v[128:129], v19 offset:32768
ds_read_b64_tr_b16 v[130:131], v19 offset:34816
ds_read_b128 a[0:3], v10 offset:0
ds_read_b128 a[4:7], v10 offset:2048
ds_read_b128 a[8:11], v10 offset:4096
ds_read_b128 a[12:15], v10 offset:6144
ds_read_b64_tr_b16 v[132:133], v19 offset:20480
ds_read_b64_tr_b16 v[134:135], v19 offset:22528
ds_read_b64_tr_b16 v[136:137], v19 offset:28672
ds_read_b64_tr_b16 v[138:139], v19 offset:30720
ds_read_b64_tr_b16 v[140:141], v19 offset:36864
ds_read_b64_tr_b16 v[142:143], v19 offset:38912
ds_read_b128 a[16:19], v11 offset:0
ds_read_b128 a[20:23], v11 offset:2048
ds_read_b128 a[24:27], v11 offset:4096
ds_read_b128 a[28:31], v11 offset:6144
ds_read_b32 v22, v243 offset:64
ds_read_b32 v23, v243 offset:128
ds_read_b32 v24, v243 offset:192
ds_read_b32 v25, v243 offset:256
s_waitcnt vmcnt(10) lgkmcnt(14)
s_barrier
v_mfma_f32_16x16x32_bf16 v[84:87], v[124:127], a[0:3], 0
ds_read_b64_tr_b16 v[152:153], v19 offset:40960
v_and_b32 v30, 1, v0
v_mfma_f32_16x16x32_bf16 v[88:91], v[124:127], a[4:7], 0
ds_read_b64_tr_b16 v[154:155], v19 offset:43008
v_cmp_eq_u32 s[80:81], 1, v30
v_mfma_f32_16x16x32_bf16 v[92:95], v[124:127], a[8:11], 0
ds_read_b64_tr_b16 v[156:157], v19 offset:49152
v_lshrrev_b32 v231, 4, v0
v_mfma_f32_16x16x32_bf16 v[96:99], v[124:127], a[12:15], 0
ds_read_b64_tr_b16 v[158:159], v19 offset:51200
v_lshl_add_u32 v231, v231, 2, v30
v_mfma_f32_16x16x32_bf16 v[104:107], a[0:3], v[128:131], 0
ds_read_b64_tr_b16 v[160:161], v19 offset:57344
v_and_b32 v230, 15, v0
v_mfma_f32_16x16x32_bf16 v[108:111], a[4:7], v[128:131], 0
v_cmp_le_u32 s[82:83], v231, v230
v_add_u32 v231, 2, v231
v_mfma_f32_16x16x32_bf16 v[112:115], a[8:11], v[128:131], 0
ds_read_b64_tr_b16 v[162:163], v19 offset:59392
v_cmp_le_u32 s[84:85], v231, v230
v_mfma_f32_16x16x32_bf16 v[116:119], a[12:15], v[128:131], 0
ds_read_b128 a[32:35], v10 offset:8192
v_mov_b32 v230, 0x0c0c0100
v_mfma_f32_16x16x32_bf16 v[64:67], v[120:123], a[0:3], 0
ds_read_b128 a[36:39], v10 offset:10240
v_mov_b32 v231, 0x01000c0c
v_mfma_f32_16x16x32_bf16 v[68:71], v[120:123], a[4:7], 0
ds_read_b128 a[40:43], v10 offset:12288
v_mov_b32 v30, 0x0c0c0c0c
v_mfma_f32_16x16x32_bf16 v[72:75], v[120:123], a[8:11], 0
ds_read_b128 a[44:47], v10 offset:14336
v_cndmask_b32 v230, v230, v231, s[80:81]
v_mfma_f32_16x16x32_bf16 v[76:79], v[120:123], a[12:15], 0
v_cndmask_b32 v226, v230, v30, s[82:83]
s_waitcnt lgkmcnt(14)
v_mfma_f32_16x16x32_bf16 v[84:87], v[136:139], a[16:19], v[84:87]
ds_read_b64_tr_b16 v[164:165], v19 offset:45056
v_cndmask_b32 v228, v30, v230, s[82:83]
v_mfma_f32_16x16x32_bf16 v[88:91], v[136:139], a[20:23], v[88:91]
ds_read_b64_tr_b16 v[166:167], v19 offset:47104
v_mov_b32 v230, 0x0c0c0302
v_mfma_f32_16x16x32_bf16 v[92:95], v[136:139], a[24:27], v[92:95]
ds_read_b64_tr_b16 v[168:169], v19 offset:53248
v_mov_b32 v231, 0x03020c0c
v_mfma_f32_16x16x32_bf16 v[96:99], v[136:139], a[28:31], v[96:99]
ds_read_b64_tr_b16 v[170:171], v19 offset:55296
v_cndmask_b32 v230, v230, v231, s[80:81]
v_mfma_f32_16x16x32_bf16 v[104:107], a[16:19], v[140:143], v[104:107]
ds_read_b64_tr_b16 v[172:173], v19 offset:61440
v_cndmask_b32 v227, v230, v30, s[84:85]
v_mfma_f32_16x16x32_bf16 v[108:111], a[20:23], v[140:143], v[108:111]
v_cndmask_b32 v229, v30, v230, s[84:85]
s_lshl_b32 s78, s41, 5
v_mfma_f32_16x16x32_bf16 v[112:115], a[24:27], v[140:143], v[112:115]
ds_read_b64_tr_b16 v[174:175], v19 offset:63488
s_lshl_b32 s79, s42, 2
v_mfma_f32_16x16x32_bf16 v[116:119], a[28:31], v[140:143], v[116:119]
ds_read_b128 a[48:51], v11 offset:8192
s_add_u32 s78, s78, s79
v_mfma_f32_16x16x32_bf16 v[64:67], v[132:135], a[16:19], v[64:67]
ds_read_b128 a[52:55], v11 offset:10240
s_add_u32 s78, s78, s40
v_mfma_f32_16x16x32_bf16 v[68:71], v[132:135], a[20:23], v[68:71]
ds_read_b128 a[56:59], v11 offset:12288
s_lshl_b32 s77, s78, 11
v_mfma_f32_16x16x32_bf16 v[72:75], v[132:135], a[24:27], v[72:75]
ds_read_b128 a[60:63], v11 offset:14336
s_add_u32 s77, s77, 23068672
v_mfma_f32_16x16x32_bf16 v[76:79], v[132:135], a[28:31], v[76:79]
s_min_u32 s76, s41, 1
s_waitcnt vmcnt(4) lgkmcnt(10)
s_barrier
v_mfma_f32_16x16x32_bf16 v[84:87], v[156:159], a[32:35], v[84:87]
s_add_u32 m0, s46, 80896
s_nop 0
buffer_load_dwordx4 v4, s[8:11], s67 offen offset:1024  lds
v_mfma_f32_16x16x32_bf16 v[88:91], v[156:159], a[36:39], v[88:91]
ds_read_b64_tr_b16 v[120:121], v20 offset:0
ds_read_b64_tr_b16 v[122:123], v20 offset:2048
v_mfma_f32_16x16x32_bf16 v[92:95], v[156:159], a[40:43], v[92:95]
ds_read_b64_tr_b16 v[124:125], v20 offset:8192
s_lshl_b32 s76, s76, 16
v_mfma_f32_16x16x32_bf16 v[96:99], v[156:159], a[44:47], v[96:99]
ds_read_b64_tr_b16 v[126:127], v20 offset:10240
s_sub_u32 s76, s77, s76
v_mfma_f32_16x16x32_bf16 v[104:107], a[32:35], v[160:163], v[104:107]
buffer_load_dwordx4 v5, s[8:11], s67 offen offset:2048  lds
s_add_u32 m0, s46, 88064
v_mfma_f32_16x16x32_bf16 v[108:111], a[36:39], v[160:163], v[108:111]
ds_read_b64_tr_b16 v[128:129], v20 offset:16384
s_lshl_b32 s79, s78, 5
v_mfma_f32_16x16x32_bf16 v[112:115], a[40:43], v[160:163], v[112:115]
ds_read_b64_tr_b16 v[130:131], v20 offset:18432
s_add_u32 s79, s79, 1605632
v_mfma_f32_16x16x32_bf16 v[116:119], a[44:47], v[160:163], v[116:119]
buffer_load_dwordx4 v4, s[8:11], s67 offen offset:2048  lds
v_mfma_f32_16x16x32_bf16 v[64:67], v[152:155], a[32:35], v[64:67]
ds_read_b128 a[64:67], v10 offset:16384
ds_read_b128 a[68:71], v10 offset:18432
v_mfma_f32_16x16x32_bf16 v[68:71], v[152:155], a[36:39], v[68:71]
ds_read_b128 a[72:75], v10 offset:20480
s_lshr_b32 s74, s40, 1
v_mfma_f32_16x16x32_bf16 v[72:75], v[152:155], a[40:43], v[72:75]
ds_read_b128 a[76:79], v10 offset:22528
s_and_b32 s75, s40, 1
v_mfma_f32_16x16x32_bf16 v[76:79], v[152:155], a[44:47], v[76:79]
buffer_load_dwordx4 v5, s[8:11], s67 offen offset:3072  lds
s_add_u32 m0, s46, 98304
s_waitcnt lgkmcnt(10)
v_mfma_f32_16x16x32_bf16 v[84:87], v[168:171], a[48:51], v[84:87]
ds_read_b64_tr_b16 v[132:133], v20 offset:4096
s_lshl1_add_u32 s78, s41, s75
v_mfma_f32_16x16x32_bf16 v[88:91], v[168:171], a[52:55], v[88:91]
ds_read_b64_tr_b16 v[134:135], v20 offset:6144
s_lshl_b32 s78, s78, 5
v_mfma_f32_16x16x32_bf16 v[92:95], v[168:171], a[56:59], v[92:95]
buffer_load_dwordx4 v4, s[8:11], s68 offen offset:0  lds
v_mfma_f32_16x16x32_bf16 v[96:99], v[168:171], a[60:63], v[96:99]
ds_read_b64_tr_b16 v[136:137], v20 offset:12288
ds_read_b64_tr_b16 v[138:139], v20 offset:14336
v_mfma_f32_16x16x32_bf16 v[104:107], a[48:51], v[172:175], v[104:107]
ds_read_b64_tr_b16 v[140:141], v20 offset:20480
s_add_u32 s78, s78, s74
v_mfma_f32_16x16x32_bf16 v[108:111], a[52:55], v[172:175], v[108:111]
s_lshl1_add_u32 s78, s1, s78
s_lshl_b32 s78, s78, 10
v_mfma_f32_16x16x32_bf16 v[112:115], a[56:59], v[172:175], v[112:115]
buffer_load_dwordx4 v5, s[8:11], s68 offen offset:1024  lds
v_mfma_f32_16x16x32_bf16 v[116:119], a[60:63], v[172:175], v[116:119]
ds_read_b64_tr_b16 v[142:143], v20 offset:22528
ds_read_b128 a[80:83], v11 offset:16384
v_mfma_f32_16x16x32_bf16 v[64:67], v[164:167], a[48:51], v[64:67]
ds_read_b128 a[84:87], v11 offset:18432
s_add_u32 s78, s78, 6291456
v_mfma_f32_16x16x32_bf16 v[68:71], v[164:167], a[52:55], v[68:71]
ds_read_b128 a[88:91], v11 offset:20480
s_lshl_b32 s74, s74, 12
v_mfma_f32_16x16x32_bf16 v[72:75], v[164:167], a[56:59], v[72:75]
ds_read_b128 a[92:95], v11 offset:22528
s_lshl3_add_u32 s74, s75, s74
v_mfma_f32_16x16x32_bf16 v[76:79], v[164:167], a[60:63], v[76:79]
s_add_u32 s74, s74, 8192
s_waitcnt vmcnt(2) lgkmcnt(10)
s_barrier
v_mfma_f32_16x16x32_bf16 v[84:87], v[124:127], a[64:67], v[84:87]
s_add_u32 m0, s46, 105472
s_nop 0
buffer_load_dwordx4 v4, s[8:11], s68 offen offset:1024  lds
v_mfma_f32_16x16x32_bf16 v[88:91], v[124:127], a[68:71], v[88:91]
ds_read_b64_tr_b16 v[152:153], v20 offset:24576
ds_read_b64_tr_b16 v[154:155], v20 offset:26624
v_mfma_f32_16x16x32_bf16 v[92:95], v[124:127], a[72:75], v[92:95]
ds_read_b64_tr_b16 v[156:157], v19 offset:16384
v_and_b32 v230, 0x30, v0
v_mfma_f32_16x16x32_bf16 v[96:99], v[124:127], a[76:79], v[96:99]
ds_read_b64_tr_b16 v[158:159], v19 offset:18432
v_add_u32 v231, s74, v1
v_mfma_f32_16x16x32_bf16 v[104:107], a[64:67], v[128:131], v[104:107]
buffer_load_dwordx4 v5, s[8:11], s68 offen offset:2048  lds
s_add_u32 m0, s46, 112640
v_mfma_f32_16x16x32_bf16 v[108:111], a[68:71], v[128:131], v[108:111]
ds_read_b64_tr_b16 v[160:161], v19 offset:24576
v_mfma_f32_16x16x32_bf16 v[112:115], a[72:75], v[128:131], v[112:115]
ds_read_b64_tr_b16 v[162:163], v19 offset:26624
v_mfma_f32_16x16x32_bf16 v[116:119], a[76:79], v[128:131], v[116:119]
buffer_load_dwordx4 v4, s[8:11], s68 offen offset:2048  lds
v_mfma_f32_16x16x32_bf16 v[64:67], v[120:123], a[64:67], v[64:67]
ds_read_b128 a[96:99], v10 offset:24576
ds_read_b128 a[100:103], v10 offset:26624
v_mfma_f32_16x16x32_bf16 v[68:71], v[120:123], a[68:71], v[68:71]
ds_read_b128 a[104:107], v10 offset:28672
v_mfma_f32_16x16x32_bf16 v[72:75], v[120:123], a[72:75], v[72:75]
ds_read_b128 a[108:111], v10 offset:30720
v_mfma_f32_16x16x32_bf16 v[76:79], v[120:123], a[76:79], v[76:79]
buffer_load_dwordx4 v5, s[8:11], s68 offen offset:3072  lds
s_add_u32 m0, s46, 122880
s_waitcnt lgkmcnt(10)
v_mfma_f32_16x16x32_bf16 v[84:87], v[136:139], a[80:83], v[84:87]
ds_read_b64_tr_b16 v[164:165], v20 offset:28672
v_mfma_f32_16x16x32_bf16 v[88:91], v[136:139], a[84:87], v[88:91]
ds_read_b64_tr_b16 v[166:167], v20 offset:30720
v_mfma_f32_16x16x32_bf16 v[92:95], v[136:139], a[88:91], v[92:95]
buffer_load_dwordx4 v4, s[8:11], s69 offen offset:0  lds
v_mfma_f32_16x16x32_bf16 v[96:99], v[136:139], a[92:95], v[96:99]
ds_read_b64_tr_b16 v[168:169], v19 offset:20480
ds_read_b64_tr_b16 v[170:171], v19 offset:22528
v_mfma_f32_16x16x32_bf16 v[104:107], a[80:83], v[140:143], v[104:107]
ds_read_b64_tr_b16 v[172:173], v19 offset:28672
v_mfma_f32_16x16x32_bf16 v[108:111], a[84:87], v[140:143], v[108:111]
v_mfma_f32_16x16x32_bf16 v[112:115], a[88:91], v[140:143], v[112:115]
buffer_load_dwordx4 v5, s[8:11], s69 offen offset:1024  lds
v_mfma_f32_16x16x32_bf16 v[116:119], a[92:95], v[140:143], v[116:119]
ds_read_b64_tr_b16 v[174:175], v19 offset:30720
ds_read_b128 a[112:115], v11 offset:24576
v_mfma_f32_16x16x32_bf16 v[64:67], v[132:135], a[80:83], v[64:67]
ds_read_b128 a[116:119], v11 offset:26624
v_mfma_f32_16x16x32_bf16 v[68:71], v[132:135], a[84:87], v[68:71]
ds_read_b128 a[120:123], v11 offset:28672
v_mfma_f32_16x16x32_bf16 v[72:75], v[132:135], a[88:91], v[72:75]
ds_read_b128 a[124:127], v11 offset:30720
v_mfma_f32_16x16x32_bf16 v[76:79], v[132:135], a[92:95], v[76:79]
s_waitcnt vmcnt(2) lgkmcnt(10)
s_barrier
v_mfma_f32_16x16x32_bf16 v[84:87], v[156:159], a[96:99], v[84:87]
s_add_u32 m0, s46, 130048
s_nop 0
buffer_load_dwordx4 v4, s[8:11], s69 offen offset:1024  lds
v_mfma_f32_16x16x32_bf16 v[88:91], v[156:159], a[100:103], v[88:91]
ds_read_b64_tr_b16 v[120:121], v19 offset:32768
ds_read_b64_tr_b16 v[122:123], v19 offset:34816
v_mfma_f32_16x16x32_bf16 v[92:95], v[156:159], a[104:107], v[92:95]
ds_read_b64_tr_b16 v[124:125], v19 offset:40960
v_mfma_f32_16x16x32_bf16 v[96:99], v[156:159], a[108:111], v[96:99]
ds_read_b64_tr_b16 v[126:127], v19 offset:43008
v_mfma_f32_16x16x32_bf16 v[104:107], a[96:99], v[160:163], v[104:107]
buffer_load_dwordx4 v5, s[8:11], s69 offen offset:2048  lds
s_add_u32 m0, s46, 137216
v_mfma_f32_16x16x32_bf16 v[108:111], a[100:103], v[160:163], v[108:111]
ds_read_b64_tr_b16 v[128:129], v19 offset:49152
v_mfma_f32_16x16x32_bf16 v[112:115], a[104:107], v[160:163], v[112:115]
ds_read_b64_tr_b16 v[130:131], v19 offset:51200
v_mfma_f32_16x16x32_bf16 v[116:119], a[108:111], v[160:163], v[116:119]
buffer_load_dwordx4 v4, s[8:11], s69 offen offset:2048  lds
v_mfma_f32_16x16x32_bf16 v[64:67], v[152:155], a[96:99], v[64:67]
ds_read_b128 a[128:131], v10 offset:32768
ds_read_b128 a[132:135], v10 offset:34816
v_mfma_f32_16x16x32_bf16 v[68:71], v[152:155], a[100:103], v[68:71]
ds_read_b128 a[136:139], v10 offset:36864
v_mfma_f32_16x16x32_bf16 v[72:75], v[152:155], a[104:107], v[72:75]
ds_read_b128 a[140:143], v10 offset:38912
v_mfma_f32_16x16x32_bf16 v[76:79], v[152:155], a[108:111], v[76:79]
buffer_load_dwordx4 v5, s[8:11], s69 offen offset:3072  lds
s_add_u32 m0, s46, 147456
s_waitcnt lgkmcnt(10)
v_mfma_f32_16x16x32_bf16 v[84:87], v[168:171], a[112:115], v[84:87]
ds_read_b64_tr_b16 v[132:133], v19 offset:36864
v_mfma_f32_16x16x32_bf16 v[88:91], v[168:171], a[116:119], v[88:91]
ds_read_b64_tr_b16 v[134:135], v19 offset:38912
v_mfma_f32_16x16x32_bf16 v[92:95], v[168:171], a[120:123], v[92:95]
buffer_load_dwordx4 v4, s[8:11], s70 offen offset:0  lds
v_mfma_f32_16x16x32_bf16 v[96:99], v[168:171], a[124:127], v[96:99]
ds_read_b64_tr_b16 v[136:137], v19 offset:45056
ds_read_b64_tr_b16 v[138:139], v19 offset:47104
v_mfma_f32_16x16x32_bf16 v[104:107], a[112:115], v[172:175], v[104:107]
ds_read_b64_tr_b16 v[140:141], v19 offset:53248
v_mfma_f32_16x16x32_bf16 v[108:111], a[116:119], v[172:175], v[108:111]
v_mfma_f32_16x16x32_bf16 v[112:115], a[120:123], v[172:175], v[112:115]
buffer_load_dwordx4 v5, s[8:11], s70 offen offset:1024  lds
v_mfma_f32_16x16x32_bf16 v[116:119], a[124:127], v[172:175], v[116:119]
ds_read_b64_tr_b16 v[142:143], v19 offset:55296
ds_read_b128 a[144:147], v11 offset:32768
v_mfma_f32_16x16x32_bf16 v[64:67], v[164:167], a[112:115], v[64:67]
ds_read_b128 a[148:151], v11 offset:34816
v_mfma_f32_16x16x32_bf16 v[68:71], v[164:167], a[116:119], v[68:71]
ds_read_b128 a[152:155], v11 offset:36864
v_mfma_f32_16x16x32_bf16 v[72:75], v[164:167], a[120:123], v[72:75]
ds_read_b128 a[156:159], v11 offset:38912
v_mfma_f32_16x16x32_bf16 v[76:79], v[164:167], a[124:127], v[76:79]
s_waitcnt vmcnt(2) lgkmcnt(10)
s_barrier
v_mfma_f32_16x16x32_bf16 v[84:87], v[124:127], a[128:131], v[84:87]
s_add_u32 m0, s46, 154624
s_nop 0
buffer_load_dwordx4 v4, s[8:11], s70 offen offset:1024  lds
v_mfma_f32_16x16x32_bf16 v[88:91], v[124:127], a[132:135], v[88:91]
ds_read_b64_tr_b16 v[152:153], v19 offset:57344
ds_read_b64_tr_b16 v[154:155], v19 offset:59392
v_mfma_f32_16x16x32_bf16 v[92:95], v[124:127], a[136:139], v[92:95]
ds_read_b64_tr_b16 v[156:157], v20 offset:0
v_mfma_f32_16x16x32_bf16 v[96:99], v[124:127], a[140:143], v[96:99]
ds_read_b64_tr_b16 v[158:159], v20 offset:2048
v_mfma_f32_16x16x32_bf16 v[104:107], a[128:131], v[128:131], v[104:107]
buffer_load_dwordx4 v5, s[8:11], s70 offen offset:2048  lds
s_add_u32 m0, s46, 79872
v_mfma_f32_16x16x32_bf16 v[108:111], a[132:135], v[128:131], v[108:111]
ds_read_b64_tr_b16 v[160:161], v20 offset:8192
v_mfma_f32_16x16x32_bf16 v[112:115], a[136:139], v[128:131], v[112:115]
ds_read_b64_tr_b16 v[162:163], v20 offset:10240
v_mfma_f32_16x16x32_bf16 v[116:119], a[140:143], v[128:131], v[116:119]
buffer_load_dwordx4 v4, s[8:11], s70 offen offset:2048  lds
v_mfma_f32_16x16x32_bf16 v[64:67], v[120:123], a[128:131], v[64:67]
ds_read_b128 a[160:163], v10 offset:40960
ds_read_b128 a[164:167], v10 offset:43008
v_mfma_f32_16x16x32_bf16 v[68:71], v[120:123], a[132:135], v[68:71]
ds_read_b128 a[168:171], v10 offset:45056
v_mfma_f32_16x16x32_bf16 v[72:75], v[120:123], a[136:139], v[72:75]
ds_read_b128 a[172:175], v10 offset:47104
v_mfma_f32_16x16x32_bf16 v[76:79], v[120:123], a[140:143], v[76:79]
buffer_load_dwordx4 v5, s[8:11], s70 offen offset:3072  lds
s_add_u32 m0, s46, 90112
s_waitcnt lgkmcnt(10)
v_mfma_f32_16x16x32_bf16 v[84:87], v[136:139], a[144:147], v[84:87]
ds_read_b64_tr_b16 v[164:165], v19 offset:61440
v_mfma_f32_16x16x32_bf16 v[88:91], v[136:139], a[148:151], v[88:91]
ds_read_b64_tr_b16 v[166:167], v19 offset:63488
v_mfma_f32_16x16x32_bf16 v[92:95], v[136:139], a[152:155], v[92:95]
buffer_load_dwordx4 v4, s[8:11], s71 offen offset:0  lds
v_mfma_f32_16x16x32_bf16 v[96:99], v[136:139], a[156:159], v[96:99]
ds_read_b64_tr_b16 v[168:169], v20 offset:4096
ds_read_b64_tr_b16 v[170:171], v20 offset:6144
v_mfma_f32_16x16x32_bf16 v[104:107], a[144:147], v[140:143], v[104:107]
ds_read_b64_tr_b16 v[172:173], v20 offset:12288
v_mfma_f32_16x16x32_bf16 v[108:111], a[148:151], v[140:143], v[108:111]
v_mfma_f32_16x16x32_bf16 v[112:115], a[152:155], v[140:143], v[112:115]
buffer_load_dwordx4 v5, s[8:11], s71 offen offset:1024  lds
v_mfma_f32_16x16x32_bf16 v[116:119], a[156:159], v[140:143], v[116:119]
ds_read_b64_tr_b16 v[174:175], v20 offset:14336
ds_read_b128 a[176:179], v11 offset:40960
v_mfma_f32_16x16x32_bf16 v[64:67], v[132:135], a[144:147], v[64:67]
ds_read_b128 a[180:183], v11 offset:43008
v_mfma_f32_16x16x32_bf16 v[68:71], v[132:135], a[148:151], v[68:71]
ds_read_b128 a[184:187], v11 offset:45056
v_mfma_f32_16x16x32_bf16 v[72:75], v[132:135], a[152:155], v[72:75]
ds_read_b128 a[188:191], v11 offset:47104
v_mfma_f32_16x16x32_bf16 v[76:79], v[132:135], a[156:159], v[76:79]
s_waitcnt vmcnt(2) lgkmcnt(10)
s_barrier
v_mfma_f32_16x16x32_bf16 v[84:87], v[156:159], a[160:163], v[84:87]
s_add_u32 m0, s46, 97280
s_nop 0
buffer_load_dwordx4 v4, s[8:11], s71 offen offset:1024  lds
v_mfma_f32_16x16x32_bf16 v[88:91], v[156:159], a[164:167], v[88:91]
ds_read_b64_tr_b16 v[120:121], v20 offset:16384
ds_read_b64_tr_b16 v[122:123], v20 offset:18432
v_mfma_f32_16x16x32_bf16 v[92:95], v[156:159], a[168:171], v[92:95]
ds_read_b64_tr_b16 v[124:125], v20 offset:24576
v_mfma_f32_16x16x32_bf16 v[96:99], v[156:159], a[172:175], v[96:99]
ds_read_b64_tr_b16 v[126:127], v20 offset:26624
v_mfma_f32_16x16x32_bf16 v[104:107], a[160:163], v[160:163], v[104:107]
buffer_load_dwordx4 v5, s[8:11], s71 offen offset:2048  lds
s_add_u32 m0, s46, 104448
v_mfma_f32_16x16x32_bf16 v[108:111], a[164:167], v[160:163], v[108:111]
ds_read_b64_tr_b16 v[128:129], v19 offset:16384
v_mfma_f32_16x16x32_bf16 v[112:115], a[168:171], v[160:163], v[112:115]
ds_read_b64_tr_b16 v[130:131], v19 offset:18432
v_mfma_f32_16x16x32_bf16 v[116:119], a[172:175], v[160:163], v[116:119]
buffer_load_dwordx4 v4, s[8:11], s71 offen offset:2048  lds
v_mfma_f32_16x16x32_bf16 v[64:67], v[152:155], a[160:163], v[64:67]
ds_read_b128 a[192:195], v10 offset:49152
ds_read_b128 a[196:199], v10 offset:51200
v_mfma_f32_16x16x32_bf16 v[68:71], v[152:155], a[164:167], v[68:71]
ds_read_b128 a[200:203], v10 offset:53248
v_mfma_f32_16x16x32_bf16 v[72:75], v[152:155], a[168:171], v[72:75]
ds_read_b128 a[204:207], v10 offset:55296
v_mfma_f32_16x16x32_bf16 v[76:79], v[152:155], a[172:175], v[76:79]
buffer_load_dwordx4 v5, s[8:11], s71 offen offset:3072  lds
s_waitcnt lgkmcnt(10)
v_mfma_f32_16x16x32_bf16 v[84:87], v[168:171], a[176:179], v[84:87]
ds_read_b64_tr_b16 v[132:133], v20 offset:20480
v_mfma_f32_16x16x32_bf16 v[88:91], v[168:171], a[180:183], v[88:91]
ds_read_b64_tr_b16 v[134:135], v20 offset:22528
v_mfma_f32_16x16x32_bf16 v[92:95], v[168:171], a[184:187], v[92:95]
ds_read_b64_tr_b16 v[136:137], v20 offset:28672
v_mfma_f32_16x16x32_bf16 v[96:99], v[168:171], a[188:191], v[96:99]
ds_read_b64_tr_b16 v[138:139], v20 offset:30720
v_mfma_f32_16x16x32_bf16 v[104:107], a[176:179], v[172:175], v[104:107]
ds_read_b64_tr_b16 v[140:141], v19 offset:20480
v_mfma_f32_16x16x32_bf16 v[108:111], a[180:183], v[172:175], v[108:111]
v_mfma_f32_16x16x32_bf16 v[112:115], a[184:187], v[172:175], v[112:115]
ds_read_b64_tr_b16 v[142:143], v19 offset:22528
v_mfma_f32_16x16x32_bf16 v[116:119], a[188:191], v[172:175], v[116:119]
ds_read_b128 a[208:211], v11 offset:49152
v_mfma_f32_16x16x32_bf16 v[64:67], v[164:167], a[176:179], v[64:67]
ds_read_b128 a[212:215], v11 offset:51200
v_mfma_f32_16x16x32_bf16 v[68:71], v[164:167], a[180:183], v[68:71]
ds_read_b128 a[216:219], v11 offset:53248
v_mfma_f32_16x16x32_bf16 v[72:75], v[164:167], a[184:187], v[72:75]
ds_read_b128 a[220:223], v11 offset:55296
v_mfma_f32_16x16x32_bf16 v[76:79], v[164:167], a[188:191], v[76:79]
s_waitcnt vmcnt(0) lgkmcnt(10)
s_barrier
v_mfma_f32_16x16x32_bf16 v[84:87], v[124:127], a[192:195], v[84:87]
ds_read_b64_tr_b16 v[152:153], v19 offset:24576
v_mfma_f32_16x16x32_bf16 v[88:91], v[124:127], a[196:199], v[88:91]
ds_read_b64_tr_b16 v[154:155], v19 offset:26624
v_mfma_f32_16x16x32_bf16 v[92:95], v[124:127], a[200:203], v[92:95]
ds_read_b64_tr_b16 v[156:157], v19 offset:32768
v_mfma_f32_16x16x32_bf16 v[96:99], v[124:127], a[204:207], v[96:99]
ds_read_b64_tr_b16 v[158:159], v19 offset:34816
v_mfma_f32_16x16x32_bf16 v[104:107], a[192:195], v[128:131], v[104:107]
ds_read_b64_tr_b16 v[160:161], v19 offset:40960
v_mfma_f32_16x16x32_bf16 v[108:111], a[196:199], v[128:131], v[108:111]
v_mfma_f32_16x16x32_bf16 v[112:115], a[200:203], v[128:131], v[112:115]
ds_read_b64_tr_b16 v[162:163], v19 offset:43008
v_mfma_f32_16x16x32_bf16 v[116:119], a[204:207], v[128:131], v[116:119]
ds_read_b128 a[224:227], v10 offset:57344
v_mfma_f32_16x16x32_bf16 v[64:67], v[120:123], a[192:195], v[64:67]
ds_read_b128 a[228:231], v10 offset:59392
v_mfma_f32_16x16x32_bf16 v[68:71], v[120:123], a[196:199], v[68:71]
ds_read_b128 a[232:235], v10 offset:61440
v_mfma_f32_16x16x32_bf16 v[72:75], v[120:123], a[200:203], v[72:75]
ds_read_b128 a[236:239], v10 offset:63488
v_mfma_f32_16x16x32_bf16 v[76:79], v[120:123], a[204:207], v[76:79]
s_waitcnt lgkmcnt(10)
v_mfma_f32_16x16x32_bf16 v[84:87], v[136:139], a[208:211], v[84:87]
ds_read_b64_tr_b16 v[164:165], v19 offset:28672
v_mfma_f32_16x16x32_bf16 v[88:91], v[136:139], a[212:215], v[88:91]
ds_read_b64_tr_b16 v[166:167], v19 offset:30720
v_mfma_f32_16x16x32_bf16 v[92:95], v[136:139], a[216:219], v[92:95]
ds_read_b64_tr_b16 v[168:169], v19 offset:36864
v_mfma_f32_16x16x32_bf16 v[96:99], v[136:139], a[220:223], v[96:99]
ds_read_b64_tr_b16 v[170:171], v19 offset:38912
v_mfma_f32_16x16x32_bf16 v[104:107], a[208:211], v[140:143], v[104:107]
ds_read_b64_tr_b16 v[172:173], v19 offset:45056
v_mfma_f32_16x16x32_bf16 v[108:111], a[212:215], v[140:143], v[108:111]
v_mfma_f32_16x16x32_bf16 v[112:115], a[216:219], v[140:143], v[112:115]
ds_read_b64_tr_b16 v[174:175], v19 offset:47104
v_mfma_f32_16x16x32_bf16 v[116:119], a[220:223], v[140:143], v[116:119]
ds_read_b128 a[240:243], v11 offset:57344
v_mfma_f32_16x16x32_bf16 v[64:67], v[132:135], a[208:211], v[64:67]
ds_read_b128 a[244:247], v11 offset:59392
v_mfma_f32_16x16x32_bf16 v[68:71], v[132:135], a[212:215], v[68:71]
ds_read_b128 a[248:251], v11 offset:61440
v_mfma_f32_16x16x32_bf16 v[72:75], v[132:135], a[216:219], v[72:75]
ds_read_b128 a[252:255], v11 offset:63488
v_mfma_f32_16x16x32_bf16 v[76:79], v[132:135], a[220:223], v[76:79]
s_waitcnt lgkmcnt(10)
s_barrier
v_mfma_f32_16x16x32_bf16 v[84:87], v[156:159], a[224:227], v[84:87]
v_mfma_f32_16x16x32_bf16 v[88:91], v[156:159], a[228:231], v[88:91]
v_mfma_f32_16x16x32_bf16 v[92:95], v[156:159], a[232:235], v[92:95]
v_mfma_f32_16x16x32_bf16 v[96:99], v[156:159], a[236:239], v[96:99]
v_mfma_f32_16x16x32_bf16 v[104:107], a[224:227], v[160:163], v[104:107]
v_mfma_f32_16x16x32_bf16 v[108:111], a[228:231], v[160:163], v[108:111]
v_mfma_f32_16x16x32_bf16 v[112:115], a[232:235], v[160:163], v[112:115]
v_mfma_f32_16x16x32_bf16 v[116:119], a[236:239], v[160:163], v[116:119]
v_mfma_f32_16x16x32_bf16 v[64:67], v[152:155], a[224:227], v[64:67]
v_mfma_f32_16x16x32_bf16 v[68:71], v[152:155], a[228:231], v[68:71]
v_mfma_f32_16x16x32_bf16 v[72:75], v[152:155], a[232:235], v[72:75]
v_mfma_f32_16x16x32_bf16 v[76:79], v[152:155], a[236:239], v[76:79]
s_waitcnt lgkmcnt(0)
v_mfma_f32_16x16x32_bf16 v[84:87], v[168:171], a[240:243], v[84:87]
v_mfma_f32_16x16x32_bf16 v[88:91], v[168:171], a[244:247], v[88:91]
v_mfma_f32_16x16x32_bf16 v[92:95], v[168:171], a[248:251], v[92:95]
v_mfma_f32_16x16x32_bf16 v[96:99], v[168:171], a[252:255], v[96:99]
v_mfma_f32_16x16x32_bf16 v[104:107], a[240:243], v[172:175], v[104:107]
v_mfma_f32_16x16x32_bf16 v[108:111], a[244:247], v[172:175], v[108:111]
v_mfma_f32_16x16x32_bf16 v[112:115], a[248:251], v[172:175], v[112:115]
v_mfma_f32_16x16x32_bf16 v[116:119], a[252:255], v[172:175], v[116:119]
v_mfma_f32_16x16x32_bf16 v[64:67], v[164:167], a[240:243], v[64:67]
v_mfma_f32_16x16x32_bf16 v[68:71], v[164:167], a[244:247], v[68:71]
v_mfma_f32_16x16x32_bf16 v[72:75], v[164:167], a[248:251], v[72:75]
v_mfma_f32_16x16x32_bf16 v[76:79], v[164:167], a[252:255], v[76:79]
s_barrier
ds_read_b128 v[80:83], v230 offset:256
v_mul_f32 v96, v25, v96
v_mul_f32 v97, v25, v97
v_mul_f32 v98, v25, v98
v_mul_f32 v99, v25, v99
v_cvt_pk_bf16_f32 v100, v96, v97
v_cvt_pk_bf16_f32 v101, v98, v99
v_mov_b32 v102, s45
s_waitcnt lgkmcnt(0)
v_mul_f32 v116, v80, v116
v_mul_f32 v117, v81, v117
v_mul_f32 v118, v82, v118
v_mul_f32 v119, v83, v119
buffer_store_dwordx4 v[100:103], v1, s[24:27], s77 offen sc1
v_cvt_pk_bf16_f32 v80, v116, v117
v_cvt_pk_bf16_f32 v81, v118, v119
v_mov_b32 v82, s45
buffer_store_dwordx4 v[80:83], v1, s[24:27], s77 offen offset:1024 sc1
buffer_load_dwordx4 v[56:59], v1, s[24:27], s76 offen sc1
buffer_load_dwordx4 v[60:63], v1, s[24:27], s76 offen offset:1024 sc1
ds_read_b128 v[156:159], v230 offset:64
ds_read_b128 v[160:163], v230 offset:128
ds_read_b128 v[164:167], v230 offset:192
v_mul_f32 v180, 0x3eb8aa3b, v22
v_mul_f32 v181, 0x3eb8aa3b, v23
v_mul_f32 v182, 0x3eb8aa3b, v24
v_mul_f32 v183, 0x3eb8aa3b, v25
v_mov_b32 v172, s96
v_mov_b32 v173, s96
v_mov_b32 v174, s96
v_mov_b32 v175, s96
v_mov_b32 v176, s44
v_mov_b32 v177, s44
v_mov_b32 v178, s44
v_mov_b32 v179, s44
v_pk_mul_f32 v[64:65], v[64:65], v[180:181] op_sel_hi:[1,0]
v_pk_mul_f32 v[66:67], v[66:67], v[180:181] op_sel_hi:[1,0]
v_cvt_pk_bf16_f32 v64, v64, v65
v_cvt_pk_bf16_f32 v65, v66, v67
v_pk_mul_f32 v[68:69], v[68:69], v[180:181] op_sel:[0,1] op_sel_hi:[1,1]
v_pk_mul_f32 v[70:71], v[70:71], v[180:181] op_sel:[0,1] op_sel_hi:[1,1]
v_cvt_pk_bf16_f32 v66, v68, v69
v_cvt_pk_bf16_f32 v67, v70, v71
v_pk_mul_f32 v[72:73], v[72:73], v[182:183] op_sel_hi:[1,0]
v_pk_mul_f32 v[74:75], v[74:75], v[182:183] op_sel_hi:[1,0]
v_cvt_pk_bf16_f32 v68, v72, v73
v_cvt_pk_bf16_f32 v69, v74, v75
v_pk_mul_f32 v[76:77], v[76:77], v[182:183] op_sel:[0,1] op_sel_hi:[1,1]
v_pk_mul_f32 v[78:79], v[78:79], v[182:183] op_sel:[0,1] op_sel_hi:[1,1]
v_cvt_pk_bf16_f32 v70, v76, v77
v_cvt_pk_bf16_f32 v71, v78, v79
v_pk_mul_f32 v[84:85], v[84:85], v[22:23] op_sel_hi:[1,0]
v_pk_mul_f32 v[86:87], v[86:87], v[22:23] op_sel_hi:[1,0]
v_cvt_pk_bf16_f32 v82, v84, v85
v_cvt_pk_bf16_f32 v83, v86, v87
v_pk_mul_f32 v[88:89], v[88:89], v[22:23] op_sel:[0,1] op_sel_hi:[1,1]
v_pk_mul_f32 v[90:91], v[90:91], v[22:23] op_sel:[0,1] op_sel_hi:[1,1]
v_cvt_pk_bf16_f32 v84, v88, v89
v_cvt_pk_bf16_f32 v85, v90, v91
v_pk_mul_f32 v[92:93], v[92:93], v[24:25] op_sel_hi:[1,0]
v_pk_mul_f32 v[94:95], v[94:95], v[24:25] op_sel_hi:[1,0]
v_cvt_pk_bf16_f32 v86, v92, v93
v_cvt_pk_bf16_f32 v87, v94, v95
v_cvt_pk_bf16_f32 v88, v96, v97
v_cvt_pk_bf16_f32 v89, v98, v99
s_waitcnt lgkmcnt(2)
v_pk_mul_f32 v[104:105], v[104:105], v[156:157]
v_pk_mul_f32 v[106:107], v[106:107], v[158:159]
v_cvt_pk_bf16_f32 v102, v104, v105
v_cvt_pk_bf16_f32 v103, v106, v107
s_waitcnt lgkmcnt(1)
v_pk_mul_f32 v[108:109], v[108:109], v[160:161]
v_pk_mul_f32 v[110:111], v[110:111], v[162:163]
v_cvt_pk_bf16_f32 v104, v108, v109
v_cvt_pk_bf16_f32 v105, v110, v111
s_waitcnt lgkmcnt(0)
v_pk_mul_f32 v[112:113], v[112:113], v[164:165]
v_pk_mul_f32 v[114:115], v[114:115], v[166:167]
v_cvt_pk_bf16_f32 v106, v112, v113
v_cvt_pk_bf16_f32 v107, v114, v115
v_cvt_pk_bf16_f32 v108, v116, v117
v_cvt_pk_bf16_f32 v109, v118, v119
v_mfma_f32_16x16x16_bf16 v[156:159], v[82:83], v[64:65], 0
v_mfma_f32_16x16x16_bf16 v[160:163], v[82:83], v[66:67], 0
v_mfma_f32_16x16x16_bf16 v[164:167], v[84:85], v[66:67], 0
v_mfma_f32_16x16x16_bf16 v[168:171], v[84:85], v[68:69], 0
v_mfma_f32_16x16x16_bf16 v[72:75], v[86:87], v[68:69], 0
v_mfma_f32_16x16x16_bf16 v[76:79], v[86:87], v[70:71], 0
v_mfma_f32_16x16x16_bf16 v[92:95], v[88:89], v[70:71], 0
s_nop 3
v_cndmask_b32 v164, v164, v165, s[80:81]
v_cndmask_b32 v166, v166, v167, s[80:81]
v_cndmask_b32 v160, v160, v161, s[80:81]
v_cndmask_b32 v162, v162, v163, s[80:81]
v_cndmask_b32 v164, v160, v164, s[82:83]
v_cndmask_b32 v165, v162, v166, s[84:85]
v_max_f32 v166, v164, v165
v_cndmask_b32 v72, v72, v73, s[80:81]
v_cndmask_b32 v74, v74, v75, s[80:81]
v_cndmask_b32 v168, v168, v169, s[80:81]
v_cndmask_b32 v170, v170, v171, s[80:81]
v_cndmask_b32 v72, v168, v72, s[82:83]
v_cndmask_b32 v73, v170, v74, s[84:85]
v_max_f32 v74, v72, v73
v_cndmask_b32 v92, v92, v93, s[80:81]
v_cndmask_b32 v94, v94, v95, s[80:81]
v_cndmask_b32 v76, v76, v77, s[80:81]
v_cndmask_b32 v78, v78, v79, s[80:81]
v_cndmask_b32 v92, v76, v92, s[82:83]
v_cndmask_b32 v93, v78, v94, s[84:85]
v_max_f32 v94, v92, v93
v_mov_b32 v167, v166
v_mov_b32 v75, v74
v_mov_b32 v95, v94
v_permlane16_swap_b32 v166, v167
v_permlane16_swap_b32 v74, v75
v_permlane16_swap_b32 v94, v95
v_max_f32 v166, v166, v167
v_max_f32 v74, v74, v75
v_max_f32 v94, v94, v95
v_mov_b32 v167, v166
v_mov_b32 v75, v74
v_mov_b32 v95, v94
v_permlane32_swap_b32 v166, v167
v_permlane32_swap_b32 v74, v75
v_permlane32_swap_b32 v94, v95
v_max_f32 v166, v166, v167
v_max_f32 v74, v74, v75
v_max_f32 v94, v94, v95
v_sub_f32 v164, v164, v166
v_sub_f32 v165, v165, v166
v_exp_f32 v164, v164
v_exp_f32 v165, v165
v_sub_f32 v72, v72, v74
v_sub_f32 v73, v73, v74
v_exp_f32 v72, v72
v_exp_f32 v73, v73
v_sub_f32 v92, v92, v94
v_sub_f32 v93, v93, v94
v_exp_f32 v92, v92
v_exp_f32 v93, v93
v_cvt_pk_bf16_f32 v164, v164, v165
v_perm_b32 v160, v164, v164, v226
v_perm_b32 v161, v164, v164, v227
v_perm_b32 v162, v164, v164, v228
v_perm_b32 v163, v164, v164, v229
v_cvt_pk_bf16_f32 v72, v72, v73
v_perm_b32 v168, v72, v72, v226
v_perm_b32 v169, v72, v72, v227
v_perm_b32 v170, v72, v72, v228
v_perm_b32 v171, v72, v72, v229
v_cvt_pk_bf16_f32 v92, v92, v93
v_perm_b32 v76, v92, v92, v226
v_perm_b32 v77, v92, v92, v227
v_perm_b32 v78, v92, v92, v228
v_perm_b32 v79, v92, v92, v229
v_mfma_f32_16x16x32_bf16 v[68:71], v[172:175], v[160:163], 0
v_mfma_f32_16x16x32_bf16 v[84:87], v[172:175], v[168:171], 0
v_mfma_f32_16x16x32_bf16 v[88:91], v[172:175], v[76:79], 0
v_mfma_f32_16x16x32_bf16 v[164:167], v[102:105], v[160:163], 0
v_mfma_f32_16x16x32_bf16 v[72:75], v[104:107], v[168:171], 0
v_mfma_f32_16x16x32_bf16 v[92:95], v[106:109], v[76:79], 0
s_waitcnt vmcnt(1)
v_xor_b32 v59, s45, v58
s_waitcnt vmcnt(0)
v_xor_b32 v63, s45, v62
v_or_b32 v59, v59, v63
v_cmp_ne_u32 vcc, 0, v59
s_nop 0
s_cbranch_vccnz L_kv_15
L_kvb_16:
v_mfma_f32_16x16x16_bf16 v[152:155], v[56:57], v[64:65], v[176:179]
v_mov_b32 v100, v60
v_mov_b32 v101, v61
v_rcp_f32 v68, v68
v_rcp_f32 v84, v84
v_rcp_f32 v88, v88
v_pk_mul_f32 v[164:165], v[164:165], v[68:69] op_sel_hi:[1,0]
v_pk_mul_f32 v[166:167], v[166:167], v[68:69] op_sel_hi:[1,0]
v_cvt_pk_bf16_f32 v164, v164, v165
v_cvt_pk_bf16_f32 v165, v166, v167
ds_write_b64 v231, v[164:165] offset:1024
v_pk_mul_f32 v[72:73], v[72:73], v[84:85] op_sel_hi:[1,0]
v_pk_mul_f32 v[74:75], v[74:75], v[84:85] op_sel_hi:[1,0]
v_cvt_pk_bf16_f32 v72, v72, v73
v_cvt_pk_bf16_f32 v73, v74, v75
ds_write_b64 v231, v[72:73] offset:2048
v_pk_mul_f32 v[92:93], v[92:93], v[88:89] op_sel_hi:[1,0]
v_pk_mul_f32 v[94:95], v[94:95], v[88:89] op_sel_hi:[1,0]
v_cvt_pk_bf16_f32 v92, v92, v93
v_cvt_pk_bf16_f32 v93, v94, v95
ds_write_b64 v231, v[92:93] offset:3072
v_cndmask_b32 v156, v156, v157, s[80:81]
v_cndmask_b32 v158, v158, v159, s[80:81]
v_cndmask_b32 v152, v152, v153, s[80:81]
v_cndmask_b32 v154, v154, v155, s[80:81]
v_cndmask_b32 v156, v152, v156, s[82:83]
v_cndmask_b32 v157, v154, v158, s[84:85]
v_max_f32 v158, v156, v157
v_mov_b32 v159, v158
s_nop 1
v_permlane16_swap_b32 v158, v159
v_max_f32 v158, v158, v159
v_mov_b32 v159, v158
s_nop 1
v_permlane32_swap_b32 v158, v159
v_max_f32 v158, v158, v159
v_sub_f32 v156, v156, v158
v_sub_f32 v157, v157, v158
v_exp_f32 v156, v156
v_exp_f32 v157, v157
s_nop 0
v_cvt_pk_bf16_f32 v156, v156, v157
v_perm_b32 v152, v156, v156, v226
v_perm_b32 v153, v156, v156, v227
v_perm_b32 v154, v156, v156, v228
v_perm_b32 v155, v156, v156, v229
s_nop 1
v_mfma_f32_16x16x32_bf16 v[80:83], v[172:175], v[152:155], 0
v_mfma_f32_16x16x32_bf16 v[156:159], v[100:103], v[152:155], 0
v_mov_b32 v226, s45
v_mov_b32 v227, 0
v_add_u32 v228, s46, v1
s_nop 3
v_rcp_f32 v80, v80
s_nop 0
v_pk_mul_f32 v[156:157], v[156:157], v[80:81] op_sel_hi:[1,0]
v_pk_mul_f32 v[158:159], v[158:159], v[80:81] op_sel_hi:[1,0]
v_cvt_pk_bf16_f32 v156, v156, v157
v_cvt_pk_bf16_f32 v157, v158, v159
ds_write_b64 v231, v[156:157] offset:0
s_waitcnt lgkmcnt(0)
s_barrier
s_lshr_b32 s76, s46, 1
v_add_u32 v229, s76, v1
ds_read_b128 v[96:99], v229 offset:8192
ds_read_b128 v[100:103], v229 offset:12288
ds_read_b128 v[176:179], v228 offset:8192
ds_read_b128 v[180:183], v228 offset:9216
s_waitcnt lgkmcnt(1)
buffer_store_dwordx4 v[176:179], v1, s[24:27], s78 offen sc1
s_add_u32 s78, s78, 16384
s_waitcnt lgkmcnt(0)
buffer_store_dwordx4 v[180:183], v1, s[24:27], s78 offen sc1
s_xor_b32 s99, s98, 1536
buffer_load_dword v255, v21, s[16:19], s99 offen
s_waitcnt vmcnt(1)
buffer_store_dword v226, v227, s[24:27], s79 offen sc1
s_lshl2_add_u32 s72, s41, s40
s_lshl_b32 s72, s72, 13
v_lshlrev_b32 v7, 7, v0
buffer_load_dword v255, v7, s[20:23], s72 offen
s_lshr_b32 s72, s72, 1
v_lshlrev_b32 v7, 6, v0
buffer_load_dword v255, v7, s[36:39], s72 offen
s_barrier
v_lshrrev_b32 v4, 3, v0
v_and_b32 v5, 7, v0
v_xor_b32 v5, v5, v4
v_lshlrev_b32 v4, 10, v4
v_lshl_add_u32 v4, v5, 4, v4
v_add_u32 v5, 7168, v4
s_lshl2_add_u32 s55, s41, s40
s_lshl_b32 s55, s55, 14
s_lshl_b32 s48, s1, 7
s_add_u32 s55, s55, s48
s_mov_b32 s62, s1
s_lshl_b32 s61, s62, 16
s_lshl_b32 s62, s62, 11
s_lshl2_add_u32 s63, s41, s40
s_lshl_b32 s63, s63, 14
s_add_u32 s62, s62, s63
s_add_u32 s62, s62, 6291456
s_lshl_b32 s59, s41, 10
s_add_u32 s58, s59, 1638400
s_add_u32 s59, s59, 1605632
s_add_u32 m0, s46, 8192
s_nop 0
buffer_load_dwordx4 v4, s[4:7], s55 offen lds
buffer_load_dwordx4 v5, s[4:7], s55 offen offset:1024 lds
buffer_load_dword v228, v218, s[24:27], s59 offen sc1
s_add_u32 m0, s46, 16384
s_xor_b32 s60, s61, 0
buffer_load_dwordx4 v8, s[36:39], s60 offen offset:0  lds
buffer_load_dwordx4 v9, s[36:39], s60 offen offset:1024  lds
s_add_u32 m0, s46, 24576
s_xor_b32 s60, s61, 65536
buffer_load_dwordx4 v8, s[36:39], s60 offen offset:0  lds
buffer_load_dwordx4 v9, s[36:39], s60 offen offset:1024  lds
s_add_u32 m0, s46, 32768
s_xor_b32 s60, s61, 131072
buffer_load_dwordx4 v8, s[36:39], s60 offen offset:0  lds
buffer_load_dwordx4 v9, s[36:39], s60 offen offset:1024  lds
s_add_u32 m0, s46, 40960
s_xor_b32 s60, s61, 196608
buffer_load_dwordx4 v8, s[36:39], s60 offen offset:0  lds
buffer_load_dwordx4 v9, s[36:39], s60 offen offset:1024  lds
s_add_u32 m0, s46, 49152
s_xor_b32 s60, s61, 262144
buffer_load_dwordx4 v8, s[36:39], s60 offen offset:0  lds
buffer_load_dwordx4 v9, s[36:39], s60 offen offset:1024  lds
s_add_u32 m0, s46, 57344
s_xor_b32 s60, s61, 327680
buffer_load_dwordx4 v8, s[36:39], s60 offen offset:0  lds
buffer_load_dwordx4 v9, s[36:39], s60 offen offset:1024  lds
s_add_u32 m0, s46, 65536
s_xor_b32 s60, s61, 393216
buffer_load_dwordx4 v8, s[36:39], s60 offen offset:0  lds
buffer_load_dwordx4 v9, s[36:39], s60 offen offset:1024  lds
s_add_u32 m0, s46, 73728
s_xor_b32 s60, s61, 458752
buffer_load_dwordx4 v8, s[36:39], s60 offen offset:0  lds
buffer_load_dwordx4 v9, s[36:39], s60 offen offset:1024  lds
v_and_b32 v25, 15, v0
v_lshrrev_b32 v26, 5, v0
v_and_b32 v27, 7, v0
v_xor_b32 v26, v26, v27
v_lshlrev_b32 v26, 4, v26
v_lshl_add_u32 v26, v25, 7, v26
v_bfe_u32 v27, v0, 4, 1
v_lshl_add_u32 v26, v27, 3, v26
s_add_u32 s56, s46, 8192
v_add_u32 v24, s56, v26
v_xor_b32 v25, 32, v24
v_xor_b32 v26, 64, v24
v_xor_b32 v27, 96, v24
v_add_u32 v28, s56, v1
s_lshl_b32 s56, s40, 5
v_xor_b32 v29, s56, v18
v_xor_b32 v12, 0, v29
v_xor_b32 v13, 32, v29
v_xor_b32 v14, 64, v29
v_xor_b32 v15, 96, v29
v_xor_b32 v16, 65536, v29
v_xor_b32 v17, 65568, v29
v_xor_b32 v18, 65600, v29
v_xor_b32 v19, 65632, v29
v_xor_b32 v20, 131072, v29
v_xor_b32 v21, 131104, v29
v_xor_b32 v22, 131136, v29
v_xor_b32 v23, 131168, v29
v_and_b32 v29, 2, v0
v_lshlrev_b32 v29, 10, v29
s_lshl2_add_u32 s56, s41, s40
s_mul_i32 s56, s56, 28672
s_add_u32 s56, s56, 8388608
s_mov_b32 s68, s56
s_add_u32 s48, s47, 0
s_mul_i32 s57, s48, 37
s_lshr_b32 s57, s57, 8
s_mul_i32 s57, s57, 7
s_sub_u32 s48, s48, s57
s_lshl_b32 s48, s48, 12
s_add_u32 s48, s48, s56
s_add_u32 s49, s47, 1
s_mul_i32 s57, s49, 37
s_lshr_b32 s57, s57, 8
s_mul_i32 s57, s57, 7
s_sub_u32 s49, s49, s57
s_lshl_b32 s49, s49, 12
s_add_u32 s49, s49, s56
s_add_u32 s50, s47, 2
s_mul_i32 s57, s50, 37
s_lshr_b32 s57, s57, 8
s_mul_i32 s57, s57, 7
s_sub_u32 s50, s50, s57
s_lshl_b32 s50, s50, 12
s_add_u32 s50, s50, s56
s_add_u32 s51, s47, 3
s_mul_i32 s57, s51, 37
s_lshr_b32 s57, s57, 8
s_mul_i32 s57, s57, 7
s_sub_u32 s51, s51, s57
s_lshl_b32 s51, s51, 12
s_add_u32 s51, s51, s56
s_add_u32 s52, s47, 4
s_mul_i32 s57, s52, 37
s_lshr_b32 s57, s57, 8
s_mul_i32 s57, s57, 7
s_sub_u32 s52, s52, s57
s_lshl_b32 s52, s52, 12
s_add_u32 s52, s52, s56
s_add_u32 s53, s47, 5
s_mul_i32 s57, s53, 37
s_lshr_b32 s57, s57, 8
s_mul_i32 s57, s57, 7
s_sub_u32 s53, s53, s57
s_lshl_b32 s53, s53, 12
s_add_u32 s53, s53, s56
s_add_u32 s54, s47, 6
s_mul_i32 s57, s54, 37
s_lshr_b32 s57, s57, 8
s_mul_i32 s57, s57, 7
s_sub_u32 s54, s54, s57
s_lshl_b32 s54, s54, 12
s_add_u32 s54, s54, s56
s_waitcnt vmcnt(16)
v_cmp_ne_u32 vcc, s45, v228
s_nop 0
s_cbranch_vccnz L_of_17
L_ofb_18:
s_xor_b32 s63, s62, 2048
buffer_load_dwordx4 a[8:11], v1, s[24:27], s63 offen offset:0 sc1
buffer_load_dwordx4 a[12:15], v1, s[24:27], s63 offen offset:1024 sc1
s_xor_b32 s63, s62, 4096
buffer_load_dwordx4 a[16:19], v1, s[24:27], s63 offen offset:0 sc1
buffer_load_dwordx4 a[20:23], v1, s[24:27], s63 offen offset:1024 sc1
s_xor_b32 s63, s62, 6144
buffer_load_dwordx4 a[24:27], v1, s[24:27], s63 offen offset:0 sc1
buffer_load_dwordx4 a[28:31], v1, s[24:27], s63 offen offset:1024 sc1
s_xor_b32 s63, s62, 8192
buffer_load_dwordx4 a[32:35], v1, s[24:27], s63 offen offset:0 sc1
buffer_load_dwordx4 a[36:39], v1, s[24:27], s63 offen offset:1024 sc1
s_xor_b32 s63, s62, 10240
buffer_load_dwordx4 a[40:43], v1, s[24:27], s63 offen offset:0 sc1
buffer_load_dwordx4 a[44:47], v1, s[24:27], s63 offen offset:1024 sc1
s_xor_b32 s63, s62, 12288
buffer_load_dwordx4 a[48:51], v1, s[24:27], s63 offen offset:0 sc1
buffer_load_dwordx4 a[52:55], v1, s[24:27], s63 offen offset:1024 sc1
s_xor_b32 s63, s62, 14336
buffer_load_dwordx4 a[56:59], v1, s[24:27], s63 offen offset:0 sc1
buffer_load_dwordx4 a[60:63], v1, s[24:27], s63 offen offset:1024 sc1
v_min_u32 v246, 6, v0
s_lshl_b32 s72, s40, 28
v_lshl_add_u32 v246, v246, 7, s72
v_mov_b32 v249, s45
v_mov_b32 v248, 0
s_waitcnt vmcnt(20)
s_barrier
ds_read_b64 v[224:225], v24
ds_read_b64 v[226:227], v25
ds_read_b64 v[228:229], v26
ds_read_b64 v[230:231], v27
ds_read_b64_tr_b16 a[64:65], v12 offset:16384
ds_read_b64_tr_b16 a[66:67], v12 offset:18432
s_add_u32 m0, s46, 81920
s_nop 0
buffer_load_dwordx4 v8, s[20:23], s97 offen offset:0  lds
ds_read_b64_tr_b16 a[68:69], v13 offset:16384
ds_read_b64_tr_b16 a[70:71], v13 offset:18432
ds_read_b64_tr_b16 a[72:73], v14 offset:16384
ds_read_b64_tr_b16 a[74:75], v14 offset:18432
ds_read_b64_tr_b16 a[76:77], v15 offset:16384
ds_read_b64_tr_b16 a[78:79], v15 offset:18432
ds_read_b64_tr_b16 a[80:81], v12 offset:20480
ds_read_b64_tr_b16 a[82:83], v12 offset:22528
ds_read_b64_tr_b16 a[84:85], v13 offset:20480
ds_read_b64_tr_b16 a[86:87], v13 offset:22528
buffer_load_dwordx4 v9, s[20:23], s97 offen offset:1024  lds
s_add_u32 s97, s97, 0x10000
s_cmp_eq_u32 s97, 917504
s_cselect_b32 s97, 0, s97
ds_read_b64_tr_b16 a[88:89], v14 offset:20480
ds_read_b64_tr_b16 a[90:91], v14 offset:22528
ds_read_b64_tr_b16 a[92:93], v15 offset:20480
ds_read_b64_tr_b16 a[94:95], v15 offset:22528
ds_read_b64_tr_b16 a[96:97], v12 offset:24576
ds_read_b64_tr_b16 a[98:99], v12 offset:26624
ds_read_b64_tr_b16 a[100:101], v13 offset:24576
s_add_u32 m0, s46, 90112
s_nop 0
buffer_load_dwordx4 v8, s[20:23], s97 offen offset:0  lds
ds_read_b64_tr_b16 a[102:103], v13 offset:26624
ds_read_b64_tr_b16 a[104:105], v14 offset:24576
ds_read_b64_tr_b16 a[106:107], v14 offset:26624
ds_read_b64_tr_b16 a[108:109], v15 offset:24576
ds_read_b64_tr_b16 a[110:111], v15 offset:26624
s_waitcnt lgkmcnt(15)
v_mfma_f32_16x16x32_bf16 v[48:51], a[64:67], v[96:99], 0
ds_read_b64_tr_b16 a[112:113], v12 offset:28672
ds_read_b64_tr_b16 a[114:115], v12 offset:30720
v_mfma_f32_16x16x32_bf16 v[52:55], a[68:71], v[96:99], 0
buffer_load_dwordx4 v9, s[20:23], s97 offen offset:1024  lds
s_add_u32 s97, s97, 0x10000
s_cmp_eq_u32 s97, 917504
s_cselect_b32 s97, 0, s97
ds_read_b64_tr_b16 a[116:117], v13 offset:28672
ds_read_b64_tr_b16 a[118:119], v13 offset:30720
v_mfma_f32_16x16x32_bf16 v[56:59], a[72:75], v[96:99], 0
ds_read_b64_tr_b16 a[120:121], v14 offset:28672
ds_read_b64_tr_b16 a[122:123], v14 offset:30720
v_mfma_f32_16x16x32_bf16 v[60:63], a[76:79], v[96:99], 0
s_add_u32 m0, s46, 98304
s_nop 0
buffer_load_dwordx4 v8, s[20:23], s97 offen offset:0  lds
ds_read_b64_tr_b16 a[124:125], v15 offset:28672
ds_read_b64_tr_b16 a[126:127], v15 offset:30720
s_waitcnt lgkmcnt(15)
v_mfma_f32_16x16x32_bf16 v[48:51], a[80:83], v[100:103], v[48:51]
ds_read_b64_tr_b16 a[128:129], v12 offset:32768
ds_read_b64_tr_b16 a[130:131], v12 offset:34816
v_mfma_f32_16x16x32_bf16 v[52:55], a[84:87], v[100:103], v[52:55]
ds_read_b64_tr_b16 a[132:133], v13 offset:32768
ds_read_b64_tr_b16 a[134:135], v13 offset:34816
v_mfma_f32_16x16x32_bf16 v[56:59], a[88:91], v[100:103], v[56:59]
buffer_load_dwordx4 v9, s[20:23], s97 offen offset:1024  lds
s_add_u32 s97, s97, 0x10000
s_cmp_eq_u32 s97, 917504
s_cselect_b32 s97, 0, s97
ds_read_b64_tr_b16 a[136:137], v14 offset:32768
ds_read_b64_tr_b16 a[138:139], v14 offset:34816
v_mfma_f32_16x16x32_bf16 v[60:63], a[92:95], v[100:103], v[60:63]
ds_read_b64_tr_b16 a[140:141], v15 offset:32768
ds_read_b64_tr_b16 a[142:143], v15 offset:34816
s_waitcnt vmcnt(19) lgkmcnt(15)
v_mfma_f32_16x16x32_bf16 v[48:51], a[96:99], a[8:11], v[48:51]
s_add_u32 m0, s46, 106496
s_nop 0
buffer_load_dwordx4 v8, s[20:23], s97 offen offset:0  lds
ds_read_b64_tr_b16 a[144:145], v12 offset:36864
ds_read_b64_tr_b16 a[146:147], v12 offset:38912
v_mfma_f32_16x16x32_bf16 v[52:55], a[100:103], a[8:11], v[52:55]
ds_read_b64_tr_b16 a[148:149], v13 offset:36864
ds_read_b64_tr_b16 a[150:151], v13 offset:38912
v_mfma_f32_16x16x32_bf16 v[56:59], a[104:107], a[8:11], v[56:59]
ds_read_b64_tr_b16 a[152:153], v14 offset:36864
ds_read_b64_tr_b16 a[154:155], v14 offset:38912
v_mfma_f32_16x16x32_bf16 v[60:63], a[108:111], a[8:11], v[60:63]
buffer_load_dwordx4 v9, s[20:23], s97 offen offset:1024  lds
s_add_u32 s97, s97, 0x10000
s_cmp_eq_u32 s97, 917504
s_cselect_b32 s97, 0, s97
ds_read_b64_tr_b16 a[156:157], v15 offset:36864
ds_read_b64_tr_b16 a[158:159], v15 offset:38912
s_waitcnt vmcnt(20) lgkmcnt(15)
v_mfma_f32_16x16x32_bf16 v[48:51], a[112:115], a[12:15], v[48:51]
ds_read_b64_tr_b16 a[160:161], v12 offset:40960
ds_read_b64_tr_b16 a[162:163], v12 offset:43008
v_mfma_f32_16x16x32_bf16 v[52:55], a[116:119], a[12:15], v[52:55]
s_add_u32 m0, s46, 114688
s_nop 0
buffer_load_dwordx4 v8, s[20:23], s97 offen offset:0  lds
ds_read_b64_tr_b16 a[164:165], v13 offset:40960
ds_read_b64_tr_b16 a[166:167], v13 offset:43008
v_mfma_f32_16x16x32_bf16 v[56:59], a[120:123], a[12:15], v[56:59]
ds_read_b64_tr_b16 a[168:169], v14 offset:40960
ds_read_b64_tr_b16 a[170:171], v14 offset:43008
v_mfma_f32_16x16x32_bf16 v[60:63], a[124:127], a[12:15], v[60:63]
ds_read_b64_tr_b16 a[172:173], v15 offset:40960
ds_read_b64_tr_b16 a[174:175], v15 offset:43008
s_waitcnt vmcnt(20) lgkmcnt(15)
v_mfma_f32_16x16x32_bf16 v[48:51], a[128:131], a[16:19], v[48:51]
buffer_load_dwordx4 v9, s[20:23], s97 offen offset:1024  lds
s_add_u32 s97, s97, 0x10000
s_cmp_eq_u32 s97, 917504
s_cselect_b32 s97, 0, s97
ds_read_b64_tr_b16 a[176:177], v12 offset:45056
ds_read_b64_tr_b16 a[178:179], v12 offset:47104
v_mfma_f32_16x16x32_bf16 v[52:55], a[132:135], a[16:19], v[52:55]
ds_read_b64_tr_b16 a[180:181], v13 offset:45056
ds_read_b64_tr_b16 a[182:183], v13 offset:47104
v_mfma_f32_16x16x32_bf16 v[56:59], a[136:139], a[16:19], v[56:59]
s_add_u32 m0, s46, 122880
s_nop 0
buffer_load_dwordx4 v8, s[20:23], s97 offen offset:0  lds
ds_read_b64_tr_b16 a[184:185], v14 offset:45056
ds_read_b64_tr_b16 a[186:187], v14 offset:47104
v_mfma_f32_16x16x32_bf16 v[60:63], a[140:143], a[16:19], v[60:63]
ds_read_b64_tr_b16 a[188:189], v15 offset:45056
ds_read_b64_tr_b16 a[190:191], v15 offset:47104
s_waitcnt vmcnt(21) lgkmcnt(15)
v_mfma_f32_16x16x32_bf16 v[48:51], a[144:147], a[20:23], v[48:51]
ds_read_b64_tr_b16 a[192:193], v12 offset:49152
ds_read_b64_tr_b16 a[194:195], v12 offset:51200
v_mfma_f32_16x16x32_bf16 v[52:55], a[148:151], a[20:23], v[52:55]
buffer_load_dwordx4 v9, s[20:23], s97 offen offset:1024  lds
s_add_u32 s97, s97, 0x10000
s_cmp_eq_u32 s97, 917504
s_cselect_b32 s97, 0, s97
ds_read_b64_tr_b16 a[196:197], v13 offset:49152
ds_read_b64_tr_b16 a[198:199], v13 offset:51200
v_mfma_f32_16x16x32_bf16 v[56:59], a[152:155], a[20:23], v[56:59]
ds_read_b64_tr_b16 a[200:201], v14 offset:49152
ds_read_b64_tr_b16 a[202:203], v14 offset:51200
v_mfma_f32_16x16x32_bf16 v[60:63], a[156:159], a[20:23], v[60:63]
s_add_u32 m0, s46, 131072
s_nop 0
buffer_load_dwordx4 v8, s[20:23], s97 offen offset:0  lds
ds_read_b64_tr_b16 a[204:205], v15 offset:49152
ds_read_b64_tr_b16 a[206:207], v15 offset:51200
s_waitcnt vmcnt(22) lgkmcnt(15)
v_mfma_f32_16x16x32_bf16 v[48:51], a[160:163], a[24:27], v[48:51]
ds_read_b64_tr_b16 a[208:209], v12 offset:53248
ds_read_b64_tr_b16 a[210:211], v12 offset:55296
v_mfma_f32_16x16x32_bf16 v[52:55], a[164:167], a[24:27], v[52:55]
ds_read_b64_tr_b16 a[212:213], v13 offset:53248
ds_read_b64_tr_b16 a[214:215], v13 offset:55296
v_mfma_f32_16x16x32_bf16 v[56:59], a[168:171], a[24:27], v[56:59]
buffer_load_dwordx4 v9, s[20:23], s97 offen offset:1024  lds
s_add_u32 s97, s97, 0x10000
s_cmp_eq_u32 s97, 917504
s_cselect_b32 s97, 0, s97
ds_read_b64_tr_b16 a[216:217], v14 offset:53248
ds_read_b64_tr_b16 a[218:219], v14 offset:55296
v_mfma_f32_16x16x32_bf16 v[60:63], a[172:175], a[24:27], v[60:63]
ds_read_b64_tr_b16 a[220:221], v15 offset:53248
ds_read_b64_tr_b16 a[222:223], v15 offset:55296
s_waitcnt vmcnt(22) lgkmcnt(15)
v_mfma_f32_16x16x32_bf16 v[48:51], a[176:179], a[28:31], v[48:51]
s_add_u32 m0, s46, 139264
s_nop 0
buffer_load_dwordx4 v8, s[20:23], s97 offen offset:0  lds
v_mfma_f32_16x16x32_bf16 v[52:55], a[180:183], a[28:31], v[52:55]
v_mfma_f32_16x16x32_bf16 v[56:59], a[184:187], a[28:31], v[56:59]
v_mfma_f32_16x16x32_bf16 v[60:63], a[188:191], a[28:31], v[60:63]
buffer_load_dwordx4 v9, s[20:23], s97 offen offset:1024  lds
s_add_u32 s97, s97, 0x10000
s_cmp_eq_u32 s97, 917504
s_cselect_b32 s97, 0, s97
s_waitcnt lgkmcnt(8)
s_barrier
s_waitcnt vmcnt(23)
v_mfma_f32_16x16x32_bf16 v[48:51], a[192:195], a[32:35], v[48:51]
s_add_u32 m0, s46, 147456
s_nop 0
buffer_load_dwordx4 v8, s[20:23], s97 offen offset:0  lds
ds_read_b64_tr_b16 a[224:225], v12 offset:57344
ds_read_b64_tr_b16 a[226:227], v12 offset:59392
v_mfma_f32_16x16x32_bf16 v[52:55], a[196:199], a[32:35], v[52:55]
ds_read_b64_tr_b16 a[228:229], v13 offset:57344
ds_read_b64_tr_b16 a[230:231], v13 offset:59392
v_mfma_f32_16x16x32_bf16 v[56:59], a[200:203], a[32:35], v[56:59]
ds_read_b64_tr_b16 a[232:233], v14 offset:57344
ds_read_b64_tr_b16 a[234:235], v14 offset:59392
v_mfma_f32_16x16x32_bf16 v[60:63], a[204:207], a[32:35], v[60:63]
buffer_load_dwordx4 v9, s[20:23], s97 offen offset:1024  lds
s_add_u32 s97, s97, 0x10000
s_cmp_eq_u32 s97, 917504
s_cselect_b32 s97, 0, s97
ds_read_b64_tr_b16 a[236:237], v15 offset:57344
ds_read_b64_tr_b16 a[238:239], v15 offset:59392
s_waitcnt vmcnt(24) lgkmcnt(8)
v_mfma_f32_16x16x32_bf16 v[48:51], a[208:211], a[36:39], v[48:51]
ds_read_b64_tr_b16 a[240:241], v12 offset:61440
ds_read_b64_tr_b16 a[242:243], v12 offset:63488
v_mfma_f32_16x16x32_bf16 v[52:55], a[212:215], a[36:39], v[52:55]
s_add_u32 m0, s46, 155648
s_nop 0
buffer_load_dwordx4 v8, s[20:23], s97 offen offset:0  lds
ds_read_b64_tr_b16 a[244:245], v13 offset:61440
ds_read_b64_tr_b16 a[246:247], v13 offset:63488
v_mfma_f32_16x16x32_bf16 v[56:59], a[216:219], a[36:39], v[56:59]
ds_read_b64_tr_b16 a[248:249], v14 offset:61440
ds_read_b64_tr_b16 a[250:251], v14 offset:63488
v_mfma_f32_16x16x32_bf16 v[60:63], a[220:223], a[36:39], v[60:63]
ds_read_b64_tr_b16 a[252:253], v15 offset:61440
ds_read_b64_tr_b16 a[254:255], v15 offset:63488
s_waitcnt vmcnt(24) lgkmcnt(8)
v_mfma_f32_16x16x32_bf16 v[48:51], a[224:227], a[40:43], v[48:51]
buffer_load_dwordx4 v9, s[20:23], s97 offen offset:1024  lds
s_add_u32 s97, s97, 0x10000
s_cmp_eq_u32 s97, 917504
s_cselect_b32 s97, 0, s97
ds_read_b64_tr_b16 a[64:65], v16 offset:0
ds_read_b64_tr_b16 a[66:67], v16 offset:2048
v_mfma_f32_16x16x32_bf16 v[52:55], a[228:231], a[40:43], v[52:55]
ds_read_b64_tr_b16 a[68:69], v17 offset:0
ds_read_b64_tr_b16 a[70:71], v17 offset:2048
v_mfma_f32_16x16x32_bf16 v[56:59], a[232:235], a[40:43], v[56:59]
s_add_u32 m0, s46, 16384
s_nop 0
buffer_load_dwordx4 v8, s[20:23], s97 offen offset:0  lds
ds_read_b64_tr_b16 a[72:73], v18 offset:0
ds_read_b64_tr_b16 a[74:75], v18 offset:2048
v_mfma_f32_16x16x32_bf16 v[60:63], a[236:239], a[40:43], v[60:63]
ds_read_b64_tr_b16 a[76:77], v19 offset:0
ds_read_b64_tr_b16 a[78:79], v19 offset:2048
s_waitcnt vmcnt(25) lgkmcnt(8)
v_mfma_f32_16x16x32_bf16 v[48:51], a[240:243], a[44:47], v[48:51]
ds_read_b64_tr_b16 a[80:81], v16 offset:4096
ds_read_b64_tr_b16 a[82:83], v16 offset:6144
v_mfma_f32_16x16x32_bf16 v[52:55], a[244:247], a[44:47], v[52:55]
buffer_load_dwordx4 v9, s[20:23], s97 offen offset:1024  lds
s_add_u32 s97, s97, 0x10000
s_cmp_eq_u32 s97, 917504
s_cselect_b32 s97, 0, s97
ds_read_b64_tr_b16 a[84:85], v17 offset:4096
ds_read_b64_tr_b16 a[86:87], v17 offset:6144
v_mfma_f32_16x16x32_bf16 v[56:59], a[248:251], a[44:47], v[56:59]
ds_read_b64_tr_b16 a[88:89], v18 offset:4096
ds_read_b64_tr_b16 a[90:91], v18 offset:6144
v_mfma_f32_16x16x32_bf16 v[60:63], a[252:255], a[44:47], v[60:63]
s_add_u32 m0, s46, 24576
s_nop 0
buffer_load_dwordx4 v8, s[20:23], s97 offen offset:0  lds
ds_read_b64_tr_b16 a[92:93], v19 offset:4096
ds_read_b64_tr_b16 a[94:95], v19 offset:6144
s_waitcnt vmcnt(26) lgkmcnt(8)
v_mfma_f32_16x16x32_bf16 v[48:51], a[64:67], a[48:51], v[48:51]
ds_read_b64_tr_b16 a[96:97], v16 offset:8192
ds_read_b64_tr_b16 a[98:99], v16 offset:10240
v_mfma_f32_16x16x32_bf16 v[52:55], a[68:71], a[48:51], v[52:55]
ds_read_b64_tr_b16 a[100:101], v17 offset:8192
ds_read_b64_tr_b16 a[102:103], v17 offset:10240
v_mfma_f32_16x16x32_bf16 v[56:59], a[72:75], a[48:51], v[56:59]
buffer_load_dwordx4 v9, s[20:23], s97 offen offset:1024  lds
s_add_u32 s97, s97, 0x10000
s_cmp_eq_u32 s97, 917504
s_cselect_b32 s97, 0, s97
ds_read_b64_tr_b16 a[104:105], v18 offset:8192
ds_read_b64_tr_b16 a[106:107], v18 offset:10240
v_mfma_f32_16x16x32_bf16 v[60:63], a[76:79], a[48:51], v[60:63]
ds_read_b64_tr_b16 a[108:109], v19 offset:8192
ds_read_b64_tr_b16 a[110:111], v19 offset:10240
s_waitcnt vmcnt(26) lgkmcnt(8)
v_mfma_f32_16x16x32_bf16 v[48:51], a[80:83], a[52:55], v[48:51]
s_add_u32 m0, s46, 32768
s_nop 0
buffer_load_dwordx4 v8, s[20:23], s97 offen offset:0  lds
ds_read_b64_tr_b16 a[112:113], v16 offset:12288
ds_read_b64_tr_b16 a[114:115], v16 offset:14336
v_mfma_f32_16x16x32_bf16 v[52:55], a[84:87], a[52:55], v[52:55]
ds_read_b64_tr_b16 a[116:117], v17 offset:12288
ds_read_b64_tr_b16 a[118:119], v17 offset:14336
v_mfma_f32_16x16x32_bf16 v[56:59], a[88:91], a[52:55], v[56:59]
ds_read_b64_tr_b16 a[120:121], v18 offset:12288
ds_read_b64_tr_b16 a[122:123], v18 offset:14336
v_mfma_f32_16x16x32_bf16 v[60:63], a[92:95], a[52:55], v[60:63]
buffer_load_dwordx4 v9, s[20:23], s97 offen offset:1024  lds
s_add_u32 s97, s97, 0x10000
s_cmp_eq_u32 s97, 917504
s_cselect_b32 s97, 0, s97
ds_read_b64_tr_b16 a[124:125], v19 offset:12288
ds_read_b64_tr_b16 a[126:127], v19 offset:14336
s_waitcnt vmcnt(27) lgkmcnt(8)
v_mfma_f32_16x16x32_bf16 v[48:51], a[96:99], a[56:59], v[48:51]
v_mfma_f32_16x16x32_bf16 v[52:55], a[100:103], a[56:59], v[52:55]
s_add_u32 m0, s46, 40960
s_nop 0
buffer_load_dwordx4 v8, s[20:23], s97 offen offset:0  lds
v_mfma_f32_16x16x32_bf16 v[56:59], a[104:107], a[56:59], v[56:59]
v_mfma_f32_16x16x32_bf16 v[60:63], a[108:111], a[56:59], v[60:63]
s_waitcnt vmcnt(27) lgkmcnt(0)
v_mfma_f32_16x16x32_bf16 v[48:51], a[112:115], a[60:63], v[48:51]
buffer_load_dwordx4 v9, s[20:23], s97 offen offset:1024  lds
s_add_u32 s97, s97, 0x10000
s_cmp_eq_u32 s97, 917504
s_cselect_b32 s97, 0, s97
v_mfma_f32_16x16x32_bf16 v[52:55], a[116:119], a[60:63], v[52:55]
v_mfma_f32_16x16x32_bf16 v[56:59], a[120:123], a[60:63], v[56:59]
v_mfma_f32_16x16x32_bf16 v[60:63], a[124:127], a[60:63], v[60:63]
buffer_load_dword v245, v246, s[24:27], s58 offen sc1
v_lshlrev_b32 v32, 16, v224
v_and_b32 v33, 0xffff0000, v224
v_lshlrev_b32 v34, 16, v225
v_and_b32 v35, 0xffff0000, v225
v_lshlrev_b32 v36, 16, v226
v_and_b32 v37, 0xffff0000, v226
v_lshlrev_b32 v38, 16, v227
v_and_b32 v39, 0xffff0000, v227
v_lshlrev_b32 v40, 16, v228
v_and_b32 v41, 0xffff0000, v228
v_lshlrev_b32 v42, 16, v229
v_and_b32 v43, 0xffff0000, v229
v_lshlrev_b32 v44, 16, v230
v_and_b32 v45, 0xffff0000, v230
v_lshlrev_b32 v46, 16, v231
v_and_b32 v47, 0xffff0000, v231
v_add_u32 v5, 1024, v5
s_waitcnt vmcnt(17)
s_barrier
ds_read_b64_tr_b16 a[128:129], v16 offset:16384
ds_read_b64_tr_b16 a[130:131], v16 offset:18432
ds_read_b64_tr_b16 a[132:133], v17 offset:16384
ds_read_b64_tr_b16 a[134:135], v17 offset:18432
ds_read_b64_tr_b16 a[136:137], v18 offset:16384
ds_read_b64_tr_b16 a[138:139], v18 offset:18432
ds_read_b64_tr_b16 a[140:141], v19 offset:16384
ds_read_b64_tr_b16 a[142:143], v19 offset:18432
ds_read_b64_tr_b16 a[144:145], v16 offset:20480
ds_read_b64_tr_b16 a[146:147], v16 offset:22528
ds_read_b64_tr_b16 a[148:149], v17 offset:20480
ds_read_b64_tr_b16 a[150:151], v17 offset:22528
ds_read_b64_tr_b16 a[152:153], v18 offset:20480
ds_read_b64_tr_b16 a[154:155], v18 offset:22528
ds_read_b64_tr_b16 a[156:157], v19 offset:20480
ds_read_b64_tr_b16 a[158:159], v19 offset:22528
ds_read_b64_tr_b16 a[160:161], v16 offset:24576
ds_read_b64_tr_b16 a[162:163], v16 offset:26624
ds_read_b64_tr_b16 a[164:165], v17 offset:24576
ds_read_b64_tr_b16 a[166:167], v17 offset:26624
ds_read_b64_tr_b16 a[168:169], v18 offset:24576
ds_read_b64_tr_b16 a[170:171], v18 offset:26624
ds_read_b64_tr_b16 a[172:173], v19 offset:24576
ds_read_b64_tr_b16 a[174:175], v19 offset:26624
ds_read_b64_tr_b16 a[176:177], v16 offset:28672
ds_read_b64_tr_b16 a[178:179], v16 offset:30720
ds_read_b64_tr_b16 a[180:181], v17 offset:28672
ds_read_b64_tr_b16 a[182:183], v17 offset:30720
ds_read_b64_tr_b16 a[184:185], v18 offset:28672
ds_read_b64_tr_b16 a[186:187], v18 offset:30720
ds_read_b64_tr_b16 a[188:189], v19 offset:28672
ds_read_b64_tr_b16 a[190:191], v19 offset:30720
ds_read_b64_tr_b16 a[192:193], v16 offset:32768
ds_read_b64_tr_b16 a[194:195], v16 offset:34816
ds_read_b64_tr_b16 a[196:197], v17 offset:32768
ds_read_b64_tr_b16 a[198:199], v17 offset:34816
ds_read_b64_tr_b16 a[200:201], v18 offset:32768
ds_read_b64_tr_b16 a[202:203], v18 offset:34816
ds_read_b64_tr_b16 a[204:205], v19 offset:32768
ds_read_b64_tr_b16 a[206:207], v19 offset:34816
ds_read_b64_tr_b16 a[208:209], v16 offset:36864
ds_read_b64_tr_b16 a[210:211], v16 offset:38912
ds_read_b64_tr_b16 a[212:213], v17 offset:36864
ds_read_b64_tr_b16 a[214:215], v17 offset:38912
ds_read_b64_tr_b16 a[216:217], v18 offset:36864
ds_read_b64_tr_b16 a[218:219], v18 offset:38912
ds_read_b64_tr_b16 a[220:221], v19 offset:36864
ds_read_b64_tr_b16 a[222:223], v19 offset:38912
s_waitcnt vmcnt(0)
s_cmp_lg_u32 s40, 0
s_cbranch_scc1 L_w0_21
v_cmp_ne_u32 vcc, s45, v245
s_nop 1
s_cbranch_vccnz L_hf_19
L_hfb_20:
L_w0_21:
s_barrier
buffer_load_dwordx4 v[64:67], v1, s[24:27], s48 offen offset:0 sc1
buffer_load_dwordx4 v[68:71], v1, s[24:27], s48 offen offset:1024 sc1
buffer_load_dwordx4 v[72:75], v1, s[24:27], s48 offen offset:2048 sc1
buffer_load_dwordx4 v[76:79], v1, s[24:27], s48 offen offset:3072 sc1
buffer_load_dwordx4 v[80:83], v1, s[24:27], s49 offen offset:0 sc1
buffer_load_dwordx4 v[84:87], v1, s[24:27], s49 offen offset:1024 sc1
buffer_load_dwordx4 v[88:91], v1, s[24:27], s49 offen offset:2048 sc1
buffer_load_dwordx4 v[92:95], v1, s[24:27], s49 offen offset:3072 sc1
ds_read_b64_tr_b16 a[224:225], v16 offset:40960
ds_read_b64_tr_b16 a[226:227], v16 offset:43008
ds_read_b64_tr_b16 a[228:229], v17 offset:40960
ds_read_b64_tr_b16 a[230:231], v17 offset:43008
ds_read_b64_tr_b16 a[232:233], v18 offset:40960
ds_read_b64_tr_b16 a[234:235], v18 offset:43008
ds_read_b64_tr_b16 a[236:237], v19 offset:40960
ds_read_b64_tr_b16 a[238:239], v19 offset:43008
ds_read_b64_tr_b16 a[240:241], v16 offset:45056
ds_read_b64_tr_b16 a[242:243], v16 offset:47104
ds_read_b64_tr_b16 a[244:245], v17 offset:45056
ds_read_b64_tr_b16 a[246:247], v17 offset:47104
ds_read_b64_tr_b16 a[248:249], v18 offset:45056
ds_read_b64_tr_b16 a[250:251], v18 offset:47104
ds_read_b64_tr_b16 a[252:253], v19 offset:45056
ds_read_b64_tr_b16 a[254:255], v19 offset:47104
ds_read_b64_tr_b16 a[0:1], v16 offset:49152
ds_read_b64_tr_b16 a[2:3], v16 offset:51200
ds_read_b64_tr_b16 a[4:5], v17 offset:49152
ds_read_b64_tr_b16 a[6:7], v17 offset:51200
ds_read_b64_tr_b16 a[8:9], v18 offset:49152
ds_read_b64_tr_b16 a[10:11], v18 offset:51200
ds_read_b64_tr_b16 a[12:13], v19 offset:49152
ds_read_b64_tr_b16 a[14:15], v19 offset:51200
ds_read_b64_tr_b16 a[16:17], v16 offset:53248
ds_read_b64_tr_b16 a[18:19], v16 offset:55296
ds_read_b64_tr_b16 a[20:21], v17 offset:53248
ds_read_b64_tr_b16 a[22:23], v17 offset:55296
ds_read_b64_tr_b16 a[24:25], v18 offset:53248
ds_read_b64_tr_b16 a[26:27], v18 offset:55296
ds_read_b64_tr_b16 a[28:29], v19 offset:53248
ds_read_b64_tr_b16 a[30:31], v19 offset:55296
ds_read_b64_tr_b16 a[32:33], v16 offset:57344
ds_read_b64_tr_b16 a[34:35], v16 offset:59392
ds_read_b64_tr_b16 a[36:37], v17 offset:57344
ds_read_b64_tr_b16 a[38:39], v17 offset:59392
ds_read_b64_tr_b16 a[40:41], v18 offset:57344
ds_read_b64_tr_b16 a[42:43], v18 offset:59392
ds_read_b64_tr_b16 a[44:45], v19 offset:57344
ds_read_b64_tr_b16 a[46:47], v19 offset:59392
ds_read_b64_tr_b16 a[48:49], v16 offset:61440
ds_read_b64_tr_b16 a[50:51], v16 offset:63488
ds_read_b64_tr_b16 a[52:53], v17 offset:61440
ds_read_b64_tr_b16 a[54:55], v17 offset:63488
ds_read_b64_tr_b16 a[56:57], v18 offset:61440
ds_read_b64_tr_b16 a[58:59], v18 offset:63488
ds_read_b64_tr_b16 a[60:61], v19 offset:61440
ds_read_b64_tr_b16 a[62:63], v19 offset:63488
s_waitcnt vmcnt(7) lgkmcnt(15)
v_mfma_f32_16x16x32_bf16 v[176:179], a[128:131], v[64:67], 0
buffer_load_dwordx4 v[96:99], v1, s[24:27], s50 offen offset:0 sc1
v_mfma_f32_16x16x32_bf16 v[180:183], a[132:135], v[64:67], 0
ds_read_b64_tr_b16 a[64:65], v20 offset:0
ds_read_b64_tr_b16 a[66:67], v20 offset:2048
v_mfma_f32_16x16x32_bf16 v[184:187], a[136:139], v[64:67], 0
ds_read_b64_tr_b16 a[68:69], v21 offset:0
ds_read_b64_tr_b16 a[70:71], v21 offset:2048
v_mfma_f32_16x16x32_bf16 v[188:191], a[140:143], v[64:67], 0
buffer_load_dwordx4 v[100:103], v1, s[24:27], s50 offen offset:1024 sc1
ds_read_b64_tr_b16 a[72:73], v22 offset:0
s_waitcnt vmcnt(8)
v_mfma_f32_16x16x32_bf16 v[176:179], a[144:147], v[68:71], v[176:179]
ds_read_b64_tr_b16 a[74:75], v22 offset:2048
ds_read_b64_tr_b16 a[76:77], v23 offset:0
v_mfma_f32_16x16x32_bf16 v[180:183], a[148:151], v[68:71], v[180:183]
buffer_load_dwordx4 v[104:107], v1, s[24:27], s50 offen offset:2048 sc1
v_mfma_f32_16x16x32_bf16 v[184:187], a[152:155], v[68:71], v[184:187]
ds_read_b64_tr_b16 a[78:79], v23 offset:2048
ds_read_b64_tr_b16 a[80:81], v20 offset:4096
v_mfma_f32_16x16x32_bf16 v[188:191], a[156:159], v[68:71], v[188:191]
ds_read_b64_tr_b16 a[82:83], v20 offset:6144
s_waitcnt vmcnt(8)
v_mfma_f32_16x16x32_bf16 v[176:179], a[160:163], v[72:75], v[176:179]
buffer_load_dwordx4 v[108:111], v1, s[24:27], s50 offen offset:3072 sc1
v_mfma_f32_16x16x32_bf16 v[180:183], a[164:167], v[72:75], v[180:183]
ds_read_b64_tr_b16 a[84:85], v21 offset:4096
ds_read_b64_tr_b16 a[86:87], v21 offset:6144
v_mfma_f32_16x16x32_bf16 v[184:187], a[168:171], v[72:75], v[184:187]
ds_read_b64_tr_b16 a[88:89], v22 offset:4096
ds_read_b64_tr_b16 a[90:91], v22 offset:6144
v_mfma_f32_16x16x32_bf16 v[188:191], a[172:175], v[72:75], v[188:191]
buffer_load_dwordx4 v[112:115], v1, s[24:27], s51 offen offset:0 sc1
ds_read_b64_tr_b16 a[92:93], v23 offset:4096
s_waitcnt vmcnt(9)
v_mfma_f32_16x16x32_bf16 v[176:179], a[176:179], v[76:79], v[176:179]
ds_read_b64_tr_b16 a[94:95], v23 offset:6144
ds_read_b64_tr_b16 a[96:97], v20 offset:8192
v_mfma_f32_16x16x32_bf16 v[180:183], a[180:183], v[76:79], v[180:183]
buffer_load_dwordx4 v[116:119], v1, s[24:27], s51 offen offset:1024 sc1
v_mfma_f32_16x16x32_bf16 v[184:187], a[184:187], v[76:79], v[184:187]
ds_read_b64_tr_b16 a[98:99], v20 offset:10240
ds_read_b64_tr_b16 a[100:101], v21 offset:8192
v_mfma_f32_16x16x32_bf16 v[188:191], a[188:191], v[76:79], v[188:191]
ds_read_b64_tr_b16 a[102:103], v21 offset:10240
s_waitcnt vmcnt(9)
v_mfma_f32_16x16x32_bf16 v[176:179], a[192:195], v[80:83], v[176:179]
buffer_load_dwordx4 v[120:123], v1, s[24:27], s51 offen offset:2048 sc1
v_mfma_f32_16x16x32_bf16 v[180:183], a[196:199], v[80:83], v[180:183]
ds_read_b64_tr_b16 a[104:105], v22 offset:8192
ds_read_b64_tr_b16 a[106:107], v22 offset:10240
v_mfma_f32_16x16x32_bf16 v[184:187], a[200:203], v[80:83], v[184:187]
ds_read_b64_tr_b16 a[108:109], v23 offset:8192
ds_read_b64_tr_b16 a[110:111], v23 offset:10240
v_mfma_f32_16x16x32_bf16 v[188:191], a[204:207], v[80:83], v[188:191]
buffer_load_dwordx4 v[124:127], v1, s[24:27], s51 offen offset:3072 sc1
ds_read_b64_tr_b16 a[112:113], v20 offset:12288
s_waitcnt vmcnt(10)
v_mfma_f32_16x16x32_bf16 v[176:179], a[208:211], v[84:87], v[176:179]
ds_read_b64_tr_b16 a[114:115], v20 offset:14336
ds_read_b64_tr_b16 a[116:117], v21 offset:12288
v_mfma_f32_16x16x32_bf16 v[180:183], a[212:215], v[84:87], v[180:183]
buffer_load_dwordx4 v[128:131], v1, s[24:27], s52 offen offset:0 sc1
v_mfma_f32_16x16x32_bf16 v[184:187], a[216:219], v[84:87], v[184:187]
ds_read_b64_tr_b16 a[118:119], v21 offset:14336
ds_read_b64_tr_b16 a[120:121], v22 offset:12288
v_mfma_f32_16x16x32_bf16 v[188:191], a[220:223], v[84:87], v[188:191]
ds_read_b64_tr_b16 a[122:123], v22 offset:14336
s_waitcnt vmcnt(10)
v_mfma_f32_16x16x32_bf16 v[176:179], a[224:227], v[88:91], v[176:179]
buffer_load_dwordx4 v[132:135], v1, s[24:27], s52 offen offset:1024 sc1
v_mfma_f32_16x16x32_bf16 v[180:183], a[228:231], v[88:91], v[180:183]
ds_read_b64_tr_b16 a[124:125], v23 offset:12288
ds_read_b64_tr_b16 a[126:127], v23 offset:14336
v_mfma_f32_16x16x32_bf16 v[184:187], a[232:235], v[88:91], v[184:187]
ds_read_b64_tr_b16 a[128:129], v20 offset:16384
ds_read_b64_tr_b16 a[130:131], v20 offset:18432
v_mfma_f32_16x16x32_bf16 v[188:191], a[236:239], v[88:91], v[188:191]
buffer_load_dwordx4 v[136:139], v1, s[24:27], s52 offen offset:2048 sc1
ds_read_b64_tr_b16 a[132:133], v21 offset:16384
s_waitcnt vmcnt(11)
v_mfma_f32_16x16x32_bf16 v[176:179], a[240:243], v[92:95], v[176:179]
ds_read_b64_tr_b16 a[134:135], v21 offset:18432
ds_read_b64_tr_b16 a[136:137], v22 offset:16384
v_mfma_f32_16x16x32_bf16 v[180:183], a[244:247], v[92:95], v[180:183]
buffer_load_dwordx4 v[140:143], v1, s[24:27], s52 offen offset:3072 sc1
v_mfma_f32_16x16x32_bf16 v[184:187], a[248:251], v[92:95], v[184:187]
ds_read_b64_tr_b16 a[138:139], v22 offset:18432
ds_read_b64_tr_b16 a[140:141], v23 offset:16384
v_mfma_f32_16x16x32_bf16 v[188:191], a[252:255], v[92:95], v[188:191]
ds_read_b64_tr_b16 a[142:143], v23 offset:18432
s_waitcnt vmcnt(11)
v_mfma_f32_16x16x32_bf16 v[176:179], a[0:3], v[96:99], v[176:179]
buffer_load_dwordx4 v[144:147], v1, s[24:27], s53 offen offset:0 sc1
v_mfma_f32_16x16x32_bf16 v[180:183], a[4:7], v[96:99], v[180:183]
ds_read_b64_tr_b16 a[144:145], v20 offset:20480
ds_read_b64_tr_b16 a[146:147], v20 offset:22528
v_mfma_f32_16x16x32_bf16 v[184:187], a[8:11], v[96:99], v[184:187]
ds_read_b64_tr_b16 a[148:149], v21 offset:20480
ds_read_b64_tr_b16 a[150:151], v21 offset:22528
v_mfma_f32_16x16x32_bf16 v[188:191], a[12:15], v[96:99], v[188:191]
buffer_load_dwordx4 v[148:151], v1, s[24:27], s53 offen offset:1024 sc1
ds_read_b64_tr_b16 a[152:153], v22 offset:20480
s_waitcnt vmcnt(12)
v_mfma_f32_16x16x32_bf16 v[176:179], a[16:19], v[100:103], v[176:179]
ds_read_b64_tr_b16 a[154:155], v22 offset:22528
ds_read_b64_tr_b16 a[156:157], v23 offset:20480
v_mfma_f32_16x16x32_bf16 v[180:183], a[20:23], v[100:103], v[180:183]
buffer_load_dwordx4 v[152:155], v1, s[24:27], s53 offen offset:2048 sc1
v_mfma_f32_16x16x32_bf16 v[184:187], a[24:27], v[100:103], v[184:187]
ds_read_b64_tr_b16 a[158:159], v23 offset:22528
ds_read_b64_tr_b16 a[160:161], v20 offset:24576
v_mfma_f32_16x16x32_bf16 v[188:191], a[28:31], v[100:103], v[188:191]
ds_read_b64_tr_b16 a[162:163], v20 offset:26624
s_waitcnt vmcnt(12) lgkmcnt(15)
v_mfma_f32_16x16x32_bf16 v[176:179], a[32:35], v[104:107], v[176:179]
buffer_load_dwordx4 v[156:159], v1, s[24:27], s53 offen offset:3072 sc1
v_mfma_f32_16x16x32_bf16 v[180:183], a[36:39], v[104:107], v[180:183]
ds_read_b64_tr_b16 a[164:165], v21 offset:24576
ds_read_b64_tr_b16 a[166:167], v21 offset:26624
v_mfma_f32_16x16x32_bf16 v[184:187], a[40:43], v[104:107], v[184:187]
ds_read_b64_tr_b16 a[168:169], v22 offset:24576
ds_read_b64_tr_b16 a[170:171], v22 offset:26624
v_mfma_f32_16x16x32_bf16 v[188:191], a[44:47], v[104:107], v[188:191]
buffer_load_dwordx4 v[160:163], v1, s[24:27], s54 offen offset:0 sc1
ds_read_b64_tr_b16 a[172:173], v23 offset:24576
s_waitcnt vmcnt(13)
v_mfma_f32_16x16x32_bf16 v[176:179], a[48:51], v[108:111], v[176:179]
ds_read_b64_tr_b16 a[174:175], v23 offset:26624
ds_read_b64_tr_b16 a[176:177], v20 offset:28672
v_mfma_f32_16x16x32_bf16 v[180:183], a[52:55], v[108:111], v[180:183]
buffer_load_dwordx4 v[164:167], v1, s[24:27], s54 offen offset:1024 sc1
v_mfma_f32_16x16x32_bf16 v[184:187], a[56:59], v[108:111], v[184:187]
ds_read_b64_tr_b16 a[178:179], v20 offset:30720
ds_read_b64_tr_b16 a[180:181], v21 offset:28672
v_mfma_f32_16x16x32_bf16 v[188:191], a[60:63], v[108:111], v[188:191]
ds_read_b64_tr_b16 a[182:183], v21 offset:30720
s_waitcnt vmcnt(13)
v_mfma_f32_16x16x32_bf16 v[176:179], a[64:67], v[112:115], v[176:179]
buffer_load_dwordx4 v[168:171], v1, s[24:27], s54 offen offset:2048 sc1
v_mfma_f32_16x16x32_bf16 v[180:183], a[68:71], v[112:115], v[180:183]
ds_read_b64_tr_b16 a[184:185], v22 offset:28672
ds_read_b64_tr_b16 a[186:187], v22 offset:30720
v_mfma_f32_16x16x32_bf16 v[184:187], a[72:75], v[112:115], v[184:187]
ds_read_b64_tr_b16 a[188:189], v23 offset:28672
ds_read_b64_tr_b16 a[190:191], v23 offset:30720
v_mfma_f32_16x16x32_bf16 v[188:191], a[76:79], v[112:115], v[188:191]
buffer_load_dwordx4 v[172:175], v1, s[24:27], s54 offen offset:3072 sc1
ds_read_b64_tr_b16 a[192:193], v12 offset:16384
s_waitcnt vmcnt(14)
v_mfma_f32_16x16x32_bf16 v[176:179], a[80:83], v[116:119], v[176:179]
ds_read_b64_tr_b16 a[194:195], v12 offset:18432
ds_read_b64_tr_b16 a[196:197], v13 offset:16384
v_mfma_f32_16x16x32_bf16 v[180:183], a[84:87], v[116:119], v[180:183]
ds_read_b64_tr_b16 a[198:199], v13 offset:18432
v_mfma_f32_16x16x32_bf16 v[184:187], a[88:91], v[116:119], v[184:187]
ds_read_b64_tr_b16 a[200:201], v14 offset:16384
v_mfma_f32_16x16x32_bf16 v[188:191], a[92:95], v[116:119], v[188:191]
ds_read_b64_tr_b16 a[202:203], v14 offset:18432
s_waitcnt vmcnt(13)
v_mfma_f32_16x16x32_bf16 v[176:179], a[96:99], v[120:123], v[176:179]
ds_read_b64_tr_b16 a[204:205], v15 offset:16384
ds_read_b64_tr_b16 a[206:207], v15 offset:18432
v_mfma_f32_16x16x32_bf16 v[180:183], a[100:103], v[120:123], v[180:183]
ds_read_b64_tr_b16 a[208:209], v12 offset:20480
v_mfma_f32_16x16x32_bf16 v[184:187], a[104:107], v[120:123], v[184:187]
ds_read_b64_tr_b16 a[210:211], v12 offset:22528
v_mfma_f32_16x16x32_bf16 v[188:191], a[108:111], v[120:123], v[188:191]
ds_read_b64_tr_b16 a[212:213], v13 offset:20480
s_waitcnt vmcnt(12)
v_mfma_f32_16x16x32_bf16 v[176:179], a[112:115], v[124:127], v[176:179]
ds_read_b64_tr_b16 a[214:215], v13 offset:22528
ds_read_b64_tr_b16 a[216:217], v14 offset:20480
v_mfma_f32_16x16x32_bf16 v[180:183], a[116:119], v[124:127], v[180:183]
ds_read_b64_tr_b16 a[218:219], v14 offset:22528
v_mfma_f32_16x16x32_bf16 v[184:187], a[120:123], v[124:127], v[184:187]
ds_read_b64_tr_b16 a[220:221], v15 offset:20480
v_mfma_f32_16x16x32_bf16 v[188:191], a[124:127], v[124:127], v[188:191]
ds_read_b64_tr_b16 a[222:223], v15 offset:22528
s_waitcnt vmcnt(11) lgkmcnt(15)
v_mfma_f32_16x16x32_bf16 v[176:179], a[128:131], v[128:131], v[176:179]
ds_read_b64_tr_b16 a[224:225], v12 offset:24576
ds_read_b64_tr_b16 a[226:227], v12 offset:26624
v_mfma_f32_16x16x32_bf16 v[180:183], a[132:135], v[128:131], v[180:183]
ds_read_b64_tr_b16 a[228:229], v13 offset:24576
v_mfma_f32_16x16x32_bf16 v[184:187], a[136:139], v[128:131], v[184:187]
ds_read_b64_tr_b16 a[230:231], v13 offset:26624
v_mfma_f32_16x16x32_bf16 v[188:191], a[140:143], v[128:131], v[188:191]
ds_read_b64_tr_b16 a[232:233], v14 offset:24576
s_waitcnt vmcnt(10)
v_mfma_f32_16x16x32_bf16 v[176:179], a[144:147], v[132:135], v[176:179]
ds_read_b64_tr_b16 a[234:235], v14 offset:26624
ds_read_b64_tr_b16 a[236:237], v15 offset:24576
v_mfma_f32_16x16x32_bf16 v[180:183], a[148:151], v[132:135], v[180:183]
ds_read_b64_tr_b16 a[238:239], v15 offset:26624
v_mfma_f32_16x16x32_bf16 v[184:187], a[152:155], v[132:135], v[184:187]
ds_read_b64_tr_b16 a[240:241], v12 offset:28672
v_mfma_f32_16x16x32_bf16 v[188:191], a[156:159], v[132:135], v[188:191]
ds_read_b64_tr_b16 a[242:243], v12 offset:30720
s_waitcnt vmcnt(9)
v_mfma_f32_16x16x32_bf16 v[176:179], a[160:163], v[136:139], v[176:179]
ds_read_b64_tr_b16 a[244:245], v13 offset:28672
ds_read_b64_tr_b16 a[246:247], v13 offset:30720
v_mfma_f32_16x16x32_bf16 v[180:183], a[164:167], v[136:139], v[180:183]
ds_read_b64_tr_b16 a[248:249], v14 offset:28672
v_mfma_f32_16x16x32_bf16 v[184:187], a[168:171], v[136:139], v[184:187]
ds_read_b64_tr_b16 a[250:251], v14 offset:30720
v_mfma_f32_16x16x32_bf16 v[188:191], a[172:175], v[136:139], v[188:191]
ds_read_b64_tr_b16 a[252:253], v15 offset:28672
s_waitcnt vmcnt(8)
v_mfma_f32_16x16x32_bf16 v[176:179], a[176:179], v[140:143], v[176:179]
ds_read_b64_tr_b16 a[254:255], v15 offset:30720
ds_read_b64_tr_b16 a[0:1], v12 offset:32768
v_mfma_f32_16x16x32_bf16 v[180:183], a[180:183], v[140:143], v[180:183]
ds_read_b64_tr_b16 a[2:3], v12 offset:34816
v_mfma_f32_16x16x32_bf16 v[184:187], a[184:187], v[140:143], v[184:187]
ds_read_b64_tr_b16 a[4:5], v13 offset:32768
v_mfma_f32_16x16x32_bf16 v[188:191], a[188:191], v[140:143], v[188:191]
ds_read_b64_tr_b16 a[6:7], v13 offset:34816
s_waitcnt vmcnt(7) lgkmcnt(15)
v_mfma_f32_16x16x32_bf16 v[176:179], a[192:195], v[144:147], v[176:179]
ds_read_b64_tr_b16 a[8:9], v14 offset:32768
ds_read_b64_tr_b16 a[10:11], v14 offset:34816
v_mfma_f32_16x16x32_bf16 v[180:183], a[196:199], v[144:147], v[180:183]
ds_read_b64_tr_b16 a[12:13], v15 offset:32768
v_mfma_f32_16x16x32_bf16 v[184:187], a[200:203], v[144:147], v[184:187]
ds_read_b64_tr_b16 a[14:15], v15 offset:34816
v_mfma_f32_16x16x32_bf16 v[188:191], a[204:207], v[144:147], v[188:191]
ds_read_b64_tr_b16 a[16:17], v12 offset:36864
s_waitcnt vmcnt(6)
v_mfma_f32_16x16x32_bf16 v[176:179], a[208:211], v[148:151], v[176:179]
ds_read_b64_tr_b16 a[18:19], v12 offset:38912
ds_read_b64_tr_b16 a[20:21], v13 offset:36864
v_mfma_f32_16x16x32_bf16 v[180:183], a[212:215], v[148:151], v[180:183]
ds_read_b64_tr_b16 a[22:23], v13 offset:38912
v_mfma_f32_16x16x32_bf16 v[184:187], a[216:219], v[148:151], v[184:187]
ds_read_b64_tr_b16 a[24:25], v14 offset:36864
v_mfma_f32_16x16x32_bf16 v[188:191], a[220:223], v[148:151], v[188:191]
ds_read_b64_tr_b16 a[26:27], v14 offset:38912
s_waitcnt vmcnt(5) lgkmcnt(15)
v_mfma_f32_16x16x32_bf16 v[176:179], a[224:227], v[152:155], v[176:179]
ds_read_b64_tr_b16 a[28:29], v15 offset:36864
ds_read_b64_tr_b16 a[30:31], v15 offset:38912
v_mfma_f32_16x16x32_bf16 v[180:183], a[228:231], v[152:155], v[180:183]
ds_read_b64_tr_b16 a[32:33], v12 offset:40960
v_mfma_f32_16x16x32_bf16 v[184:187], a[232:235], v[152:155], v[184:187]
ds_read_b64_tr_b16 a[34:35], v12 offset:43008
v_mfma_f32_16x16x32_bf16 v[188:191], a[236:239], v[152:155], v[188:191]
ds_read_b64_tr_b16 a[36:37], v13 offset:40960
s_waitcnt vmcnt(4) lgkmcnt(15)
v_mfma_f32_16x16x32_bf16 v[176:179], a[240:243], v[156:159], v[176:179]
ds_read_b64_tr_b16 a[38:39], v13 offset:43008
ds_read_b64_tr_b16 a[40:41], v14 offset:40960
v_mfma_f32_16x16x32_bf16 v[180:183], a[244:247], v[156:159], v[180:183]
ds_read_b64_tr_b16 a[42:43], v14 offset:43008
v_mfma_f32_16x16x32_bf16 v[184:187], a[248:251], v[156:159], v[184:187]
ds_read_b64_tr_b16 a[44:45], v15 offset:40960
v_mfma_f32_16x16x32_bf16 v[188:191], a[252:255], v[156:159], v[188:191]
ds_read_b64_tr_b16 a[46:47], v15 offset:43008
s_waitcnt vmcnt(3) lgkmcnt(15)
v_mfma_f32_16x16x32_bf16 v[176:179], a[0:3], v[160:163], v[176:179]
ds_read_b64_tr_b16 a[48:49], v12 offset:45056
ds_read_b64_tr_b16 a[50:51], v12 offset:47104
v_mfma_f32_16x16x32_bf16 v[180:183], a[4:7], v[160:163], v[180:183]
ds_read_b64_tr_b16 a[52:53], v13 offset:45056
v_mfma_f32_16x16x32_bf16 v[184:187], a[8:11], v[160:163], v[184:187]
ds_read_b64_tr_b16 a[54:55], v13 offset:47104
v_mfma_f32_16x16x32_bf16 v[188:191], a[12:15], v[160:163], v[188:191]
ds_read_b64_tr_b16 a[56:57], v14 offset:45056
s_waitcnt vmcnt(2) lgkmcnt(13)
v_mfma_f32_16x16x32_bf16 v[176:179], a[16:19], v[164:167], v[176:179]
ds_read_b64_tr_b16 a[58:59], v14 offset:47104
v_mfma_f32_16x16x32_bf16 v[180:183], a[20:23], v[164:167], v[180:183]
ds_read_b64_tr_b16 a[60:61], v15 offset:45056
v_mfma_f32_16x16x32_bf16 v[184:187], a[24:27], v[164:167], v[184:187]
ds_read_b64_tr_b16 a[62:63], v15 offset:47104
v_mfma_f32_16x16x32_bf16 v[188:191], a[28:31], v[164:167], v[188:191]
s_waitcnt vmcnt(1) lgkmcnt(8)
v_mfma_f32_16x16x32_bf16 v[176:179], a[32:35], v[168:171], v[176:179]
v_mfma_f32_16x16x32_bf16 v[180:183], a[36:39], v[168:171], v[180:183]
v_mfma_f32_16x16x32_bf16 v[184:187], a[40:43], v[168:171], v[184:187]
v_mfma_f32_16x16x32_bf16 v[188:191], a[44:47], v[168:171], v[188:191]
s_waitcnt vmcnt(0) lgkmcnt(0)
v_mfma_f32_16x16x32_bf16 v[176:179], a[48:51], v[172:175], v[176:179]
v_mfma_f32_16x16x32_bf16 v[180:183], a[52:55], v[172:175], v[180:183]
v_mfma_f32_16x16x32_bf16 v[184:187], a[56:59], v[172:175], v[184:187]
v_mfma_f32_16x16x32_bf16 v[188:191], a[60:63], v[172:175], v[188:191]
s_mov_b32 s72, 0xbfb8aa3b
s_mov_b32 s73, 0xbfb8aa3b
s_nop 2
v_pk_mul_f32 v[64:65], v[176:177], s[72:73]
v_pk_mul_f32 v[66:67], v[178:179], s[72:73]
v_pk_mul_f32 v[68:69], v[180:181], s[72:73]
v_pk_mul_f32 v[70:71], v[182:183], s[72:73]
v_pk_mul_f32 v[72:73], v[184:185], s[72:73]
v_pk_mul_f32 v[74:75], v[186:187], s[72:73]
v_pk_mul_f32 v[76:77], v[188:189], s[72:73]
v_pk_mul_f32 v[78:79], v[190:191], s[72:73]
v_exp_f32 v64, v64
v_exp_f32 v65, v65
v_pk_mul_f32 v[176:177], v[176:177], v[48:49]
v_exp_f32 v66, v66
v_exp_f32 v67, v67
v_pk_mul_f32 v[178:179], v[178:179], v[50:51]
v_exp_f32 v68, v68
v_exp_f32 v69, v69
v_pk_mul_f32 v[180:181], v[180:181], v[52:53]
v_exp_f32 v70, v70
v_exp_f32 v71, v71
v_pk_mul_f32 v[182:183], v[182:183], v[54:55]
v_exp_f32 v72, v72
v_exp_f32 v73, v73
v_pk_mul_f32 v[184:185], v[184:185], v[56:57]
v_exp_f32 v74, v74
v_exp_f32 v75, v75
v_pk_mul_f32 v[186:187], v[186:187], v[58:59]
v_exp_f32 v76, v76
v_exp_f32 v77, v77
v_pk_mul_f32 v[188:189], v[188:189], v[60:61]
v_exp_f32 v78, v78
v_exp_f32 v79, v79
v_pk_mul_f32 v[190:191], v[190:191], v[62:63]
v_pk_add_f32 v[64:65], v[64:65], 1.0 op_sel_hi:[1,0]
v_pk_add_f32 v[66:67], v[66:67], 1.0 op_sel_hi:[1,0]
v_pk_add_f32 v[68:69], v[68:69], 1.0 op_sel_hi:[1,0]
v_pk_add_f32 v[70:71], v[70:71], 1.0 op_sel_hi:[1,0]
v_pk_add_f32 v[72:73], v[72:73], 1.0 op_sel_hi:[1,0]
v_pk_add_f32 v[74:75], v[74:75], 1.0 op_sel_hi:[1,0]
v_pk_add_f32 v[76:77], v[76:77], 1.0 op_sel_hi:[1,0]
v_pk_add_f32 v[78:79], v[78:79], 1.0 op_sel_hi:[1,0]
v_rcp_f32 v64, v64
v_rcp_f32 v65, v65
v_rcp_f32 v66, v66
v_rcp_f32 v67, v67
v_rcp_f32 v68, v68
v_rcp_f32 v69, v69
v_rcp_f32 v70, v70
v_rcp_f32 v71, v71
v_rcp_f32 v72, v72
v_rcp_f32 v73, v73
v_rcp_f32 v74, v74
v_rcp_f32 v75, v75
v_rcp_f32 v76, v76
v_rcp_f32 v77, v77
v_rcp_f32 v78, v78
v_rcp_f32 v79, v79
v_pk_fma_f32 v[176:177], v[176:177], v[64:65], v[32:33]
v_pk_fma_f32 v[178:179], v[178:179], v[66:67], v[34:35]
v_pk_fma_f32 v[180:181], v[180:181], v[68:69], v[36:37]
v_pk_fma_f32 v[182:183], v[182:183], v[70:71], v[38:39]
v_pk_fma_f32 v[184:185], v[184:185], v[72:73], v[40:41]
v_pk_fma_f32 v[186:187], v[186:187], v[74:75], v[42:43]
v_pk_fma_f32 v[188:189], v[188:189], v[76:77], v[44:45]
v_pk_fma_f32 v[190:191], v[190:191], v[78:79], v[46:47]
v_cvt_pk_bf16_f32 v64, v176, v177
v_cvt_pk_bf16_f32 v65, v178, v179
ds_write_b64 v24, v[64:65]
v_cvt_pk_bf16_f32 v66, v180, v181
v_cvt_pk_bf16_f32 v67, v182, v183
ds_write_b64 v25, v[66:67]
v_cvt_pk_bf16_f32 v68, v184, v185
v_cvt_pk_bf16_f32 v69, v186, v187
ds_write_b64 v26, v[68:69]
v_cvt_pk_bf16_f32 v70, v188, v189
v_cvt_pk_bf16_f32 v71, v190, v191
ds_write_b64 v27, v[70:71]
ds_read_b128 v[72:75], v28 offset:0
ds_read_b128 v[76:79], v28 offset:1024
s_waitcnt lgkmcnt(1)
buffer_store_dwordx4 v[72:75], v4, s[28:31], s55 offen sc1
s_waitcnt lgkmcnt(0)
buffer_store_dwordx4 v[76:79], v5, s[28:31], s55 offen sc1
s_endpgm
L_st_1:
s_mov_b32 s93, 0
L_st_1_l:
s_sleep 2
s_add_u32 s93, s93, 1
buffer_load_dwordx4 v[232:235], v223, s[24:27], s86 offen sc1
buffer_load_dwordx4 v[236:239], v223, s[24:27], s87 offen sc1
s_waitcnt vmcnt(0)
v_xor_b32 v240, s45, v234
s_nop 1
v_xor_b32 v241, s45, v239
s_nop 1
v_or_b32 v240, v240, v241
s_nop 1
v_cmp_ne_u32 vcc, 0, v240
s_nop 1
s_cmp_gt_u32 s93, 30000
s_cbranch_scc1 L_stb_2
s_cbranch_vccnz L_st_1_l
s_branch L_stb_2
L_kv_3:
s_mov_b32 s93, 0
L_kv_3_l:
s_sleep 2
s_add_u32 s93, s93, 1
buffer_load_dwordx4 v[56:59], v1, s[24:27], s76 offen sc1
buffer_load_dwordx4 v[60:63], v1, s[24:27], s76 offen offset:1024 sc1
s_waitcnt vmcnt(0)
v_xor_b32 v59, s45, v58
s_nop 1
v_xor_b32 v63, s45, v62
s_nop 1
v_or_b32 v59, v59, v63
s_nop 1
v_cmp_ne_u32 vcc, 0, v59
s_nop 1
s_cmp_gt_u32 s93, 30000
s_cbranch_scc1 L_kvb_4
s_cbranch_vccnz L_kv_3_l
s_branch L_kvb_4
L_z_5:
s_mov_b32 s93, 0
L_z_5_l:
s_sleep 2
s_add_u32 s93, s93, 1
buffer_load_dword v219, v218, s[24:27], s89 offen sc1
s_waitcnt vmcnt(0)
v_cmp_ne_u32 vcc, s45, v219
s_nop 1
s_cmp_gt_u32 s93, 30000
s_cbranch_scc1 L_zb_6
s_cbranch_vccnz L_z_5_l
s_branch L_zb_6
L_x_7:
s_mov_b32 s93, 0
L_x_7_l:
s_sleep 2
s_add_u32 s93, s93, 1
buffer_load_dword v219, v227, s[24:27], s88 offen sc1
s_waitcnt vmcnt(0)
v_cmp_ne_u32 vcc, s45, v219
s_nop 1
s_cmp_gt_u32 s93, 30000
s_cbranch_scc1 L_xb_8
s_cbranch_vccnz L_x_7_l
s_branch L_xb_8
L_of_9:
s_mov_b32 s93, 0
L_of_9_l:
s_sleep 2
s_add_u32 s93, s93, 1
buffer_load_dword v228, v218, s[24:27], s59 offen sc1
s_waitcnt vmcnt(0)
v_cmp_ne_u32 vcc, s45, v228
s_nop 1
s_cmp_gt_u32 s93, 30000
s_cbranch_scc1 L_ofb_10
s_cbranch_vccnz L_of_9_l
s_branch L_ofb_10
L_hf_11:
s_mov_b32 s93, 0
L_hf_11_l:
s_sleep 1
s_add_u32 s93, s93, 1
buffer_load_dword v245, v246, s[24:27], s58 offen sc1
s_waitcnt vmcnt(0)
v_cmp_ne_u32 vcc, s45, v245
s_nop 1
s_cmp_gt_u32 s93, 30000
s_cbranch_scc1 L_hfb_12
s_cbranch_vccnz L_hf_11_l
s_branch L_hfb_12
L_kv_15:
s_mov_b32 s93, 0
L_kv_15_l:
s_sleep 2
s_add_u32 s93, s93, 1
buffer_load_dwordx4 v[56:59], v1, s[24:27], s76 offen sc1
buffer_load_dwordx4 v[60:63], v1, s[24:27], s76 offen offset:1024 sc1
s_waitcnt vmcnt(0)
v_xor_b32 v59, s45, v58
s_nop 1
v_xor_b32 v63, s45, v62
s_nop 1
v_or_b32 v59, v59, v63
s_nop 1
v_cmp_ne_u32 vcc, 0, v59
s_nop 1
s_cmp_gt_u32 s93, 30000
s_cbranch_scc1 L_kvb_16
s_cbranch_vccnz L_kv_15_l
s_branch L_kvb_16
L_of_17:
s_mov_b32 s93, 0
L_of_17_l:
s_sleep 8
s_add_u32 s93, s93, 1
buffer_load_dword v228, v218, s[24:27], s59 offen sc1
s_waitcnt vmcnt(0)
v_cmp_ne_u32 vcc, s45, v228
s_nop 1
s_cmp_gt_u32 s93, 30000
s_cbranch_scc1 L_ofb_18
s_cbranch_vccnz L_of_17_l
s_branch L_ofb_18
L_hf_19:
s_mov_b32 s93, 0
L_hf_19_l:
s_sleep 8
s_add_u32 s93, s93, 1
buffer_load_dword v245, v246, s[24:27], s58 offen sc1
s_waitcnt vmcnt(0)
v_cmp_ne_u32 vcc, s45, v245
s_nop 1
s_cmp_gt_u32 s93, 30000
s_cbranch_scc1 L_hfb_20
s_cbranch_vccnz L_hf_19_l
s_branch L_hfb_20
L_end:
s_endpgm
.fill (65536 + 256 - (. - recurrent_scan__sliding_local_dilated__mixer_gmlp__prompt_kernel)) / 4, 4, 0xBF810000
.section .rodata,"a"
.p2align 6
.amdhsa_kernel recurrent_scan__sliding_local_dilated__mixer_gmlp__prompt_kernel
  .amdhsa_next_free_vgpr 512
  .amdhsa_next_free_sgpr 102
  .amdhsa_accum_offset 256
  .amdhsa_group_segment_fixed_size 0
  .amdhsa_kernarg_size 88
  .amdhsa_user_sgpr_count 2
  .amdhsa_user_sgpr_kernarg_segment_ptr 1
  .amdhsa_system_sgpr_workgroup_id_x 1
.end_amdhsa_kernel
```
